```python
import torch

def _softmax(x, axis=-1):
    return torch.softmax(x, dim=axis)
def _gelu(x):
    return torch.nn.functional.gelu(x, approximate="tanh")
def _silu(x):
    return torch.nn.functional.silu(x)
def _sigmoid(x):
    return torch.sigmoid(x)
def _layernorm(x, axis=-1, eps=1e-5):
    m = x.mean(dim=axis, keepdim=True)
    v = x.var(dim=axis, keepdim=True, unbiased=False)
    return (x - m) / torch.sqrt(v + eps)
def _scatter_add(tgt, idx, src, axis=0):
    return tgt.clone().index_add_(axis, idx, src)
def _segment_sum(src, seg, n):
    out = torch.zeros((n,) + src.shape[1:], dtype=src.dtype)
    return out.index_add_(0, seg, src)
def _pad(x, pw):
    flat = tuple(v for pair in reversed(pw) for v in pair)
    return torch.nn.functional.pad(x, flat)

kernel_name = 'interleave_layers__softmax_full_mha__mixer_token_mlp__prompt'

def setup_inputs():

    _w = (lambda a: (lambda t: t.to(torch.bfloat16) if t.is_floating_point() else t)(torch.as_tensor(a)))
    def _A_setup():
        B, S, D = 1, 2048, 640
        return {
            "x": _w((lambda *s: torch.randn(*s, dtype=torch.bfloat16) * 0.05)(B, S, D)),
            "wqkv": _w((lambda *s: torch.randn(*s, dtype=torch.bfloat16) * 0.05)(D, 3 * D)),
            "wo": _w((lambda *s: torch.randn(*s, dtype=torch.bfloat16) * 0.05)(D, D)),
        }
    _A_in = _A_setup()

    def _B_setup():
        B, S, D, F = 1, 2048, 640, 1536
        return {
            "x": _w((lambda *s: torch.randn(*s, dtype=torch.bfloat16) * 0.05)(B, S, D)),
            "w1": _w((lambda *s: torch.randn(*s, dtype=torch.bfloat16) * 0.8)(S, F) * (S ** -0.5)),
            "b1": _w((lambda *s: torch.randn(*s, dtype=torch.bfloat16) * 12.8)(F) * 0.02),
            "w2": _w((lambda *s: torch.randn(*s, dtype=torch.bfloat16) * 0.4)(F, S) * (F ** -0.5)),
            "b2": _w((lambda *s: torch.randn(*s, dtype=torch.bfloat16) * 6.4)(S) * 0.02),
        }
    _B_in = _B_setup()

    return {
        "A_x": _A_in["x"],
        "A_wqkv": _A_in["wqkv"],
        "A_wo": _A_in["wo"],
        "B_x": _B_in["x"],
        "B_w1": _B_in["w1"],
        "B_b1": _B_in["b1"],
        "B_w2": _B_in["w2"],
        "B_b2": _B_in["b2"],
    }

def reference(A_x, A_wqkv, A_wo, B_x, B_w1, B_b1, B_w2, B_b2):
    def _A_ref(x, wqkv, wo):
        B, S, D = x.shape
        H = 32; Dh = D // H
        qkv = (lambda x, *d: x.permute(*d))((x @ wqkv).reshape(B, S, 3, H, Dh), 2, 0, 3, 1, 4)
        q, k, v = qkv[0], qkv[1], qkv[2]
        scale = Dh ** -0.5
        scores = torch.einsum("bhqd,bhkd->bhqk", q, k) * scale
        p = _softmax(scores, axis=-1)
        o = torch.einsum("bhqk,bhkd->bhqd", p, v)
        return (lambda x, *d: x.permute(*d))(o, 0, 2, 1, 3).reshape(B, S, D) @ wo

    def _B_ref(x, w1, b1, w2, b2):
        B, S, D = x.shape
        h = _layernorm(x, axis=-1)
        u = torch.einsum("bsd,sf->bdf", h, w1) + b1
        u = _gelu(u)
        y = torch.einsum("bdf,fs->bds", u, w2) + b2
        return (lambda x, *d: x.permute(*d))(y, 0, 2, 1)

    x = A_x
    x = x + _A_ref(_layernorm(x, axis=-1), A_wqkv, A_wo)
    x = x + _B_ref(_layernorm(x, axis=-1), B_w1, B_b1, B_w2, B_b2)
    x = x + _A_ref(_layernorm(x, axis=-1), A_wqkv, A_wo)
    x = x + _B_ref(_layernorm(x, axis=-1), B_w1, B_b1, B_w2, B_b2)
    return x
```

```asm
; @launch grid=(256,1,1) block=(512,1,1) lds=163840
.amdgcn_target "amdgcn-amd-amdhsa--gfx950"
.text
.globl interleave_layers__softmax_full_mha__mixer_token_mlp__prompt_kernel
.p2align 8
.type interleave_layers__softmax_full_mha__mixer_token_mlp__prompt_kernel,@function
interleave_layers__softmax_full_mha__mixer_token_mlp__prompt_kernel:
    s_load_dwordx16 s[68:83], s[0:1], 0
    s_load_dwordx4 s[84:87], s[0:1], 64
    s_load_dwordx2 s[88:89], s[0:1], 80
    s_cmp_ge_u32 s2, 256
    s_cbranch_scc1 L_end
    v_and_b32 v252, 63, v0
    v_lshrrev_b32 v1, 6, v0
    v_mov_b32 v255, 0
    v_readfirstlane_b32 s24, v1
    s_mov_b32 s91, 0
    s_mov_b32 s96, 0x1200000
    s_and_b32 s3, s24, 3
    s_lshl_b32 s95, s2, 3
    s_add_u32 s95, s95, s24
    s_lshl_b32 s95, s95, 8
    s_add_u32 s95, s95, 0x1100000
    s_cmp_ge_u32 s2, 16
    s_cbranch_scc1 L_nopf
    s_cmp_ge_u32 s24, 3
    s_cbranch_scc1 L_nopf
    s_getpc_b64 s[30:31]
    s_lshl_b32 s33, s24, 13
    v_lshl_add_u32 v2, v252, 7, s33
    v_mov_b32 v3, s31
    v_add_co_u32 v2, vcc, s30, v2
    s_nop 1
    v_addc_co_u32 v3, vcc, 0, v3, vcc
    global_load_dword v249, v[2:3], off
L_nopf:
    s_waitcnt lgkmcnt(0)
    s_mov_b32 s4, s88
    s_mov_b32 s5, s89
    s_mov_b32 s6, 0x1600000
    s_mov_b32 s7, 0x20000
    s_add_u32 s20, s88, 0x1600000
    s_addc_u32 s21, s89, 0
    s_mov_b32 s22, 0x1400000
    s_mov_b32 s23, 0x20000
    buffer_load_dword v253, v255, s[4:7], 0 offen sc1
    s_cmp_ge_u32 s2, 240
    s_cbranch_scc1 L_q0_repack
    s_and_b32 s30, s2, 7
    s_mul_i32 s30, s30, 30
    s_lshr_b32 s31, s2, 3
    s_add_u32 s34, s30, s31
    s_mul_i32 s31, s34, 205
    s_lshr_b32 s31, s31, 10
    s_mul_i32 s30, s31, 5
    s_sub_u32 s26, s34, s30
    s_and_b32 s25, s31, 15
    s_lshr_b32 s27, s31, 4
    s_lshl_b32 s30, s25, 2
    s_add_u32 s32, s30, s3
    s_mul_i32 s30, s27, 5
    s_add_u32 s40, s30, s26
    s_lshl_b32 s34, s40, 4
    s_add_u32 s34, s34, s25
    s_mov_b32 s12, s68
    s_mov_b32 s13, s69
    s_mov_b32 s14, 0x280000
    s_mov_b32 s15, 0x20000
    s_mov_b32 s16, s70
    s_mov_b32 s17, s71
    s_mov_b32 s18, 0x258000
    s_mov_b32 s19, 0x20000
    s_mul_i32 s28, s32, 40960
    s_lshl_b32 s35, s3, 12
    s_cmp_lt_u32 s24, 4
    s_cbranch_scc1 L_q0_c
    v_lshrrev_b32 v145, 3, v252
    v_and_b32 v146, 4, v145
    v_add_u32 v146, v146, v145
    v_mul_u32_u24 v146, 1280, v146
    v_lshrrev_b32 v147, 4, v252
    v_and_b32 v148, 7, v252
    v_xor_b32 v148, v148, v147
    v_lshl_add_u32 v123, v148, 4, v146
    v_xor_b32 v148, 64, v123
    v_add_u32 v124, 4096, v148
    v_add_u32 v125, 18432, v123
    v_add_u32 v126, 22528, v148
    v_lshrrev_b32 v147, 4, v252
    v_and_b32 v148, 15, v252
    v_lshlrev_b32 v149, 2, v147
    v_xor_b32 v148, v148, v149
    v_mul_u32_u24 v147, 3840, v147
    v_lshl_add_u32 v127, v148, 4, v147
    v_add_u32 v128, 14336, v127
    v_add_u32 v129, 28672, v127
    v_add_u32 v130, 43008, v127
    s_lshl_b32 s30, s40, 8
    s_mul_i32 s29, s3, 61440
    s_add_u32 s29, s29, s30
    s_add_u32 s30, s25, s26
    s_mul_i32 s31, s30, 52
    s_lshr_b32 s31, s31, 8
    s_mul_i32 s31, s31, 5
    s_sub_u32 s30, s30, s31
    s_lshl_b32 s36, s30, 1
    s_mul_i32 s30, s36, 245760
    s_add_u32 s29, s29, s30
    s_lshl_b32 s30, s36, 7
    s_add_u32 s28, s28, s30
    s_add_u32 m0, s35, 16384
    s_nop 0
    buffer_load_dwordx4 v127, s[16:19], s29 offen offset:0 lds
    buffer_load_dwordx4 v128, s[16:19], s29 offen offset:1024 lds
    buffer_load_dwordx4 v129, s[16:19], s29 offen offset:2048 lds
    buffer_load_dwordx4 v130, s[16:19], s29 offen offset:3072 lds
    s_add_u32 m0, s35, 0
    s_add_u32 s29, s29, 245760
    buffer_load_dwordx4 v123, s[12:15], s28 offen offset:0 lds
    buffer_load_dwordx4 v124, s[12:15], s28 offen offset:1024 lds
    buffer_load_dwordx4 v125, s[12:15], s28 offen offset:2048 lds
    buffer_load_dwordx4 v126, s[12:15], s28 offen offset:3072 lds
    s_add_u32 s28, s28, 128
    s_add_u32 s36, s36, 1
    s_cmp_eq_u32 s36, 10
    s_cselect_b32 s37, 2457600, 0
    s_cselect_b32 s38, 1280, 0
    s_sub_u32 s29, s29, s37
    s_sub_u32 s28, s28, s38
    s_add_u32 m0, s35, 49152
    s_nop 0
    buffer_load_dwordx4 v127, s[16:19], s29 offen offset:0 lds
    buffer_load_dwordx4 v128, s[16:19], s29 offen offset:1024 lds
    buffer_load_dwordx4 v129, s[16:19], s29 offen offset:2048 lds
    buffer_load_dwordx4 v130, s[16:19], s29 offen offset:3072 lds
    s_add_u32 m0, s35, 32768
    s_add_u32 s29, s29, 245760
    buffer_load_dwordx4 v123, s[12:15], s28 offen offset:0 lds
    buffer_load_dwordx4 v124, s[12:15], s28 offen offset:1024 lds
    buffer_load_dwordx4 v125, s[12:15], s28 offen offset:2048 lds
    buffer_load_dwordx4 v126, s[12:15], s28 offen offset:3072 lds
    s_add_u32 s28, s28, 128
    s_add_u32 s36, s36, 1
    s_cmp_eq_u32 s36, 10
    s_cselect_b32 s37, 2457600, 0
    s_cselect_b32 s38, 1280, 0
    s_sub_u32 s29, s29, s37
    s_sub_u32 s28, s28, s38
    v_lshrrev_b32 v121, 5, v252
    v_and_b32 v122, 31, v252
    v_bfe_u32 v144, v252, 1, 3
    v_xor_b32 v144, v144, v121
    v_lshlrev_b32 v144, 4, v144
    v_lshl_add_u32 v144, v122, 7, v144
    v_add_u32 v131, s35, v144
    v_xor_b32 v132, 32, v131
    v_xor_b32 v133, 64, v131
    v_xor_b32 v134, 96, v131
    v_bfe_u32 v144, v252, 2, 2
    v_lshl_add_u32 v145, v121, 3, v144
    v_lshlrev_b32 v145, 8, v145
    v_xor_b32 v144, s3, v144
    v_lshl_add_u32 v145, v144, 6, v145
    v_and_b32 v146, 16, v252
    v_lshl_add_u32 v145, v146, 1, v145
    v_and_b32 v146, 3, v252
    v_lshl_add_u32 v145, v146, 3, v145
    v_add_u32 v135, 16384, v145
    v_xor_b32 v136, 64, v135
    v_xor_b32 v137, 128, v135
    v_xor_b32 v138, 192, v135
    v_bfe_u32 v144, v252, 4, 1
    v_and_b32 v145, 15, v252
    v_cmp_eq_u32 vcc, v144, v145
    v_mov_b32 v146, 0x3f803f80
    v_mov_b32 v8, 0
    v_mov_b32 v9, 0
    v_mov_b32 v10, 0
    v_mov_b32 v11, 0
    v_mov_b32 v12, 0
    v_mov_b32 v13, 0
    v_mov_b32 v14, 0
    v_mov_b32 v15, 0
    s_setprio 2
    v_cndmask_b32 v0, 0, v146, vcc
    v_cndmask_b32 v1, 0, v146, vcc
    v_cndmask_b32 v2, 0, v146, vcc
    v_cndmask_b32 v3, 0, v146, vcc
    s_waitcnt vmcnt(8)
    s_barrier
    ds_read_b128 v[96:99], v131 offset:0
    ds_read_b64_tr_b16 v[64:65], v135 offset:0
    ds_read_b64_tr_b16 v[66:67], v135 offset:1024
    s_waitcnt lgkmcnt(0)
    ds_read_b128 v[100:103], v132 offset:0
    ds_read_b64_tr_b16 v[80:81], v135 offset:4096
    ds_read_b64_tr_b16 v[82:83], v135 offset:5120
    v_mfma_f32_16x16x32_bf16 v[4:7], v[64:67], v[0:3], 0
    v_lshlrev_b32 v16, 16, v96
    v_and_b32 v17, 0xffff0000, v96
    v_lshlrev_b32 v18, 16, v97
    v_and_b32 v19, 0xffff0000, v97
    v_lshlrev_b32 v20, 16, v98
    v_and_b32 v21, 0xffff0000, v98
    v_lshlrev_b32 v22, 16, v99
    v_and_b32 v23, 0xffff0000, v99
    v_add_f32 v8, v8, v16
    v_fmac_f32 v12, v16, v16
    v_add_f32 v9, v9, v17
    v_fmac_f32 v13, v17, v17
    v_add_f32 v10, v10, v18
    v_fmac_f32 v14, v18, v18
    v_add_f32 v11, v11, v19
    v_fmac_f32 v15, v19, v19
    v_add_f32 v8, v8, v20
    v_fmac_f32 v12, v20, v20
    v_add_f32 v9, v9, v21
    v_fmac_f32 v13, v21, v21
    v_add_f32 v10, v10, v22
    v_fmac_f32 v14, v22, v22
    v_add_f32 v11, v11, v23
    v_fmac_f32 v15, v23, v23
    s_add_u32 m0, s35, 81920
    s_nop 0
    buffer_load_dwordx4 v127, s[16:19], s29 offen offset:0 lds
    buffer_load_dwordx4 v128, s[16:19], s29 offen offset:1024 lds
    buffer_load_dwordx4 v129, s[16:19], s29 offen offset:2048 lds
    s_waitcnt lgkmcnt(0)
    ds_read_b128 v[96:99], v133 offset:0
    ds_read_b64_tr_b16 v[64:65], v135 offset:8192
    ds_read_b64_tr_b16 v[66:67], v135 offset:9216
    v_mfma_f32_16x16x32_bf16 v[4:7], v[80:83], v[0:3], v[4:7]
    v_lshlrev_b32 v16, 16, v100
    v_and_b32 v17, 0xffff0000, v100
    v_lshlrev_b32 v18, 16, v101
    v_and_b32 v19, 0xffff0000, v101
    v_lshlrev_b32 v20, 16, v102
    v_and_b32 v21, 0xffff0000, v102
    v_lshlrev_b32 v22, 16, v103
    v_and_b32 v23, 0xffff0000, v103
    v_add_f32 v8, v8, v16
    v_fmac_f32 v12, v16, v16
    v_add_f32 v9, v9, v17
    v_fmac_f32 v13, v17, v17
    v_add_f32 v10, v10, v18
    v_fmac_f32 v14, v18, v18
    v_add_f32 v11, v11, v19
    v_fmac_f32 v15, v19, v19
    v_add_f32 v8, v8, v20
    v_fmac_f32 v12, v20, v20
    v_add_f32 v9, v9, v21
    v_fmac_f32 v13, v21, v21
    v_add_f32 v10, v10, v22
    v_fmac_f32 v14, v22, v22
    v_add_f32 v11, v11, v23
    v_fmac_f32 v15, v23, v23
    buffer_load_dwordx4 v130, s[16:19], s29 offen offset:3072 lds
    s_add_u32 m0, s35, 65536
    s_add_u32 s29, s29, 245760
    buffer_load_dwordx4 v123, s[12:15], s28 offen offset:0 lds
    s_waitcnt lgkmcnt(0)
    ds_read_b128 v[100:103], v134 offset:0
    ds_read_b64_tr_b16 v[80:81], v135 offset:12288
    ds_read_b64_tr_b16 v[82:83], v135 offset:13312
    v_mfma_f32_16x16x32_bf16 v[4:7], v[64:67], v[0:3], v[4:7]
    v_lshlrev_b32 v16, 16, v96
    v_and_b32 v17, 0xffff0000, v96
    v_lshlrev_b32 v18, 16, v97
    v_and_b32 v19, 0xffff0000, v97
    v_lshlrev_b32 v20, 16, v98
    v_and_b32 v21, 0xffff0000, v98
    v_lshlrev_b32 v22, 16, v99
    v_and_b32 v23, 0xffff0000, v99
    v_add_f32 v8, v8, v16
    v_fmac_f32 v12, v16, v16
    v_add_f32 v9, v9, v17
    v_fmac_f32 v13, v17, v17
    v_add_f32 v10, v10, v18
    v_fmac_f32 v14, v18, v18
    v_add_f32 v11, v11, v19
    v_fmac_f32 v15, v19, v19
    v_add_f32 v8, v8, v20
    v_fmac_f32 v12, v20, v20
    v_add_f32 v9, v9, v21
    v_fmac_f32 v13, v21, v21
    v_add_f32 v10, v10, v22
    v_fmac_f32 v14, v22, v22
    v_add_f32 v11, v11, v23
    v_fmac_f32 v15, v23, v23
    buffer_load_dwordx4 v124, s[12:15], s28 offen offset:1024 lds
    buffer_load_dwordx4 v125, s[12:15], s28 offen offset:2048 lds
    buffer_load_dwordx4 v126, s[12:15], s28 offen offset:3072 lds
    s_add_u32 s28, s28, 128
    s_add_u32 s36, s36, 1
    s_cmp_eq_u32 s36, 10
    s_cselect_b32 s37, 2457600, 0
    s_cselect_b32 s38, 1280, 0
    s_sub_u32 s29, s29, s37
    s_sub_u32 s28, s28, s38
    s_waitcnt vmcnt(8) lgkmcnt(0)
    s_barrier
    ds_read_b128 v[96:99], v131 offset:32768
    ds_read_b64_tr_b16 v[64:65], v135 offset:32768
    ds_read_b64_tr_b16 v[66:67], v135 offset:33792
    v_mfma_f32_16x16x32_bf16 v[4:7], v[80:83], v[0:3], v[4:7]
    v_lshlrev_b32 v16, 16, v100
    v_and_b32 v17, 0xffff0000, v100
    v_lshlrev_b32 v18, 16, v101
    v_and_b32 v19, 0xffff0000, v101
    v_lshlrev_b32 v20, 16, v102
    v_and_b32 v21, 0xffff0000, v102
    v_lshlrev_b32 v22, 16, v103
    v_and_b32 v23, 0xffff0000, v103
    v_add_f32 v8, v8, v16
    v_fmac_f32 v12, v16, v16
    v_add_f32 v9, v9, v17
    v_fmac_f32 v13, v17, v17
    v_add_f32 v10, v10, v18
    v_fmac_f32 v14, v18, v18
    v_add_f32 v11, v11, v19
    v_fmac_f32 v15, v19, v19
    v_add_f32 v8, v8, v20
    v_fmac_f32 v12, v20, v20
    v_add_f32 v9, v9, v21
    v_fmac_f32 v13, v21, v21
    v_add_f32 v10, v10, v22
    v_fmac_f32 v14, v22, v22
    v_add_f32 v11, v11, v23
    v_fmac_f32 v15, v23, v23
    s_waitcnt lgkmcnt(0)
    ds_read_b128 v[100:103], v132 offset:32768
    ds_read_b64_tr_b16 v[80:81], v135 offset:36864
    ds_read_b64_tr_b16 v[82:83], v135 offset:37888
    v_mfma_f32_16x16x32_bf16 v[4:7], v[64:67], v[0:3], v[4:7]
    v_lshlrev_b32 v16, 16, v96
    v_and_b32 v17, 0xffff0000, v96
    v_lshlrev_b32 v18, 16, v97
    v_and_b32 v19, 0xffff0000, v97
    v_lshlrev_b32 v20, 16, v98
    v_and_b32 v21, 0xffff0000, v98
    v_lshlrev_b32 v22, 16, v99
    v_and_b32 v23, 0xffff0000, v99
    v_add_f32 v8, v8, v16
    v_fmac_f32 v12, v16, v16
    v_add_f32 v9, v9, v17
    v_fmac_f32 v13, v17, v17
    v_add_f32 v10, v10, v18
    v_fmac_f32 v14, v18, v18
    v_add_f32 v11, v11, v19
    v_fmac_f32 v15, v19, v19
    v_add_f32 v8, v8, v20
    v_fmac_f32 v12, v20, v20
    v_add_f32 v9, v9, v21
    v_fmac_f32 v13, v21, v21
    v_add_f32 v10, v10, v22
    v_fmac_f32 v14, v22, v22
    v_add_f32 v11, v11, v23
    v_fmac_f32 v15, v23, v23
    s_add_u32 m0, s35, 114688
    s_nop 0
    buffer_load_dwordx4 v127, s[16:19], s29 offen offset:0 lds
    buffer_load_dwordx4 v128, s[16:19], s29 offen offset:1024 lds
    buffer_load_dwordx4 v129, s[16:19], s29 offen offset:2048 lds
    s_waitcnt lgkmcnt(0)
    ds_read_b128 v[96:99], v133 offset:32768
    ds_read_b64_tr_b16 v[64:65], v135 offset:40960
    ds_read_b64_tr_b16 v[66:67], v135 offset:41984
    v_mfma_f32_16x16x32_bf16 v[4:7], v[80:83], v[0:3], v[4:7]
    v_lshlrev_b32 v16, 16, v100
    v_and_b32 v17, 0xffff0000, v100
    v_lshlrev_b32 v18, 16, v101
    v_and_b32 v19, 0xffff0000, v101
    v_lshlrev_b32 v20, 16, v102
    v_and_b32 v21, 0xffff0000, v102
    v_lshlrev_b32 v22, 16, v103
    v_and_b32 v23, 0xffff0000, v103
    v_add_f32 v8, v8, v16
    v_fmac_f32 v12, v16, v16
    v_add_f32 v9, v9, v17
    v_fmac_f32 v13, v17, v17
    v_add_f32 v10, v10, v18
    v_fmac_f32 v14, v18, v18
    v_add_f32 v11, v11, v19
    v_fmac_f32 v15, v19, v19
    v_add_f32 v8, v8, v20
    v_fmac_f32 v12, v20, v20
    v_add_f32 v9, v9, v21
    v_fmac_f32 v13, v21, v21
    v_add_f32 v10, v10, v22
    v_fmac_f32 v14, v22, v22
    v_add_f32 v11, v11, v23
    v_fmac_f32 v15, v23, v23
    buffer_load_dwordx4 v130, s[16:19], s29 offen offset:3072 lds
    s_add_u32 m0, s35, 98304
    s_add_u32 s29, s29, 245760
    buffer_load_dwordx4 v123, s[12:15], s28 offen offset:0 lds
    s_waitcnt lgkmcnt(0)
    ds_read_b128 v[100:103], v134 offset:32768
    ds_read_b64_tr_b16 v[80:81], v135 offset:45056
    ds_read_b64_tr_b16 v[82:83], v135 offset:46080
    v_mfma_f32_16x16x32_bf16 v[4:7], v[64:67], v[0:3], v[4:7]
    v_lshlrev_b32 v16, 16, v96
    v_and_b32 v17, 0xffff0000, v96
    v_lshlrev_b32 v18, 16, v97
    v_and_b32 v19, 0xffff0000, v97
    v_lshlrev_b32 v20, 16, v98
    v_and_b32 v21, 0xffff0000, v98
    v_lshlrev_b32 v22, 16, v99
    v_and_b32 v23, 0xffff0000, v99
    v_add_f32 v8, v8, v16
    v_fmac_f32 v12, v16, v16
    v_add_f32 v9, v9, v17
    v_fmac_f32 v13, v17, v17
    v_add_f32 v10, v10, v18
    v_fmac_f32 v14, v18, v18
    v_add_f32 v11, v11, v19
    v_fmac_f32 v15, v19, v19
    v_add_f32 v8, v8, v20
    v_fmac_f32 v12, v20, v20
    v_add_f32 v9, v9, v21
    v_fmac_f32 v13, v21, v21
    v_add_f32 v10, v10, v22
    v_fmac_f32 v14, v22, v22
    v_add_f32 v11, v11, v23
    v_fmac_f32 v15, v23, v23
    buffer_load_dwordx4 v124, s[12:15], s28 offen offset:1024 lds
    buffer_load_dwordx4 v125, s[12:15], s28 offen offset:2048 lds
    buffer_load_dwordx4 v126, s[12:15], s28 offen offset:3072 lds
    s_add_u32 s28, s28, 128
    s_add_u32 s36, s36, 1
    s_cmp_eq_u32 s36, 10
    s_cselect_b32 s37, 2457600, 0
    s_cselect_b32 s38, 1280, 0
    s_sub_u32 s29, s29, s37
    s_sub_u32 s28, s28, s38
    s_waitcnt vmcnt(8) lgkmcnt(0)
    s_barrier
    v_mfma_f32_16x16x32_bf16 v[4:7], v[80:83], v[0:3], v[4:7]
    v_lshlrev_b32 v16, 16, v100
    v_and_b32 v17, 0xffff0000, v100
    v_lshlrev_b32 v18, 16, v101
    v_and_b32 v19, 0xffff0000, v101
    v_lshlrev_b32 v20, 16, v102
    v_and_b32 v21, 0xffff0000, v102
    v_lshlrev_b32 v22, 16, v103
    v_and_b32 v23, 0xffff0000, v103
    v_add_f32 v8, v8, v16
    v_fmac_f32 v12, v16, v16
    v_add_f32 v9, v9, v17
    v_fmac_f32 v13, v17, v17
    v_add_f32 v10, v10, v18
    v_fmac_f32 v14, v18, v18
    v_add_f32 v11, v11, v19
    v_fmac_f32 v15, v19, v19
    v_add_f32 v8, v8, v20
    v_fmac_f32 v12, v20, v20
    v_add_f32 v9, v9, v21
    v_fmac_f32 v13, v21, v21
    v_add_f32 v10, v10, v22
    v_fmac_f32 v14, v22, v22
    v_add_f32 v11, v11, v23
    v_fmac_f32 v15, v23, v23
    s_add_u32 m0, s35, 16384
    s_nop 0
    buffer_load_dwordx4 v127, s[16:19], s29 offen offset:0 lds
    buffer_load_dwordx4 v128, s[16:19], s29 offen offset:1024 lds
    buffer_load_dwordx4 v129, s[16:19], s29 offen offset:2048 lds
    buffer_load_dwordx4 v130, s[16:19], s29 offen offset:3072 lds
    s_add_u32 m0, s35, 0
    s_add_u32 s29, s29, 245760
    buffer_load_dwordx4 v123, s[12:15], s28 offen offset:0 lds
    buffer_load_dwordx4 v124, s[12:15], s28 offen offset:1024 lds
    buffer_load_dwordx4 v125, s[12:15], s28 offen offset:2048 lds
    buffer_load_dwordx4 v126, s[12:15], s28 offen offset:3072 lds
    s_add_u32 s28, s28, 128
    s_add_u32 s36, s36, 1
    s_cmp_eq_u32 s36, 10
    s_cselect_b32 s37, 2457600, 0
    s_cselect_b32 s38, 1280, 0
    s_sub_u32 s29, s29, s37
    s_sub_u32 s28, s28, s38
    s_add_u32 m0, s35, 49152
    s_nop 0
    buffer_load_dwordx4 v127, s[16:19], s29 offen offset:0 lds
    buffer_load_dwordx4 v128, s[16:19], s29 offen offset:1024 lds
    buffer_load_dwordx4 v129, s[16:19], s29 offen offset:2048 lds
    buffer_load_dwordx4 v130, s[16:19], s29 offen offset:3072 lds
    s_add_u32 m0, s35, 32768
    s_add_u32 s29, s29, 245760
    buffer_load_dwordx4 v123, s[12:15], s28 offen offset:0 lds
    buffer_load_dwordx4 v124, s[12:15], s28 offen offset:1024 lds
    buffer_load_dwordx4 v125, s[12:15], s28 offen offset:2048 lds
    buffer_load_dwordx4 v126, s[12:15], s28 offen offset:3072 lds
    s_add_u32 s28, s28, 128
    s_add_u32 s36, s36, 1
    s_cmp_eq_u32 s36, 10
    s_cselect_b32 s37, 2457600, 0
    s_cselect_b32 s38, 1280, 0
    s_sub_u32 s29, s29, s37
    s_sub_u32 s28, s28, s38
    v_readfirstlane_b32 s90, v253
    s_nop 0
    s_mul_i32 s90, s90, 0x9e3779b1
    s_add_u32 s90, s90, 0x7f4a7c15
    v_add_f32 v8, v8, v9
    v_add_f32 v10, v10, v11
    v_add_f32 v12, v12, v13
    v_add_f32 v14, v14, v15
    v_add_f32 v24, v8, v10
    v_add_f32 v26, v12, v14
    v_mov_b32 v144, v24
    v_mov_b32 v145, v26
    v_mov_b32 v25, s90
    v_mov_b32 v27, s90
    v_mov_b32 v29, s90
    v_mov_b32 v31, s90
    v_mov_b32 v33, s90
    v_mov_b32 v35, s90
    v_permlane32_swap_b32 v24, v144
    v_permlane32_swap_b32 v26, v145
    v_add_f32 v24, v24, v144
    v_add_f32 v26, v26, v145
    v_mov_b32 v28, v4
    v_mov_b32 v30, v5
    v_mov_b32 v32, v6
    v_mov_b32 v34, v7
    s_lshl_b32 s41, s34, 12
    s_lshl_b32 s42, s3, 10
    s_add_u32 s42, s42, 0x1500000
    s_add_u32 s41, s41, s42
    v_lshlrev_b32 v146, 4, v252
    v_and_b32 v147, 48, v252
    v_and_b32 v148, 1, v252
    v_lshl_add_u32 v147, v148, 6, v147
    s_mov_b32 exec_lo, -1
    s_mov_b32 exec_hi, 0
    buffer_store_dwordx4 v[24:27], v146, s[4:7], s41 offen sc1
    s_mov_b32 s44, 0x00030003
    s_mov_b32 s45, 0x00030003
    s_mov_b64 exec, s[44:45]
    buffer_store_dwordx4 v[28:31], v147, s[4:7], s41 offen offset:512 sc1
    buffer_store_dwordx4 v[32:35], v147, s[4:7], s41 offen offset:640 sc1
    s_mov_b64 exec, -1
    s_setprio 0
    s_mul_i32 s43, s27, 80
    s_add_u32 s43, s43, s25
    s_mul_i32 s44, s25, 52
    s_lshr_b32 s44, s44, 8
    s_mul_i32 s44, s44, 5
    s_min_u32 s44, s44, 11
    s_lshl_b32 s45, s40, 4
    s_add_u32 s44, s44, s45
    v_cmp_gt_u32 vcc, 32, v252
    v_mov_b32 v144, s43
    v_mov_b32 v145, s44
    v_min_u32 v146, 47, v252
    v_cndmask_b32 v144, v145, v144, vcc
    v_lshlrev_b32 v146, 4, v146
    v_lshl_add_u32 v52, v144, 12, v146
    v_mov_b32 v144, 0x10000
    v_mov_b32 v145, 0x1000
    v_cndmask_b32 v53, v145, v144, vcc
    v_add_u32 v54, v52, v53
    v_add_u32 v55, v54, v53
    v_add_u32 v56, v55, v53
    v_add_u32 v57, v56, v53
    s_waitcnt vmcnt(19) lgkmcnt(0)
    s_barrier
    s_add_u32 m0, s35, 81920
    s_nop 0
    buffer_load_dwordx4 v127, s[16:19], s29 offen offset:0 lds
    buffer_load_dwordx4 v128, s[16:19], s29 offen offset:1024 lds
    buffer_load_dwordx4 v129, s[16:19], s29 offen offset:2048 lds
    buffer_load_dwordx4 v130, s[16:19], s29 offen offset:3072 lds
    s_add_u32 m0, s35, 65536
    s_add_u32 s29, s29, 245760
    buffer_load_dwordx4 v123, s[12:15], s28 offen offset:0 lds
    buffer_load_dwordx4 v124, s[12:15], s28 offen offset:1024 lds
    buffer_load_dwordx4 v125, s[12:15], s28 offen offset:2048 lds
    buffer_load_dwordx4 v126, s[12:15], s28 offen offset:3072 lds
    s_add_u32 s28, s28, 128
    s_add_u32 s36, s36, 1
    s_cmp_eq_u32 s36, 10
    s_cselect_b32 s37, 2457600, 0
    s_cselect_b32 s38, 1280, 0
    s_sub_u32 s29, s29, s37
    s_sub_u32 s28, s28, s38
    s_waitcnt vmcnt(19) lgkmcnt(0)
    s_barrier
    s_add_u32 m0, s35, 114688
    s_nop 0
    buffer_load_dwordx4 v127, s[16:19], s29 offen offset:0 lds
    buffer_load_dwordx4 v128, s[16:19], s29 offen offset:1024 lds
    buffer_load_dwordx4 v129, s[16:19], s29 offen offset:2048 lds
    buffer_load_dwordx4 v130, s[16:19], s29 offen offset:3072 lds
    s_add_u32 m0, s35, 98304
    s_add_u32 s29, s29, 245760
    buffer_load_dwordx4 v123, s[12:15], s28 offen offset:0 lds
    buffer_load_dwordx4 v124, s[12:15], s28 offen offset:1024 lds
    buffer_load_dwordx4 v125, s[12:15], s28 offen offset:2048 lds
    buffer_load_dwordx4 v126, s[12:15], s28 offen offset:3072 lds
    s_add_u32 s28, s28, 128
    s_add_u32 s36, s36, 1
    s_cmp_eq_u32 s36, 10
    s_cselect_b32 s37, 2457600, 0
    s_cselect_b32 s38, 1280, 0
    s_sub_u32 s29, s29, s37
    s_sub_u32 s28, s28, s38
    s_waitcnt vmcnt(16) lgkmcnt(0)
    s_barrier
    s_add_u32 m0, s35, 16384
    s_nop 0
    buffer_load_dwordx4 v127, s[16:19], s29 offen offset:0 lds
    buffer_load_dwordx4 v128, s[16:19], s29 offen offset:1024 lds
    buffer_load_dwordx4 v129, s[16:19], s29 offen offset:2048 lds
    buffer_load_dwordx4 v130, s[16:19], s29 offen offset:3072 lds
    s_add_u32 m0, s35, 0
    s_add_u32 s29, s29, 245760
    buffer_load_dwordx4 v123, s[12:15], s28 offen offset:0 lds
    buffer_load_dwordx4 v124, s[12:15], s28 offen offset:1024 lds
    buffer_load_dwordx4 v125, s[12:15], s28 offen offset:2048 lds
    buffer_load_dwordx4 v126, s[12:15], s28 offen offset:3072 lds
    s_add_u32 s28, s28, 128
    s_add_u32 s36, s36, 1
    s_cmp_eq_u32 s36, 10
    s_cselect_b32 s37, 2457600, 0
    s_cselect_b32 s38, 1280, 0
    s_sub_u32 s29, s29, s37
    s_sub_u32 s28, s28, s38
    buffer_load_dwordx4 v[32:35], v52, s[4:7], s42 offen sc1
    buffer_load_dwordx4 v[36:39], v54, s[4:7], s42 offen sc1
    buffer_load_dwordx4 v[40:43], v55, s[4:7], s42 offen sc1
    buffer_load_dwordx4 v[44:47], v56, s[4:7], s42 offen sc1
    buffer_load_dwordx4 v[48:51], v57, s[4:7], s42 offen sc1
    s_waitcnt vmcnt(21) lgkmcnt(0)
    s_barrier
    s_add_u32 m0, s35, 49152
    s_nop 0
    buffer_load_dwordx4 v127, s[16:19], s29 offen offset:0 lds
    buffer_load_dwordx4 v128, s[16:19], s29 offen offset:1024 lds
    buffer_load_dwordx4 v129, s[16:19], s29 offen offset:2048 lds
    buffer_load_dwordx4 v130, s[16:19], s29 offen offset:3072 lds
    s_add_u32 m0, s35, 32768
    s_add_u32 s29, s29, 245760
    buffer_load_dwordx4 v123, s[12:15], s28 offen offset:0 lds
    buffer_load_dwordx4 v124, s[12:15], s28 offen offset:1024 lds
    buffer_load_dwordx4 v125, s[12:15], s28 offen offset:2048 lds
    buffer_load_dwordx4 v126, s[12:15], s28 offen offset:3072 lds
    s_add_u32 s28, s28, 128
    s_add_u32 s36, s36, 1
    s_cmp_eq_u32 s36, 10
    s_cselect_b32 s37, 2457600, 0
    s_cselect_b32 s38, 1280, 0
    s_sub_u32 s29, s29, s37
    s_sub_u32 s28, s28, s38
    s_waitcnt vmcnt(21) lgkmcnt(0)
    s_barrier
    s_waitcnt vmcnt(8) lgkmcnt(0)
    s_barrier
    s_mov_b32 s61, 0x40000
L_q0_chk:
    v_xor_b32 v33, s90, v33
    v_xor_b32 v35, s90, v35
    v_xor_b32 v37, s90, v37
    v_xor_b32 v39, s90, v39
    v_xor_b32 v41, s90, v41
    v_xor_b32 v43, s90, v43
    v_xor_b32 v45, s90, v45
    v_xor_b32 v47, s90, v47
    v_xor_b32 v49, s90, v49
    v_xor_b32 v51, s90, v51
    v_or3_b32 v33, v33, v35, v37
    v_or3_b32 v33, v33, v39, v41
    v_or3_b32 v33, v33, v43, v45
    v_or3_b32 v33, v33, v47, v49
    v_or_b32 v33, v33, v51
    v_cmp_ne_u32 vcc, 0, v33
    s_cbranch_vccz L_q0_ok
    s_sub_u32 s61, s61, 1
    s_cbranch_scc1 L_q0_ok
    buffer_load_dwordx4 v[32:35], v52, s[4:7], s42 offen sc1
    buffer_load_dwordx4 v[36:39], v54, s[4:7], s42 offen sc1
    buffer_load_dwordx4 v[40:43], v55, s[4:7], s42 offen sc1
    buffer_load_dwordx4 v[44:47], v56, s[4:7], s42 offen sc1
    buffer_load_dwordx4 v[48:51], v57, s[4:7], s42 offen sc1
    s_waitcnt vmcnt(0)
    s_branch L_q0_chk
L_q0_ok:
    v_add_f32 v32, v32, v36
    v_add_f32 v34, v34, v38
    v_add_f32 v32, v32, v40
    v_add_f32 v34, v34, v42
    v_add_f32 v32, v32, v44
    v_add_f32 v34, v34, v46
    v_add_f32 v32, v32, v48
    v_add_f32 v34, v34, v50
    v_mov_b32 v33, v34
    v_and_b32 v146, 7, v252
    v_and_b32 v147, 8, v252
    v_lshl_add_u32 v147, v146, 4, v147
    s_lshl_b32 s31, s3, 7
    v_add_u32 v147, s31, v147
    v_add_u32 v149, 131072, v147
    s_mov_b32 s44, 0
    s_mov_b32 s45, 0xffff
    s_mov_b64 exec, s[44:45]
    ds_write_b64 v149, v[32:33] offset:2048
    s_cmp_lg_u32 s25, 0
    s_cbranch_scc1 L_q0_ncs
    s_lshl_b32 s30, s40, 9
    s_add_u32 s30, s30, 0x68000
    buffer_store_dwordx2 v[32:33], v147, s[4:7], s30 offen sc1
L_q0_ncs:
    s_mov_b32 exec_lo, -1
    s_mov_b32 exec_hi, 0
    s_lshl_b32 s30, s3, 8
    s_add_u32 s30, s30, 131072
    v_lshl_add_u32 v148, v122, 2, s30
    v_mul_f32 v32, 0xbacccccd, v32
    s_mov_b32 s31, 0x3acccccd
    v_mul_f32 v144, v32, v32
    v_fma_f32 v33, v33, s31, -v144
    v_max_f32 v33, 0, v33
    v_add_f32 v33, 0x3727c5ac, v33
    v_rsq_f32 v33, v33
    ds_write_b32 v148, v32
    ds_write_b32 v148, v33 offset:128
    s_mov_b64 exec, -1
    s_waitcnt vmcnt(0) lgkmcnt(0)
    s_barrier
    s_branch L_q_sig
L_q0_c:
    v_lshrrev_b32 v121, 5, v252
    v_and_b32 v122, 31, v252
    v_bfe_u32 v144, v252, 1, 3
    v_xor_b32 v144, v144, v121
    v_lshlrev_b32 v144, 4, v144
    v_lshl_add_u32 v144, v122, 7, v144
    v_add_u32 v131, s35, v144
    v_xor_b32 v132, 32, v131
    v_xor_b32 v133, 64, v131
    v_xor_b32 v134, 96, v131
    v_bfe_u32 v144, v252, 2, 2
    v_lshl_add_u32 v145, v121, 3, v144
    v_lshlrev_b32 v145, 8, v145
    v_lshl_add_u32 v145, v144, 6, v145
    v_and_b32 v146, 16, v252
    v_lshl_add_u32 v145, v146, 1, v145
    v_and_b32 v146, 3, v252
    v_lshl_add_u32 v145, v146, 3, v145
    v_add_u32 v135, 16384, v145
    v_xor_b32 v136, 64, v135
    v_xor_b32 v137, 128, v135
    v_xor_b32 v138, 192, v135
    s_cmp_eq_u32 s27, 2
    s_cbranch_scc1 L_q0_v
    s_mov_b32 s36, 163840
    s_cmp_eq_u32 s27, 0
    s_cselect_b32 s36, 81920, s36
    s_cselect_b32 s38, 0, 0x300000
    s_cselect_b32 s39, 0x3ea52b5c, 1.0
    s_cselect_b64 vcc, -1, 0
    s_lshr_b32 s37, s36, 6
    s_mul_i32 s37, s37, s32
    s_add_u32 s37, s37, s38
    v_and_b32 v144, 19, v122
    v_and_b32 v145, 4, v122
    v_lshl_or_b32 v144, v145, 1, v144
    v_and_b32 v145, 8, v122
    v_lshrrev_b32 v145, 1, v145
    v_or_b32 v144, v144, v145
    v_cndmask_b32 v144, v122, v144, vcc
    v_lshlrev_b32 v145, 4, v144
    v_lshl_add_u32 v145, v121, 3, v145
    v_lshlrev_b32 v144, 3, v144
    v_mad_u32_u24 v144, v121, s36, v144
    v_add_u32 v144, 1024, v144
    s_mov_b32 s30, 0
    s_lshl_b32 s31, s26, 4
    s_add_u32 s30, s30, s31
    s_add_u32 s31, s30, 0
    s_mul_i32 s41, s31, 205
    s_lshr_b32 s41, s41, 10
    s_mul_i32 s42, s41, 5
    s_sub_u32 s31, s31, s42
    s_mul_i32 s41, s41, s36
    s_lshl_b32 s41, s41, 1
    s_lshl_b32 s42, s31, 9
    s_sub_u32 s43, s36, 1536
    s_cmp_gt_u32 s31, 2
    s_cselect_b32 s43, s43, 0
    s_add_u32 s42, s42, s43
    s_cmp_eq_u32 s31, 2
    s_cselect_b32 s42, 0, s42
    s_cselect_b64 vcc, -1, 0
    s_add_u32 s41, s41, s42
    v_cndmask_b32 v146, v145, v144, vcc
    v_add_u32 v104, s41, v146
    s_add_u32 s31, s30, 1
    s_mul_i32 s41, s31, 205
    s_lshr_b32 s41, s41, 10
    s_mul_i32 s42, s41, 5
    s_sub_u32 s31, s31, s42
    s_mul_i32 s41, s41, s36
    s_lshl_b32 s41, s41, 1
    s_lshl_b32 s42, s31, 9
    s_sub_u32 s43, s36, 1536
    s_cmp_gt_u32 s31, 2
    s_cselect_b32 s43, s43, 0
    s_add_u32 s42, s42, s43
    s_cmp_eq_u32 s31, 2
    s_cselect_b32 s42, 0, s42
    s_cselect_b64 vcc, -1, 0
    s_add_u32 s41, s41, s42
    v_cndmask_b32 v146, v145, v144, vcc
    v_add_u32 v105, s41, v146
    s_add_u32 s31, s30, 2
    s_mul_i32 s41, s31, 205
    s_lshr_b32 s41, s41, 10
    s_mul_i32 s42, s41, 5
    s_sub_u32 s31, s31, s42
    s_mul_i32 s41, s41, s36
    s_lshl_b32 s41, s41, 1
    s_lshl_b32 s42, s31, 9
    s_sub_u32 s43, s36, 1536
    s_cmp_gt_u32 s31, 2
    s_cselect_b32 s43, s43, 0
    s_add_u32 s42, s42, s43
    s_cmp_eq_u32 s31, 2
    s_cselect_b32 s42, 0, s42
    s_cselect_b64 vcc, -1, 0
    s_add_u32 s41, s41, s42
    v_cndmask_b32 v146, v145, v144, vcc
    v_add_u32 v106, s41, v146
    s_add_u32 s31, s30, 3
    s_mul_i32 s41, s31, 205
    s_lshr_b32 s41, s41, 10
    s_mul_i32 s42, s41, 5
    s_sub_u32 s31, s31, s42
    s_mul_i32 s41, s41, s36
    s_lshl_b32 s41, s41, 1
    s_lshl_b32 s42, s31, 9
    s_sub_u32 s43, s36, 1536
    s_cmp_gt_u32 s31, 2
    s_cselect_b32 s43, s43, 0
    s_add_u32 s42, s42, s43
    s_cmp_eq_u32 s31, 2
    s_cselect_b32 s42, 0, s42
    s_cselect_b64 vcc, -1, 0
    s_add_u32 s41, s41, s42
    v_cndmask_b32 v146, v145, v144, vcc
    v_add_u32 v107, s41, v146
    s_mov_b32 s30, 4
    s_lshl_b32 s31, s26, 4
    s_add_u32 s30, s30, s31
    s_add_u32 s31, s30, 0
    s_mul_i32 s41, s31, 205
    s_lshr_b32 s41, s41, 10
    s_mul_i32 s42, s41, 5
    s_sub_u32 s31, s31, s42
    s_mul_i32 s41, s41, s36
    s_lshl_b32 s41, s41, 1
    s_lshl_b32 s42, s31, 9
    s_sub_u32 s43, s36, 1536
    s_cmp_gt_u32 s31, 2
    s_cselect_b32 s43, s43, 0
    s_add_u32 s42, s42, s43
    s_cmp_eq_u32 s31, 2
    s_cselect_b32 s42, 0, s42
    s_cselect_b64 vcc, -1, 0
    s_add_u32 s41, s41, s42
    v_cndmask_b32 v146, v145, v144, vcc
    v_add_u32 v108, s41, v146
    s_add_u32 s31, s30, 1
    s_mul_i32 s41, s31, 205
    s_lshr_b32 s41, s41, 10
    s_mul_i32 s42, s41, 5
    s_sub_u32 s31, s31, s42
    s_mul_i32 s41, s41, s36
    s_lshl_b32 s41, s41, 1
    s_lshl_b32 s42, s31, 9
    s_sub_u32 s43, s36, 1536
    s_cmp_gt_u32 s31, 2
    s_cselect_b32 s43, s43, 0
    s_add_u32 s42, s42, s43
    s_cmp_eq_u32 s31, 2
    s_cselect_b32 s42, 0, s42
    s_cselect_b64 vcc, -1, 0
    s_add_u32 s41, s41, s42
    v_cndmask_b32 v146, v145, v144, vcc
    v_add_u32 v109, s41, v146
    s_add_u32 s31, s30, 2
    s_mul_i32 s41, s31, 205
    s_lshr_b32 s41, s41, 10
    s_mul_i32 s42, s41, 5
    s_sub_u32 s31, s31, s42
    s_mul_i32 s41, s41, s36
    s_lshl_b32 s41, s41, 1
    s_lshl_b32 s42, s31, 9
    s_sub_u32 s43, s36, 1536
    s_cmp_gt_u32 s31, 2
    s_cselect_b32 s43, s43, 0
    s_add_u32 s42, s42, s43
    s_cmp_eq_u32 s31, 2
    s_cselect_b32 s42, 0, s42
    s_cselect_b64 vcc, -1, 0
    s_add_u32 s41, s41, s42
    v_cndmask_b32 v146, v145, v144, vcc
    v_add_u32 v110, s41, v146
    s_add_u32 s31, s30, 3
    s_mul_i32 s41, s31, 205
    s_lshr_b32 s41, s41, 10
    s_mul_i32 s42, s41, 5
    s_sub_u32 s31, s31, s42
    s_mul_i32 s41, s41, s36
    s_lshl_b32 s41, s41, 1
    s_lshl_b32 s42, s31, 9
    s_sub_u32 s43, s36, 1536
    s_cmp_gt_u32 s31, 2
    s_cselect_b32 s43, s43, 0
    s_add_u32 s42, s42, s43
    s_cmp_eq_u32 s31, 2
    s_cselect_b32 s42, 0, s42
    s_cselect_b64 vcc, -1, 0
    s_add_u32 s41, s41, s42
    v_cndmask_b32 v146, v145, v144, vcc
    v_add_u32 v111, s41, v146
    s_mov_b32 s30, 8
    s_lshl_b32 s31, s26, 4
    s_add_u32 s30, s30, s31
    s_add_u32 s31, s30, 0
    s_mul_i32 s41, s31, 205
    s_lshr_b32 s41, s41, 10
    s_mul_i32 s42, s41, 5
    s_sub_u32 s31, s31, s42
    s_mul_i32 s41, s41, s36
    s_lshl_b32 s41, s41, 1
    s_lshl_b32 s42, s31, 9
    s_sub_u32 s43, s36, 1536
    s_cmp_gt_u32 s31, 2
    s_cselect_b32 s43, s43, 0
    s_add_u32 s42, s42, s43
    s_cmp_eq_u32 s31, 2
    s_cselect_b32 s42, 0, s42
    s_cselect_b64 vcc, -1, 0
    s_add_u32 s41, s41, s42
    v_cndmask_b32 v146, v145, v144, vcc
    v_add_u32 v112, s41, v146
    s_add_u32 s31, s30, 1
    s_mul_i32 s41, s31, 205
    s_lshr_b32 s41, s41, 10
    s_mul_i32 s42, s41, 5
    s_sub_u32 s31, s31, s42
    s_mul_i32 s41, s41, s36
    s_lshl_b32 s41, s41, 1
    s_lshl_b32 s42, s31, 9
    s_sub_u32 s43, s36, 1536
    s_cmp_gt_u32 s31, 2
    s_cselect_b32 s43, s43, 0
    s_add_u32 s42, s42, s43
    s_cmp_eq_u32 s31, 2
    s_cselect_b32 s42, 0, s42
    s_cselect_b64 vcc, -1, 0
    s_add_u32 s41, s41, s42
    v_cndmask_b32 v146, v145, v144, vcc
    v_add_u32 v113, s41, v146
    s_add_u32 s31, s30, 2
    s_mul_i32 s41, s31, 205
    s_lshr_b32 s41, s41, 10
    s_mul_i32 s42, s41, 5
    s_sub_u32 s31, s31, s42
    s_mul_i32 s41, s41, s36
    s_lshl_b32 s41, s41, 1
    s_lshl_b32 s42, s31, 9
    s_sub_u32 s43, s36, 1536
    s_cmp_gt_u32 s31, 2
    s_cselect_b32 s43, s43, 0
    s_add_u32 s42, s42, s43
    s_cmp_eq_u32 s31, 2
    s_cselect_b32 s42, 0, s42
    s_cselect_b64 vcc, -1, 0
    s_add_u32 s41, s41, s42
    v_cndmask_b32 v146, v145, v144, vcc
    v_add_u32 v114, s41, v146
    s_add_u32 s31, s30, 3
    s_mul_i32 s41, s31, 205
    s_lshr_b32 s41, s41, 10
    s_mul_i32 s42, s41, 5
    s_sub_u32 s31, s31, s42
    s_mul_i32 s41, s41, s36
    s_lshl_b32 s41, s41, 1
    s_lshl_b32 s42, s31, 9
    s_sub_u32 s43, s36, 1536
    s_cmp_gt_u32 s31, 2
    s_cselect_b32 s43, s43, 0
    s_add_u32 s42, s42, s43
    s_cmp_eq_u32 s31, 2
    s_cselect_b32 s42, 0, s42
    s_cselect_b64 vcc, -1, 0
    s_add_u32 s41, s41, s42
    v_cndmask_b32 v146, v145, v144, vcc
    v_add_u32 v115, s41, v146
    s_mov_b32 s30, 12
    s_lshl_b32 s31, s26, 4
    s_add_u32 s30, s30, s31
    s_add_u32 s31, s30, 0
    s_mul_i32 s41, s31, 205
    s_lshr_b32 s41, s41, 10
    s_mul_i32 s42, s41, 5
    s_sub_u32 s31, s31, s42
    s_mul_i32 s41, s41, s36
    s_lshl_b32 s41, s41, 1
    s_lshl_b32 s42, s31, 9
    s_sub_u32 s43, s36, 1536
    s_cmp_gt_u32 s31, 2
    s_cselect_b32 s43, s43, 0
    s_add_u32 s42, s42, s43
    s_cmp_eq_u32 s31, 2
    s_cselect_b32 s42, 0, s42
    s_cselect_b64 vcc, -1, 0
    s_add_u32 s41, s41, s42
    v_cndmask_b32 v146, v145, v144, vcc
    v_add_u32 v116, s41, v146
    s_add_u32 s31, s30, 1
    s_mul_i32 s41, s31, 205
    s_lshr_b32 s41, s41, 10
    s_mul_i32 s42, s41, 5
    s_sub_u32 s31, s31, s42
    s_mul_i32 s41, s41, s36
    s_lshl_b32 s41, s41, 1
    s_lshl_b32 s42, s31, 9
    s_sub_u32 s43, s36, 1536
    s_cmp_gt_u32 s31, 2
    s_cselect_b32 s43, s43, 0
    s_add_u32 s42, s42, s43
    s_cmp_eq_u32 s31, 2
    s_cselect_b32 s42, 0, s42
    s_cselect_b64 vcc, -1, 0
    s_add_u32 s41, s41, s42
    v_cndmask_b32 v146, v145, v144, vcc
    v_add_u32 v117, s41, v146
    s_add_u32 s31, s30, 2
    s_mul_i32 s41, s31, 205
    s_lshr_b32 s41, s41, 10
    s_mul_i32 s42, s41, 5
    s_sub_u32 s31, s31, s42
    s_mul_i32 s41, s41, s36
    s_lshl_b32 s41, s41, 1
    s_lshl_b32 s42, s31, 9
    s_sub_u32 s43, s36, 1536
    s_cmp_gt_u32 s31, 2
    s_cselect_b32 s43, s43, 0
    s_add_u32 s42, s42, s43
    s_cmp_eq_u32 s31, 2
    s_cselect_b32 s42, 0, s42
    s_cselect_b64 vcc, -1, 0
    s_add_u32 s41, s41, s42
    v_cndmask_b32 v146, v145, v144, vcc
    v_add_u32 v118, s41, v146
    s_add_u32 s31, s30, 3
    s_mul_i32 s41, s31, 205
    s_lshr_b32 s41, s41, 10
    s_mul_i32 s42, s41, 5
    s_sub_u32 s31, s31, s42
    s_mul_i32 s41, s41, s36
    s_lshl_b32 s41, s41, 1
    s_lshl_b32 s42, s31, 9
    s_sub_u32 s43, s36, 1536
    s_cmp_gt_u32 s31, 2
    s_cselect_b32 s43, s43, 0
    s_add_u32 s42, s42, s43
    s_cmp_eq_u32 s31, 2
    s_cselect_b32 s42, 0, s42
    s_cselect_b64 vcc, -1, 0
    s_add_u32 s41, s41, s42
    v_cndmask_b32 v146, v145, v144, vcc
    v_add_u32 v119, s41, v146
    s_barrier
    ds_read_b128 v[96:99], v131 offset:0
    ds_read_b64_tr_b16 v[64:65], v135 offset:0
    ds_read_b64_tr_b16 v[66:67], v135 offset:1024
    ds_read_b64_tr_b16 v[68:69], v136 offset:0
    ds_read_b64_tr_b16 v[70:71], v136 offset:1024
    ds_read_b64_tr_b16 v[72:73], v137 offset:0
    ds_read_b64_tr_b16 v[74:75], v137 offset:1024
    ds_read_b64_tr_b16 v[76:77], v138 offset:0
    ds_read_b64_tr_b16 v[78:79], v138 offset:1024
    s_waitcnt lgkmcnt(0)
    v_mfma_f32_32x32x16_bf16 v[0:15], v[64:67], v[96:99], 0
    ds_read_b128 v[100:103], v132 offset:0
    ds_read_b64_tr_b16 v[80:81], v135 offset:4096
    ds_read_b64_tr_b16 v[82:83], v135 offset:5120
    v_mfma_f32_32x32x16_bf16 v[16:31], v[68:71], v[96:99], 0
    ds_read_b64_tr_b16 v[84:85], v136 offset:4096
    ds_read_b64_tr_b16 v[86:87], v136 offset:5120
    ds_read_b64_tr_b16 v[88:89], v137 offset:4096
    v_mfma_f32_32x32x16_bf16 v[32:47], v[72:75], v[96:99], 0
    ds_read_b64_tr_b16 v[90:91], v137 offset:5120
    ds_read_b64_tr_b16 v[92:93], v138 offset:4096
    ds_read_b64_tr_b16 v[94:95], v138 offset:5120
    v_mfma_f32_32x32x16_bf16 v[48:63], v[76:79], v[96:99], 0
    s_waitcnt lgkmcnt(0)
    v_mfma_f32_32x32x16_bf16 v[0:15], v[80:83], v[100:103], v[0:15]
    ds_read_b128 v[96:99], v133 offset:0
    ds_read_b64_tr_b16 v[64:65], v135 offset:8192
    ds_read_b64_tr_b16 v[66:67], v135 offset:9216
    v_mfma_f32_32x32x16_bf16 v[16:31], v[84:87], v[100:103], v[16:31]
    ds_read_b64_tr_b16 v[68:69], v136 offset:8192
    ds_read_b64_tr_b16 v[70:71], v136 offset:9216
    ds_read_b64_tr_b16 v[72:73], v137 offset:8192
    v_mfma_f32_32x32x16_bf16 v[32:47], v[88:91], v[100:103], v[32:47]
    ds_read_b64_tr_b16 v[74:75], v137 offset:9216
    ds_read_b64_tr_b16 v[76:77], v138 offset:8192
    ds_read_b64_tr_b16 v[78:79], v138 offset:9216
    v_mfma_f32_32x32x16_bf16 v[48:63], v[92:95], v[100:103], v[48:63]
    s_waitcnt lgkmcnt(0)
    v_mfma_f32_32x32x16_bf16 v[0:15], v[64:67], v[96:99], v[0:15]
    ds_read_b128 v[100:103], v134 offset:0
    ds_read_b64_tr_b16 v[80:81], v135 offset:12288
    ds_read_b64_tr_b16 v[82:83], v135 offset:13312
    v_mfma_f32_32x32x16_bf16 v[16:31], v[68:71], v[96:99], v[16:31]
    ds_read_b64_tr_b16 v[84:85], v136 offset:12288
    ds_read_b64_tr_b16 v[86:87], v136 offset:13312
    ds_read_b64_tr_b16 v[88:89], v137 offset:12288
    v_mfma_f32_32x32x16_bf16 v[32:47], v[72:75], v[96:99], v[32:47]
    ds_read_b64_tr_b16 v[90:91], v137 offset:13312
    ds_read_b64_tr_b16 v[92:93], v138 offset:12288
    ds_read_b64_tr_b16 v[94:95], v138 offset:13312
    v_mfma_f32_32x32x16_bf16 v[48:63], v[76:79], v[96:99], v[48:63]
    s_waitcnt lgkmcnt(0)
    s_barrier
    v_mfma_f32_32x32x16_bf16 v[0:15], v[80:83], v[100:103], v[0:15]
    ds_read_b128 v[96:99], v131 offset:32768
    ds_read_b64_tr_b16 v[64:65], v135 offset:32768
    ds_read_b64_tr_b16 v[66:67], v135 offset:33792
    v_mfma_f32_32x32x16_bf16 v[16:31], v[84:87], v[100:103], v[16:31]
    ds_read_b64_tr_b16 v[68:69], v136 offset:32768
    ds_read_b64_tr_b16 v[70:71], v136 offset:33792
    ds_read_b64_tr_b16 v[72:73], v137 offset:32768
    v_mfma_f32_32x32x16_bf16 v[32:47], v[88:91], v[100:103], v[32:47]
    ds_read_b64_tr_b16 v[74:75], v137 offset:33792
    ds_read_b64_tr_b16 v[76:77], v138 offset:32768
    ds_read_b64_tr_b16 v[78:79], v138 offset:33792
    v_mfma_f32_32x32x16_bf16 v[48:63], v[92:95], v[100:103], v[48:63]
    s_waitcnt lgkmcnt(0)
    v_mfma_f32_32x32x16_bf16 v[0:15], v[64:67], v[96:99], v[0:15]
    ds_read_b128 v[100:103], v132 offset:32768
    ds_read_b64_tr_b16 v[80:81], v135 offset:36864
    ds_read_b64_tr_b16 v[82:83], v135 offset:37888
    v_mfma_f32_32x32x16_bf16 v[16:31], v[68:71], v[96:99], v[16:31]
    ds_read_b64_tr_b16 v[84:85], v136 offset:36864
    ds_read_b64_tr_b16 v[86:87], v136 offset:37888
    ds_read_b64_tr_b16 v[88:89], v137 offset:36864
    v_mfma_f32_32x32x16_bf16 v[32:47], v[72:75], v[96:99], v[32:47]
    ds_read_b64_tr_b16 v[90:91], v137 offset:37888
    ds_read_b64_tr_b16 v[92:93], v138 offset:36864
    ds_read_b64_tr_b16 v[94:95], v138 offset:37888
    v_mfma_f32_32x32x16_bf16 v[48:63], v[76:79], v[96:99], v[48:63]
    s_waitcnt lgkmcnt(0)
    v_mfma_f32_32x32x16_bf16 v[0:15], v[80:83], v[100:103], v[0:15]
    ds_read_b128 v[96:99], v133 offset:32768
    ds_read_b64_tr_b16 v[64:65], v135 offset:40960
    ds_read_b64_tr_b16 v[66:67], v135 offset:41984
    v_mfma_f32_32x32x16_bf16 v[16:31], v[84:87], v[100:103], v[16:31]
    ds_read_b64_tr_b16 v[68:69], v136 offset:40960
    ds_read_b64_tr_b16 v[70:71], v136 offset:41984
    ds_read_b64_tr_b16 v[72:73], v137 offset:40960
    v_mfma_f32_32x32x16_bf16 v[32:47], v[88:91], v[100:103], v[32:47]
    ds_read_b64_tr_b16 v[74:75], v137 offset:41984
    ds_read_b64_tr_b16 v[76:77], v138 offset:40960
    ds_read_b64_tr_b16 v[78:79], v138 offset:41984
    v_mfma_f32_32x32x16_bf16 v[48:63], v[92:95], v[100:103], v[48:63]
    s_waitcnt lgkmcnt(0)
    v_mfma_f32_32x32x16_bf16 v[0:15], v[64:67], v[96:99], v[0:15]
    ds_read_b128 v[100:103], v134 offset:32768
    ds_read_b64_tr_b16 v[80:81], v135 offset:45056
    ds_read_b64_tr_b16 v[82:83], v135 offset:46080
    v_mfma_f32_32x32x16_bf16 v[16:31], v[68:71], v[96:99], v[16:31]
    ds_read_b64_tr_b16 v[84:85], v136 offset:45056
    ds_read_b64_tr_b16 v[86:87], v136 offset:46080
    ds_read_b64_tr_b16 v[88:89], v137 offset:45056
    v_mfma_f32_32x32x16_bf16 v[32:47], v[72:75], v[96:99], v[32:47]
    ds_read_b64_tr_b16 v[90:91], v137 offset:46080
    ds_read_b64_tr_b16 v[92:93], v138 offset:45056
    ds_read_b64_tr_b16 v[94:95], v138 offset:46080
    v_mfma_f32_32x32x16_bf16 v[48:63], v[76:79], v[96:99], v[48:63]
    s_waitcnt lgkmcnt(0)
    s_barrier
    v_mfma_f32_32x32x16_bf16 v[0:15], v[80:83], v[100:103], v[0:15]
    v_xor_b32 v131, 0x10000, v131
    v_xor_b32 v132, 0x10000, v132
    v_xor_b32 v133, 0x10000, v133
    v_xor_b32 v134, 0x10000, v134
    v_xor_b32 v135, 0x10000, v135
    v_xor_b32 v136, 0x10000, v136
    v_xor_b32 v137, 0x10000, v137
    v_xor_b32 v138, 0x10000, v138
    ds_read_b128 v[96:99], v131 offset:0
    ds_read_b64_tr_b16 v[64:65], v135 offset:0
    ds_read_b64_tr_b16 v[66:67], v135 offset:1024
    v_mfma_f32_32x32x16_bf16 v[16:31], v[84:87], v[100:103], v[16:31]
    ds_read_b64_tr_b16 v[68:69], v136 offset:0
    ds_read_b64_tr_b16 v[70:71], v136 offset:1024
    ds_read_b64_tr_b16 v[72:73], v137 offset:0
    v_mfma_f32_32x32x16_bf16 v[32:47], v[88:91], v[100:103], v[32:47]
    ds_read_b64_tr_b16 v[74:75], v137 offset:1024
    ds_read_b64_tr_b16 v[76:77], v138 offset:0
    ds_read_b64_tr_b16 v[78:79], v138 offset:1024
    v_mfma_f32_32x32x16_bf16 v[48:63], v[92:95], v[100:103], v[48:63]
    s_waitcnt lgkmcnt(0)
    v_mfma_f32_32x32x16_bf16 v[0:15], v[64:67], v[96:99], v[0:15]
    ds_read_b128 v[100:103], v132 offset:0
    ds_read_b64_tr_b16 v[80:81], v135 offset:4096
    ds_read_b64_tr_b16 v[82:83], v135 offset:5120
    v_mfma_f32_32x32x16_bf16 v[16:31], v[68:71], v[96:99], v[16:31]
    ds_read_b64_tr_b16 v[84:85], v136 offset:4096
    ds_read_b64_tr_b16 v[86:87], v136 offset:5120
    ds_read_b64_tr_b16 v[88:89], v137 offset:4096
    v_mfma_f32_32x32x16_bf16 v[32:47], v[72:75], v[96:99], v[32:47]
    ds_read_b64_tr_b16 v[90:91], v137 offset:5120
    ds_read_b64_tr_b16 v[92:93], v138 offset:4096
    ds_read_b64_tr_b16 v[94:95], v138 offset:5120
    v_mfma_f32_32x32x16_bf16 v[48:63], v[76:79], v[96:99], v[48:63]
    s_waitcnt lgkmcnt(0)
    v_mfma_f32_32x32x16_bf16 v[0:15], v[80:83], v[100:103], v[0:15]
    ds_read_b128 v[96:99], v133 offset:0
    ds_read_b64_tr_b16 v[64:65], v135 offset:8192
    ds_read_b64_tr_b16 v[66:67], v135 offset:9216
    v_mfma_f32_32x32x16_bf16 v[16:31], v[84:87], v[100:103], v[16:31]
    ds_read_b64_tr_b16 v[68:69], v136 offset:8192
    ds_read_b64_tr_b16 v[70:71], v136 offset:9216
    ds_read_b64_tr_b16 v[72:73], v137 offset:8192
    v_mfma_f32_32x32x16_bf16 v[32:47], v[88:91], v[100:103], v[32:47]
    ds_read_b64_tr_b16 v[74:75], v137 offset:9216
    ds_read_b64_tr_b16 v[76:77], v138 offset:8192
    ds_read_b64_tr_b16 v[78:79], v138 offset:9216
    v_mfma_f32_32x32x16_bf16 v[48:63], v[92:95], v[100:103], v[48:63]
    s_waitcnt lgkmcnt(0)
    v_mfma_f32_32x32x16_bf16 v[0:15], v[64:67], v[96:99], v[0:15]
    ds_read_b128 v[100:103], v134 offset:0
    ds_read_b64_tr_b16 v[80:81], v135 offset:12288
    ds_read_b64_tr_b16 v[82:83], v135 offset:13312
    v_mfma_f32_32x32x16_bf16 v[16:31], v[68:71], v[96:99], v[16:31]
    ds_read_b64_tr_b16 v[84:85], v136 offset:12288
    ds_read_b64_tr_b16 v[86:87], v136 offset:13312
    ds_read_b64_tr_b16 v[88:89], v137 offset:12288
    v_mfma_f32_32x32x16_bf16 v[32:47], v[72:75], v[96:99], v[32:47]
    ds_read_b64_tr_b16 v[90:91], v137 offset:13312
    ds_read_b64_tr_b16 v[92:93], v138 offset:12288
    ds_read_b64_tr_b16 v[94:95], v138 offset:13312
    v_mfma_f32_32x32x16_bf16 v[48:63], v[76:79], v[96:99], v[48:63]
    s_waitcnt lgkmcnt(0)
    s_barrier
    v_mfma_f32_32x32x16_bf16 v[0:15], v[80:83], v[100:103], v[0:15]
    ds_read_b128 v[96:99], v131 offset:32768
    ds_read_b64_tr_b16 v[64:65], v135 offset:32768
    ds_read_b64_tr_b16 v[66:67], v135 offset:33792
    v_mfma_f32_32x32x16_bf16 v[16:31], v[84:87], v[100:103], v[16:31]
    ds_read_b64_tr_b16 v[68:69], v136 offset:32768
    ds_read_b64_tr_b16 v[70:71], v136 offset:33792
    ds_read_b64_tr_b16 v[72:73], v137 offset:32768
    v_mfma_f32_32x32x16_bf16 v[32:47], v[88:91], v[100:103], v[32:47]
    ds_read_b64_tr_b16 v[74:75], v137 offset:33792
    ds_read_b64_tr_b16 v[76:77], v138 offset:32768
    ds_read_b64_tr_b16 v[78:79], v138 offset:33792
    v_mfma_f32_32x32x16_bf16 v[48:63], v[92:95], v[100:103], v[48:63]
    s_waitcnt lgkmcnt(0)
    v_mfma_f32_32x32x16_bf16 v[0:15], v[64:67], v[96:99], v[0:15]
    ds_read_b128 v[100:103], v132 offset:32768
    ds_read_b64_tr_b16 v[80:81], v135 offset:36864
    ds_read_b64_tr_b16 v[82:83], v135 offset:37888
    v_mfma_f32_32x32x16_bf16 v[16:31], v[68:71], v[96:99], v[16:31]
    ds_read_b64_tr_b16 v[84:85], v136 offset:36864
    ds_read_b64_tr_b16 v[86:87], v136 offset:37888
    ds_read_b64_tr_b16 v[88:89], v137 offset:36864
    v_mfma_f32_32x32x16_bf16 v[32:47], v[72:75], v[96:99], v[32:47]
    ds_read_b64_tr_b16 v[90:91], v137 offset:37888
    ds_read_b64_tr_b16 v[92:93], v138 offset:36864
    ds_read_b64_tr_b16 v[94:95], v138 offset:37888
    v_mfma_f32_32x32x16_bf16 v[48:63], v[76:79], v[96:99], v[48:63]
    s_waitcnt lgkmcnt(0)
    v_mfma_f32_32x32x16_bf16 v[0:15], v[80:83], v[100:103], v[0:15]
    ds_read_b128 v[96:99], v133 offset:32768
    ds_read_b64_tr_b16 v[64:65], v135 offset:40960
    ds_read_b64_tr_b16 v[66:67], v135 offset:41984
    v_mfma_f32_32x32x16_bf16 v[16:31], v[84:87], v[100:103], v[16:31]
    ds_read_b64_tr_b16 v[68:69], v136 offset:40960
    ds_read_b64_tr_b16 v[70:71], v136 offset:41984
    ds_read_b64_tr_b16 v[72:73], v137 offset:40960
    v_mfma_f32_32x32x16_bf16 v[32:47], v[88:91], v[100:103], v[32:47]
    ds_read_b64_tr_b16 v[74:75], v137 offset:41984
    ds_read_b64_tr_b16 v[76:77], v138 offset:40960
    ds_read_b64_tr_b16 v[78:79], v138 offset:41984
    v_mfma_f32_32x32x16_bf16 v[48:63], v[92:95], v[100:103], v[48:63]
    s_waitcnt lgkmcnt(0)
    v_mfma_f32_32x32x16_bf16 v[0:15], v[64:67], v[96:99], v[0:15]
    ds_read_b128 v[100:103], v134 offset:32768
    ds_read_b64_tr_b16 v[80:81], v135 offset:45056
    ds_read_b64_tr_b16 v[82:83], v135 offset:46080
    v_mfma_f32_32x32x16_bf16 v[16:31], v[68:71], v[96:99], v[16:31]
    ds_read_b64_tr_b16 v[84:85], v136 offset:45056
    ds_read_b64_tr_b16 v[86:87], v136 offset:46080
    ds_read_b64_tr_b16 v[88:89], v137 offset:45056
    v_mfma_f32_32x32x16_bf16 v[32:47], v[72:75], v[96:99], v[32:47]
    ds_read_b64_tr_b16 v[90:91], v137 offset:46080
    ds_read_b64_tr_b16 v[92:93], v138 offset:45056
    ds_read_b64_tr_b16 v[94:95], v138 offset:46080
    v_mfma_f32_32x32x16_bf16 v[48:63], v[76:79], v[96:99], v[48:63]
    s_waitcnt lgkmcnt(0)
    s_barrier
    v_mfma_f32_32x32x16_bf16 v[0:15], v[80:83], v[100:103], v[0:15]
    v_xor_b32 v131, 0x10000, v131
    v_xor_b32 v132, 0x10000, v132
    v_xor_b32 v133, 0x10000, v133
    v_xor_b32 v134, 0x10000, v134
    v_xor_b32 v135, 0x10000, v135
    v_xor_b32 v136, 0x10000, v136
    v_xor_b32 v137, 0x10000, v137
    v_xor_b32 v138, 0x10000, v138
    ds_read_b128 v[96:99], v131 offset:0
    ds_read_b64_tr_b16 v[64:65], v135 offset:0
    ds_read_b64_tr_b16 v[66:67], v135 offset:1024
    v_mfma_f32_32x32x16_bf16 v[16:31], v[84:87], v[100:103], v[16:31]
    ds_read_b64_tr_b16 v[68:69], v136 offset:0
    ds_read_b64_tr_b16 v[70:71], v136 offset:1024
    ds_read_b64_tr_b16 v[72:73], v137 offset:0
    v_mfma_f32_32x32x16_bf16 v[32:47], v[88:91], v[100:103], v[32:47]
    ds_read_b64_tr_b16 v[74:75], v137 offset:1024
    ds_read_b64_tr_b16 v[76:77], v138 offset:0
    ds_read_b64_tr_b16 v[78:79], v138 offset:1024
    v_mfma_f32_32x32x16_bf16 v[48:63], v[92:95], v[100:103], v[48:63]
    s_waitcnt lgkmcnt(0)
    v_mfma_f32_32x32x16_bf16 v[0:15], v[64:67], v[96:99], v[0:15]
    ds_read_b128 v[100:103], v132 offset:0
    ds_read_b64_tr_b16 v[80:81], v135 offset:4096
    ds_read_b64_tr_b16 v[82:83], v135 offset:5120
    v_mfma_f32_32x32x16_bf16 v[16:31], v[68:71], v[96:99], v[16:31]
    ds_read_b64_tr_b16 v[84:85], v136 offset:4096
    ds_read_b64_tr_b16 v[86:87], v136 offset:5120
    ds_read_b64_tr_b16 v[88:89], v137 offset:4096
    v_mfma_f32_32x32x16_bf16 v[32:47], v[72:75], v[96:99], v[32:47]
    ds_read_b64_tr_b16 v[90:91], v137 offset:5120
    ds_read_b64_tr_b16 v[92:93], v138 offset:4096
    ds_read_b64_tr_b16 v[94:95], v138 offset:5120
    v_mfma_f32_32x32x16_bf16 v[48:63], v[76:79], v[96:99], v[48:63]
    s_waitcnt lgkmcnt(0)
    v_mfma_f32_32x32x16_bf16 v[0:15], v[80:83], v[100:103], v[0:15]
    ds_read_b128 v[96:99], v133 offset:0
    ds_read_b64_tr_b16 v[64:65], v135 offset:8192
    ds_read_b64_tr_b16 v[66:67], v135 offset:9216
    v_mfma_f32_32x32x16_bf16 v[16:31], v[84:87], v[100:103], v[16:31]
    ds_read_b64_tr_b16 v[68:69], v136 offset:8192
    ds_read_b64_tr_b16 v[70:71], v136 offset:9216
    ds_read_b64_tr_b16 v[72:73], v137 offset:8192
    v_mfma_f32_32x32x16_bf16 v[32:47], v[88:91], v[100:103], v[32:47]
    ds_read_b64_tr_b16 v[74:75], v137 offset:9216
    ds_read_b64_tr_b16 v[76:77], v138 offset:8192
    ds_read_b64_tr_b16 v[78:79], v138 offset:9216
    v_mfma_f32_32x32x16_bf16 v[48:63], v[92:95], v[100:103], v[48:63]
    s_waitcnt lgkmcnt(0)
    v_mfma_f32_32x32x16_bf16 v[0:15], v[64:67], v[96:99], v[0:15]
    ds_read_b128 v[100:103], v134 offset:0
    ds_read_b64_tr_b16 v[80:81], v135 offset:12288
    ds_read_b64_tr_b16 v[82:83], v135 offset:13312
    v_mfma_f32_32x32x16_bf16 v[16:31], v[68:71], v[96:99], v[16:31]
    ds_read_b64_tr_b16 v[84:85], v136 offset:12288
    ds_read_b64_tr_b16 v[86:87], v136 offset:13312
    ds_read_b64_tr_b16 v[88:89], v137 offset:12288
    v_mfma_f32_32x32x16_bf16 v[32:47], v[72:75], v[96:99], v[32:47]
    ds_read_b64_tr_b16 v[90:91], v137 offset:13312
    ds_read_b64_tr_b16 v[92:93], v138 offset:12288
    ds_read_b64_tr_b16 v[94:95], v138 offset:13312
    v_mfma_f32_32x32x16_bf16 v[48:63], v[76:79], v[96:99], v[48:63]
    s_waitcnt lgkmcnt(0)
    s_barrier
    v_mfma_f32_32x32x16_bf16 v[0:15], v[80:83], v[100:103], v[0:15]
    ds_read_b128 v[96:99], v131 offset:32768
    ds_read_b64_tr_b16 v[64:65], v135 offset:32768
    ds_read_b64_tr_b16 v[66:67], v135 offset:33792
    v_mfma_f32_32x32x16_bf16 v[16:31], v[84:87], v[100:103], v[16:31]
    ds_read_b64_tr_b16 v[68:69], v136 offset:32768
    ds_read_b64_tr_b16 v[70:71], v136 offset:33792
    ds_read_b64_tr_b16 v[72:73], v137 offset:32768
    v_mfma_f32_32x32x16_bf16 v[32:47], v[88:91], v[100:103], v[32:47]
    ds_read_b64_tr_b16 v[74:75], v137 offset:33792
    ds_read_b64_tr_b16 v[76:77], v138 offset:32768
    ds_read_b64_tr_b16 v[78:79], v138 offset:33792
    v_mfma_f32_32x32x16_bf16 v[48:63], v[92:95], v[100:103], v[48:63]
    s_waitcnt lgkmcnt(0)
    v_mfma_f32_32x32x16_bf16 v[0:15], v[64:67], v[96:99], v[0:15]
    ds_read_b128 v[100:103], v132 offset:32768
    ds_read_b64_tr_b16 v[80:81], v135 offset:36864
    ds_read_b64_tr_b16 v[82:83], v135 offset:37888
    v_mfma_f32_32x32x16_bf16 v[16:31], v[68:71], v[96:99], v[16:31]
    ds_read_b64_tr_b16 v[84:85], v136 offset:36864
    ds_read_b64_tr_b16 v[86:87], v136 offset:37888
    ds_read_b64_tr_b16 v[88:89], v137 offset:36864
    v_mfma_f32_32x32x16_bf16 v[32:47], v[72:75], v[96:99], v[32:47]
    ds_read_b64_tr_b16 v[90:91], v137 offset:37888
    ds_read_b64_tr_b16 v[92:93], v138 offset:36864
    ds_read_b64_tr_b16 v[94:95], v138 offset:37888
    v_mfma_f32_32x32x16_bf16 v[48:63], v[76:79], v[96:99], v[48:63]
    s_waitcnt lgkmcnt(0)
    v_mfma_f32_32x32x16_bf16 v[0:15], v[80:83], v[100:103], v[0:15]
    ds_read_b128 v[96:99], v133 offset:32768
    ds_read_b64_tr_b16 v[64:65], v135 offset:40960
    ds_read_b64_tr_b16 v[66:67], v135 offset:41984
    v_mfma_f32_32x32x16_bf16 v[16:31], v[84:87], v[100:103], v[16:31]
    ds_read_b64_tr_b16 v[68:69], v136 offset:40960
    ds_read_b64_tr_b16 v[70:71], v136 offset:41984
    ds_read_b64_tr_b16 v[72:73], v137 offset:40960
    v_mfma_f32_32x32x16_bf16 v[32:47], v[88:91], v[100:103], v[32:47]
    ds_read_b64_tr_b16 v[74:75], v137 offset:41984
    ds_read_b64_tr_b16 v[76:77], v138 offset:40960
    ds_read_b64_tr_b16 v[78:79], v138 offset:41984
    v_mfma_f32_32x32x16_bf16 v[48:63], v[92:95], v[100:103], v[48:63]
    s_waitcnt lgkmcnt(0)
    v_mfma_f32_32x32x16_bf16 v[0:15], v[64:67], v[96:99], v[0:15]
    ds_read_b128 v[100:103], v134 offset:32768
    ds_read_b64_tr_b16 v[80:81], v135 offset:45056
    ds_read_b64_tr_b16 v[82:83], v135 offset:46080
    v_mfma_f32_32x32x16_bf16 v[16:31], v[68:71], v[96:99], v[16:31]
    ds_read_b64_tr_b16 v[84:85], v136 offset:45056
    ds_read_b64_tr_b16 v[86:87], v136 offset:46080
    ds_read_b64_tr_b16 v[88:89], v137 offset:45056
    v_mfma_f32_32x32x16_bf16 v[32:47], v[72:75], v[96:99], v[32:47]
    ds_read_b64_tr_b16 v[90:91], v137 offset:46080
    ds_read_b64_tr_b16 v[92:93], v138 offset:45056
    ds_read_b64_tr_b16 v[94:95], v138 offset:46080
    v_mfma_f32_32x32x16_bf16 v[48:63], v[76:79], v[96:99], v[48:63]
    s_waitcnt lgkmcnt(0)
    s_barrier
    v_mfma_f32_32x32x16_bf16 v[0:15], v[80:83], v[100:103], v[0:15]
    v_xor_b32 v131, 0x10000, v131
    v_xor_b32 v132, 0x10000, v132
    v_xor_b32 v133, 0x10000, v133
    v_xor_b32 v134, 0x10000, v134
    v_xor_b32 v135, 0x10000, v135
    v_xor_b32 v136, 0x10000, v136
    v_xor_b32 v137, 0x10000, v137
    v_xor_b32 v138, 0x10000, v138
    ds_read_b128 v[96:99], v131 offset:0
    ds_read_b64_tr_b16 v[64:65], v135 offset:0
    ds_read_b64_tr_b16 v[66:67], v135 offset:1024
    v_mfma_f32_32x32x16_bf16 v[16:31], v[84:87], v[100:103], v[16:31]
    ds_read_b64_tr_b16 v[68:69], v136 offset:0
    ds_read_b64_tr_b16 v[70:71], v136 offset:1024
    ds_read_b64_tr_b16 v[72:73], v137 offset:0
    v_mfma_f32_32x32x16_bf16 v[32:47], v[88:91], v[100:103], v[32:47]
    ds_read_b64_tr_b16 v[74:75], v137 offset:1024
    ds_read_b64_tr_b16 v[76:77], v138 offset:0
    ds_read_b64_tr_b16 v[78:79], v138 offset:1024
    v_mfma_f32_32x32x16_bf16 v[48:63], v[92:95], v[100:103], v[48:63]
    s_waitcnt lgkmcnt(0)
    v_mfma_f32_32x32x16_bf16 v[0:15], v[64:67], v[96:99], v[0:15]
    ds_read_b128 v[100:103], v132 offset:0
    ds_read_b64_tr_b16 v[80:81], v135 offset:4096
    ds_read_b64_tr_b16 v[82:83], v135 offset:5120
    v_mfma_f32_32x32x16_bf16 v[16:31], v[68:71], v[96:99], v[16:31]
    ds_read_b64_tr_b16 v[84:85], v136 offset:4096
    ds_read_b64_tr_b16 v[86:87], v136 offset:5120
    ds_read_b64_tr_b16 v[88:89], v137 offset:4096
    v_mfma_f32_32x32x16_bf16 v[32:47], v[72:75], v[96:99], v[32:47]
    ds_read_b64_tr_b16 v[90:91], v137 offset:5120
    ds_read_b64_tr_b16 v[92:93], v138 offset:4096
    ds_read_b64_tr_b16 v[94:95], v138 offset:5120
    v_mfma_f32_32x32x16_bf16 v[48:63], v[76:79], v[96:99], v[48:63]
    s_waitcnt lgkmcnt(0)
    v_mfma_f32_32x32x16_bf16 v[0:15], v[80:83], v[100:103], v[0:15]
    ds_read_b128 v[96:99], v133 offset:0
    ds_read_b64_tr_b16 v[64:65], v135 offset:8192
    ds_read_b64_tr_b16 v[66:67], v135 offset:9216
    v_mfma_f32_32x32x16_bf16 v[16:31], v[84:87], v[100:103], v[16:31]
    ds_read_b64_tr_b16 v[68:69], v136 offset:8192
    ds_read_b64_tr_b16 v[70:71], v136 offset:9216
    ds_read_b64_tr_b16 v[72:73], v137 offset:8192
    v_mfma_f32_32x32x16_bf16 v[32:47], v[88:91], v[100:103], v[32:47]
    ds_read_b64_tr_b16 v[74:75], v137 offset:9216
    ds_read_b64_tr_b16 v[76:77], v138 offset:8192
    ds_read_b64_tr_b16 v[78:79], v138 offset:9216
    v_mfma_f32_32x32x16_bf16 v[48:63], v[92:95], v[100:103], v[48:63]
    s_waitcnt lgkmcnt(0)
    v_mfma_f32_32x32x16_bf16 v[0:15], v[64:67], v[96:99], v[0:15]
    ds_read_b128 v[100:103], v134 offset:0
    ds_read_b64_tr_b16 v[80:81], v135 offset:12288
    ds_read_b64_tr_b16 v[82:83], v135 offset:13312
    v_mfma_f32_32x32x16_bf16 v[16:31], v[68:71], v[96:99], v[16:31]
    ds_read_b64_tr_b16 v[84:85], v136 offset:12288
    ds_read_b64_tr_b16 v[86:87], v136 offset:13312
    ds_read_b64_tr_b16 v[88:89], v137 offset:12288
    v_mfma_f32_32x32x16_bf16 v[32:47], v[72:75], v[96:99], v[32:47]
    ds_read_b64_tr_b16 v[90:91], v137 offset:13312
    ds_read_b64_tr_b16 v[92:93], v138 offset:12288
    ds_read_b64_tr_b16 v[94:95], v138 offset:13312
    v_mfma_f32_32x32x16_bf16 v[48:63], v[76:79], v[96:99], v[48:63]
    s_waitcnt lgkmcnt(0)
    s_barrier
    v_mfma_f32_32x32x16_bf16 v[0:15], v[80:83], v[100:103], v[0:15]
    ds_read_b128 v[96:99], v131 offset:32768
    ds_read_b64_tr_b16 v[64:65], v135 offset:32768
    ds_read_b64_tr_b16 v[66:67], v135 offset:33792
    v_mfma_f32_32x32x16_bf16 v[16:31], v[84:87], v[100:103], v[16:31]
    ds_read_b64_tr_b16 v[68:69], v136 offset:32768
    ds_read_b64_tr_b16 v[70:71], v136 offset:33792
    ds_read_b64_tr_b16 v[72:73], v137 offset:32768
    v_mfma_f32_32x32x16_bf16 v[32:47], v[88:91], v[100:103], v[32:47]
    ds_read_b64_tr_b16 v[74:75], v137 offset:33792
    ds_read_b64_tr_b16 v[76:77], v138 offset:32768
    ds_read_b64_tr_b16 v[78:79], v138 offset:33792
    v_mfma_f32_32x32x16_bf16 v[48:63], v[92:95], v[100:103], v[48:63]
    s_waitcnt lgkmcnt(0)
    v_mfma_f32_32x32x16_bf16 v[0:15], v[64:67], v[96:99], v[0:15]
    ds_read_b128 v[100:103], v132 offset:32768
    ds_read_b64_tr_b16 v[80:81], v135 offset:36864
    ds_read_b64_tr_b16 v[82:83], v135 offset:37888
    v_mfma_f32_32x32x16_bf16 v[16:31], v[68:71], v[96:99], v[16:31]
    ds_read_b64_tr_b16 v[84:85], v136 offset:36864
    ds_read_b64_tr_b16 v[86:87], v136 offset:37888
    ds_read_b64_tr_b16 v[88:89], v137 offset:36864
    v_mfma_f32_32x32x16_bf16 v[32:47], v[72:75], v[96:99], v[32:47]
    ds_read_b64_tr_b16 v[90:91], v137 offset:37888
    ds_read_b64_tr_b16 v[92:93], v138 offset:36864
    ds_read_b64_tr_b16 v[94:95], v138 offset:37888
    v_mfma_f32_32x32x16_bf16 v[48:63], v[76:79], v[96:99], v[48:63]
    s_waitcnt lgkmcnt(0)
    v_mfma_f32_32x32x16_bf16 v[0:15], v[80:83], v[100:103], v[0:15]
    ds_read_b128 v[96:99], v133 offset:32768
    ds_read_b64_tr_b16 v[64:65], v135 offset:40960
    ds_read_b64_tr_b16 v[66:67], v135 offset:41984
    v_mfma_f32_32x32x16_bf16 v[16:31], v[84:87], v[100:103], v[16:31]
    ds_read_b64_tr_b16 v[68:69], v136 offset:40960
    ds_read_b64_tr_b16 v[70:71], v136 offset:41984
    ds_read_b64_tr_b16 v[72:73], v137 offset:40960
    v_mfma_f32_32x32x16_bf16 v[32:47], v[88:91], v[100:103], v[32:47]
    ds_read_b64_tr_b16 v[74:75], v137 offset:41984
    ds_read_b64_tr_b16 v[76:77], v138 offset:40960
    ds_read_b64_tr_b16 v[78:79], v138 offset:41984
    v_mfma_f32_32x32x16_bf16 v[48:63], v[92:95], v[100:103], v[48:63]
    s_waitcnt lgkmcnt(0)
    v_mfma_f32_32x32x16_bf16 v[0:15], v[64:67], v[96:99], v[0:15]
    ds_read_b128 v[100:103], v134 offset:32768
    ds_read_b64_tr_b16 v[80:81], v135 offset:45056
    ds_read_b64_tr_b16 v[82:83], v135 offset:46080
    v_mfma_f32_32x32x16_bf16 v[16:31], v[68:71], v[96:99], v[16:31]
    ds_read_b64_tr_b16 v[84:85], v136 offset:45056
    ds_read_b64_tr_b16 v[86:87], v136 offset:46080
    ds_read_b64_tr_b16 v[88:89], v137 offset:45056
    v_mfma_f32_32x32x16_bf16 v[32:47], v[72:75], v[96:99], v[32:47]
    ds_read_b64_tr_b16 v[90:91], v137 offset:46080
    ds_read_b64_tr_b16 v[92:93], v138 offset:45056
    ds_read_b64_tr_b16 v[94:95], v138 offset:46080
    v_mfma_f32_32x32x16_bf16 v[48:63], v[76:79], v[96:99], v[48:63]
    s_waitcnt lgkmcnt(0)
    s_barrier
    v_mfma_f32_32x32x16_bf16 v[0:15], v[80:83], v[100:103], v[0:15]
    v_xor_b32 v131, 0x10000, v131
    v_xor_b32 v132, 0x10000, v132
    v_xor_b32 v133, 0x10000, v133
    v_xor_b32 v134, 0x10000, v134
    v_xor_b32 v135, 0x10000, v135
    v_xor_b32 v136, 0x10000, v136
    v_xor_b32 v137, 0x10000, v137
    v_xor_b32 v138, 0x10000, v138
    ds_read_b128 v[96:99], v131 offset:0
    ds_read_b64_tr_b16 v[64:65], v135 offset:0
    ds_read_b64_tr_b16 v[66:67], v135 offset:1024
    v_mfma_f32_32x32x16_bf16 v[16:31], v[84:87], v[100:103], v[16:31]
    ds_read_b64_tr_b16 v[68:69], v136 offset:0
    ds_read_b64_tr_b16 v[70:71], v136 offset:1024
    ds_read_b64_tr_b16 v[72:73], v137 offset:0
    v_mfma_f32_32x32x16_bf16 v[32:47], v[88:91], v[100:103], v[32:47]
    ds_read_b64_tr_b16 v[74:75], v137 offset:1024
    ds_read_b64_tr_b16 v[76:77], v138 offset:0
    ds_read_b64_tr_b16 v[78:79], v138 offset:1024
    v_mfma_f32_32x32x16_bf16 v[48:63], v[92:95], v[100:103], v[48:63]
    s_waitcnt lgkmcnt(0)
    v_mfma_f32_32x32x16_bf16 v[0:15], v[64:67], v[96:99], v[0:15]
    ds_read_b128 v[100:103], v132 offset:0
    ds_read_b64_tr_b16 v[80:81], v135 offset:4096
    ds_read_b64_tr_b16 v[82:83], v135 offset:5120
    v_mfma_f32_32x32x16_bf16 v[16:31], v[68:71], v[96:99], v[16:31]
    ds_read_b64_tr_b16 v[84:85], v136 offset:4096
    ds_read_b64_tr_b16 v[86:87], v136 offset:5120
    ds_read_b64_tr_b16 v[88:89], v137 offset:4096
    v_mfma_f32_32x32x16_bf16 v[32:47], v[72:75], v[96:99], v[32:47]
    ds_read_b64_tr_b16 v[90:91], v137 offset:5120
    ds_read_b64_tr_b16 v[92:93], v138 offset:4096
    ds_read_b64_tr_b16 v[94:95], v138 offset:5120
    v_mfma_f32_32x32x16_bf16 v[48:63], v[76:79], v[96:99], v[48:63]
    s_waitcnt lgkmcnt(0)
    v_mfma_f32_32x32x16_bf16 v[0:15], v[80:83], v[100:103], v[0:15]
    ds_read_b128 v[96:99], v133 offset:0
    ds_read_b64_tr_b16 v[64:65], v135 offset:8192
    ds_read_b64_tr_b16 v[66:67], v135 offset:9216
    v_mfma_f32_32x32x16_bf16 v[16:31], v[84:87], v[100:103], v[16:31]
    ds_read_b64_tr_b16 v[68:69], v136 offset:8192
    ds_read_b64_tr_b16 v[70:71], v136 offset:9216
    ds_read_b64_tr_b16 v[72:73], v137 offset:8192
    v_mfma_f32_32x32x16_bf16 v[32:47], v[88:91], v[100:103], v[32:47]
    ds_read_b64_tr_b16 v[74:75], v137 offset:9216
    ds_read_b64_tr_b16 v[76:77], v138 offset:8192
    ds_read_b64_tr_b16 v[78:79], v138 offset:9216
    v_mfma_f32_32x32x16_bf16 v[48:63], v[92:95], v[100:103], v[48:63]
    s_waitcnt lgkmcnt(0)
    v_mfma_f32_32x32x16_bf16 v[0:15], v[64:67], v[96:99], v[0:15]
    ds_read_b128 v[100:103], v134 offset:0
    ds_read_b64_tr_b16 v[80:81], v135 offset:12288
    ds_read_b64_tr_b16 v[82:83], v135 offset:13312
    v_mfma_f32_32x32x16_bf16 v[16:31], v[68:71], v[96:99], v[16:31]
    ds_read_b64_tr_b16 v[84:85], v136 offset:12288
    ds_read_b64_tr_b16 v[86:87], v136 offset:13312
    ds_read_b64_tr_b16 v[88:89], v137 offset:12288
    v_mfma_f32_32x32x16_bf16 v[32:47], v[72:75], v[96:99], v[32:47]
    ds_read_b64_tr_b16 v[90:91], v137 offset:13312
    ds_read_b64_tr_b16 v[92:93], v138 offset:12288
    ds_read_b64_tr_b16 v[94:95], v138 offset:13312
    v_mfma_f32_32x32x16_bf16 v[48:63], v[76:79], v[96:99], v[48:63]
    s_waitcnt lgkmcnt(0)
    s_barrier
    v_mfma_f32_32x32x16_bf16 v[0:15], v[80:83], v[100:103], v[0:15]
    ds_read_b128 v[96:99], v131 offset:32768
    ds_read_b64_tr_b16 v[64:65], v135 offset:32768
    ds_read_b64_tr_b16 v[66:67], v135 offset:33792
    v_mfma_f32_32x32x16_bf16 v[16:31], v[84:87], v[100:103], v[16:31]
    ds_read_b64_tr_b16 v[68:69], v136 offset:32768
    ds_read_b64_tr_b16 v[70:71], v136 offset:33792
    ds_read_b64_tr_b16 v[72:73], v137 offset:32768
    v_mfma_f32_32x32x16_bf16 v[32:47], v[88:91], v[100:103], v[32:47]
    ds_read_b64_tr_b16 v[74:75], v137 offset:33792
    ds_read_b64_tr_b16 v[76:77], v138 offset:32768
    ds_read_b64_tr_b16 v[78:79], v138 offset:33792
    v_mfma_f32_32x32x16_bf16 v[48:63], v[92:95], v[100:103], v[48:63]
    s_waitcnt lgkmcnt(0)
    v_mfma_f32_32x32x16_bf16 v[0:15], v[64:67], v[96:99], v[0:15]
    ds_read_b128 v[100:103], v132 offset:32768
    ds_read_b64_tr_b16 v[80:81], v135 offset:36864
    ds_read_b64_tr_b16 v[82:83], v135 offset:37888
    v_mfma_f32_32x32x16_bf16 v[16:31], v[68:71], v[96:99], v[16:31]
    ds_read_b64_tr_b16 v[84:85], v136 offset:36864
    ds_read_b64_tr_b16 v[86:87], v136 offset:37888
    ds_read_b64_tr_b16 v[88:89], v137 offset:36864
    v_mfma_f32_32x32x16_bf16 v[32:47], v[72:75], v[96:99], v[32:47]
    ds_read_b64_tr_b16 v[90:91], v137 offset:37888
    ds_read_b64_tr_b16 v[92:93], v138 offset:36864
    ds_read_b64_tr_b16 v[94:95], v138 offset:37888
    v_mfma_f32_32x32x16_bf16 v[48:63], v[76:79], v[96:99], v[48:63]
    s_waitcnt lgkmcnt(0)
    v_mfma_f32_32x32x16_bf16 v[0:15], v[80:83], v[100:103], v[0:15]
    ds_read_b128 v[96:99], v133 offset:32768
    ds_read_b64_tr_b16 v[64:65], v135 offset:40960
    ds_read_b64_tr_b16 v[66:67], v135 offset:41984
    v_mfma_f32_32x32x16_bf16 v[16:31], v[84:87], v[100:103], v[16:31]
    ds_read_b64_tr_b16 v[68:69], v136 offset:40960
    ds_read_b64_tr_b16 v[70:71], v136 offset:41984
    ds_read_b64_tr_b16 v[72:73], v137 offset:40960
    v_mfma_f32_32x32x16_bf16 v[32:47], v[88:91], v[100:103], v[32:47]
    ds_read_b64_tr_b16 v[74:75], v137 offset:41984
    ds_read_b64_tr_b16 v[76:77], v138 offset:40960
    ds_read_b64_tr_b16 v[78:79], v138 offset:41984
    v_mfma_f32_32x32x16_bf16 v[48:63], v[92:95], v[100:103], v[48:63]
    s_waitcnt lgkmcnt(0)
    v_mfma_f32_32x32x16_bf16 v[0:15], v[64:67], v[96:99], v[0:15]
    ds_read_b128 v[100:103], v134 offset:32768
    ds_read_b64_tr_b16 v[80:81], v135 offset:45056
    ds_read_b64_tr_b16 v[82:83], v135 offset:46080
    v_mfma_f32_32x32x16_bf16 v[16:31], v[68:71], v[96:99], v[16:31]
    ds_read_b64_tr_b16 v[84:85], v136 offset:45056
    ds_read_b64_tr_b16 v[86:87], v136 offset:46080
    ds_read_b64_tr_b16 v[88:89], v137 offset:45056
    v_mfma_f32_32x32x16_bf16 v[32:47], v[72:75], v[96:99], v[32:47]
    ds_read_b64_tr_b16 v[90:91], v137 offset:46080
    ds_read_b64_tr_b16 v[92:93], v138 offset:45056
    ds_read_b64_tr_b16 v[94:95], v138 offset:46080
    v_mfma_f32_32x32x16_bf16 v[48:63], v[76:79], v[96:99], v[48:63]
    s_waitcnt lgkmcnt(0)
    v_mfma_f32_32x32x16_bf16 v[0:15], v[80:83], v[100:103], v[0:15]
    v_mfma_f32_32x32x16_bf16 v[16:31], v[84:87], v[100:103], v[16:31]
    v_mfma_f32_32x32x16_bf16 v[32:47], v[88:91], v[100:103], v[32:47]
    v_mfma_f32_32x32x16_bf16 v[48:63], v[92:95], v[100:103], v[48:63]
    s_lshl_b32 s30, s3, 8
    s_add_u32 s30, s30, 131072
    v_lshl_add_u32 v148, v122, 2, s30
    v_lshlrev_b32 v149, 4, v121
    v_add_u32 v149, 131072, v149
    ds_read_b32 v144, v148
    ds_read_b32 v146, v148 offset:128
    ds_read_b128 v[150:153], v149 offset:2048
    ds_read_b128 v[154:157], v149 offset:2080
    ds_read_b128 v[158:161], v149 offset:2112
    ds_read_b128 v[162:165], v149 offset:2144
    ds_read_b128 v[166:169], v149 offset:2176
    ds_read_b128 v[170:173], v149 offset:2208
    ds_read_b128 v[174:177], v149 offset:2240
    ds_read_b128 v[178:181], v149 offset:2272
    ds_read_b128 v[182:185], v149 offset:2304
    ds_read_b128 v[186:189], v149 offset:2336
    ds_read_b128 v[190:193], v149 offset:2368
    ds_read_b128 v[194:197], v149 offset:2400
    ds_read_b128 v[198:201], v149 offset:2432
    ds_read_b128 v[202:205], v149 offset:2464
    ds_read_b128 v[206:209], v149 offset:2496
    ds_read_b128 v[210:213], v149 offset:2528
    s_waitcnt lgkmcnt(12)
    v_mul_f32 v146, s39, v146
    v_pk_fma_f32 v[0:1], v[150:151], v[144:145], v[0:1] op_sel_hi:[1,0,1]
    v_pk_fma_f32 v[2:3], v[152:153], v[144:145], v[2:3] op_sel_hi:[1,0,1]
    v_pk_fma_f32 v[4:5], v[154:155], v[144:145], v[4:5] op_sel_hi:[1,0,1]
    v_pk_fma_f32 v[6:7], v[156:157], v[144:145], v[6:7] op_sel_hi:[1,0,1]
    v_pk_fma_f32 v[8:9], v[158:159], v[144:145], v[8:9] op_sel_hi:[1,0,1]
    v_pk_fma_f32 v[10:11], v[160:161], v[144:145], v[10:11] op_sel_hi:[1,0,1]
    v_pk_fma_f32 v[12:13], v[162:163], v[144:145], v[12:13] op_sel_hi:[1,0,1]
    v_pk_fma_f32 v[14:15], v[164:165], v[144:145], v[14:15] op_sel_hi:[1,0,1]
    v_pk_mul_f32 v[0:1], v[0:1], v[146:147] op_sel_hi:[1,0]
    v_pk_mul_f32 v[2:3], v[2:3], v[146:147] op_sel_hi:[1,0]
    v_pk_mul_f32 v[4:5], v[4:5], v[146:147] op_sel_hi:[1,0]
    v_pk_mul_f32 v[6:7], v[6:7], v[146:147] op_sel_hi:[1,0]
    v_pk_mul_f32 v[8:9], v[8:9], v[146:147] op_sel_hi:[1,0]
    v_pk_mul_f32 v[10:11], v[10:11], v[146:147] op_sel_hi:[1,0]
    v_pk_mul_f32 v[12:13], v[12:13], v[146:147] op_sel_hi:[1,0]
    v_pk_mul_f32 v[14:15], v[14:15], v[146:147] op_sel_hi:[1,0]
    v_cvt_pk_bf16_f32 v64, v0, v1
    v_cvt_pk_bf16_f32 v65, v2, v3
    v_cvt_pk_bf16_f32 v66, v4, v5
    v_cvt_pk_bf16_f32 v67, v6, v7
    v_cvt_pk_bf16_f32 v68, v8, v9
    v_cvt_pk_bf16_f32 v69, v10, v11
    v_cvt_pk_bf16_f32 v70, v12, v13
    v_cvt_pk_bf16_f32 v71, v14, v15
    buffer_store_dwordx2 v[64:65], v104, s[20:23], s37 offen sc1
    buffer_store_dwordx2 v[66:67], v105, s[20:23], s37 offen sc1
    buffer_store_dwordx2 v[68:69], v106, s[20:23], s37 offen sc1
    buffer_store_dwordx2 v[70:71], v107, s[20:23], s37 offen sc1
    s_waitcnt lgkmcnt(8)
    v_pk_fma_f32 v[16:17], v[166:167], v[144:145], v[16:17] op_sel_hi:[1,0,1]
    v_pk_fma_f32 v[18:19], v[168:169], v[144:145], v[18:19] op_sel_hi:[1,0,1]
    v_pk_fma_f32 v[20:21], v[170:171], v[144:145], v[20:21] op_sel_hi:[1,0,1]
    v_pk_fma_f32 v[22:23], v[172:173], v[144:145], v[22:23] op_sel_hi:[1,0,1]
    v_pk_fma_f32 v[24:25], v[174:175], v[144:145], v[24:25] op_sel_hi:[1,0,1]
    v_pk_fma_f32 v[26:27], v[176:177], v[144:145], v[26:27] op_sel_hi:[1,0,1]
    v_pk_fma_f32 v[28:29], v[178:179], v[144:145], v[28:29] op_sel_hi:[1,0,1]
    v_pk_fma_f32 v[30:31], v[180:181], v[144:145], v[30:31] op_sel_hi:[1,0,1]
    v_pk_mul_f32 v[16:17], v[16:17], v[146:147] op_sel_hi:[1,0]
    v_pk_mul_f32 v[18:19], v[18:19], v[146:147] op_sel_hi:[1,0]
    v_pk_mul_f32 v[20:21], v[20:21], v[146:147] op_sel_hi:[1,0]
    v_pk_mul_f32 v[22:23], v[22:23], v[146:147] op_sel_hi:[1,0]
    v_pk_mul_f32 v[24:25], v[24:25], v[146:147] op_sel_hi:[1,0]
    v_pk_mul_f32 v[26:27], v[26:27], v[146:147] op_sel_hi:[1,0]
    v_pk_mul_f32 v[28:29], v[28:29], v[146:147] op_sel_hi:[1,0]
    v_pk_mul_f32 v[30:31], v[30:31], v[146:147] op_sel_hi:[1,0]
    v_cvt_pk_bf16_f32 v72, v16, v17
    v_cvt_pk_bf16_f32 v73, v18, v19
    v_cvt_pk_bf16_f32 v74, v20, v21
    v_cvt_pk_bf16_f32 v75, v22, v23
    v_cvt_pk_bf16_f32 v76, v24, v25
    v_cvt_pk_bf16_f32 v77, v26, v27
    v_cvt_pk_bf16_f32 v78, v28, v29
    v_cvt_pk_bf16_f32 v79, v30, v31
    buffer_store_dwordx2 v[72:73], v108, s[20:23], s37 offen sc1
    buffer_store_dwordx2 v[74:75], v109, s[20:23], s37 offen sc1
    buffer_store_dwordx2 v[76:77], v110, s[20:23], s37 offen sc1
    buffer_store_dwordx2 v[78:79], v111, s[20:23], s37 offen sc1
    s_waitcnt lgkmcnt(4)
    v_pk_fma_f32 v[32:33], v[182:183], v[144:145], v[32:33] op_sel_hi:[1,0,1]
    v_pk_fma_f32 v[34:35], v[184:185], v[144:145], v[34:35] op_sel_hi:[1,0,1]
    v_pk_fma_f32 v[36:37], v[186:187], v[144:145], v[36:37] op_sel_hi:[1,0,1]
    v_pk_fma_f32 v[38:39], v[188:189], v[144:145], v[38:39] op_sel_hi:[1,0,1]
    v_pk_fma_f32 v[40:41], v[190:191], v[144:145], v[40:41] op_sel_hi:[1,0,1]
    v_pk_fma_f32 v[42:43], v[192:193], v[144:145], v[42:43] op_sel_hi:[1,0,1]
    v_pk_fma_f32 v[44:45], v[194:195], v[144:145], v[44:45] op_sel_hi:[1,0,1]
    v_pk_fma_f32 v[46:47], v[196:197], v[144:145], v[46:47] op_sel_hi:[1,0,1]
    v_pk_mul_f32 v[32:33], v[32:33], v[146:147] op_sel_hi:[1,0]
    v_pk_mul_f32 v[34:35], v[34:35], v[146:147] op_sel_hi:[1,0]
    v_pk_mul_f32 v[36:37], v[36:37], v[146:147] op_sel_hi:[1,0]
    v_pk_mul_f32 v[38:39], v[38:39], v[146:147] op_sel_hi:[1,0]
    v_pk_mul_f32 v[40:41], v[40:41], v[146:147] op_sel_hi:[1,0]
    v_pk_mul_f32 v[42:43], v[42:43], v[146:147] op_sel_hi:[1,0]
    v_pk_mul_f32 v[44:45], v[44:45], v[146:147] op_sel_hi:[1,0]
    v_pk_mul_f32 v[46:47], v[46:47], v[146:147] op_sel_hi:[1,0]
    v_cvt_pk_bf16_f32 v80, v32, v33
    v_cvt_pk_bf16_f32 v81, v34, v35
    v_cvt_pk_bf16_f32 v82, v36, v37
    v_cvt_pk_bf16_f32 v83, v38, v39
    v_cvt_pk_bf16_f32 v84, v40, v41
    v_cvt_pk_bf16_f32 v85, v42, v43
    v_cvt_pk_bf16_f32 v86, v44, v45
    v_cvt_pk_bf16_f32 v87, v46, v47
    buffer_store_dwordx2 v[80:81], v112, s[20:23], s37 offen sc1
    buffer_store_dwordx2 v[82:83], v113, s[20:23], s37 offen sc1
    buffer_store_dwordx2 v[84:85], v114, s[20:23], s37 offen sc1
    buffer_store_dwordx2 v[86:87], v115, s[20:23], s37 offen sc1
    s_waitcnt lgkmcnt(0)
    v_pk_fma_f32 v[48:49], v[198:199], v[144:145], v[48:49] op_sel_hi:[1,0,1]
    v_pk_fma_f32 v[50:51], v[200:201], v[144:145], v[50:51] op_sel_hi:[1,0,1]
    v_pk_fma_f32 v[52:53], v[202:203], v[144:145], v[52:53] op_sel_hi:[1,0,1]
    v_pk_fma_f32 v[54:55], v[204:205], v[144:145], v[54:55] op_sel_hi:[1,0,1]
    v_pk_fma_f32 v[56:57], v[206:207], v[144:145], v[56:57] op_sel_hi:[1,0,1]
    v_pk_fma_f32 v[58:59], v[208:209], v[144:145], v[58:59] op_sel_hi:[1,0,1]
    v_pk_fma_f32 v[60:61], v[210:211], v[144:145], v[60:61] op_sel_hi:[1,0,1]
    v_pk_fma_f32 v[62:63], v[212:213], v[144:145], v[62:63] op_sel_hi:[1,0,1]
    v_pk_mul_f32 v[48:49], v[48:49], v[146:147] op_sel_hi:[1,0]
    v_pk_mul_f32 v[50:51], v[50:51], v[146:147] op_sel_hi:[1,0]
    v_pk_mul_f32 v[52:53], v[52:53], v[146:147] op_sel_hi:[1,0]
    v_pk_mul_f32 v[54:55], v[54:55], v[146:147] op_sel_hi:[1,0]
    v_pk_mul_f32 v[56:57], v[56:57], v[146:147] op_sel_hi:[1,0]
    v_pk_mul_f32 v[58:59], v[58:59], v[146:147] op_sel_hi:[1,0]
    v_pk_mul_f32 v[60:61], v[60:61], v[146:147] op_sel_hi:[1,0]
    v_pk_mul_f32 v[62:63], v[62:63], v[146:147] op_sel_hi:[1,0]
    v_cvt_pk_bf16_f32 v88, v48, v49
    v_cvt_pk_bf16_f32 v89, v50, v51
    v_cvt_pk_bf16_f32 v90, v52, v53
    v_cvt_pk_bf16_f32 v91, v54, v55
    v_cvt_pk_bf16_f32 v92, v56, v57
    v_cvt_pk_bf16_f32 v93, v58, v59
    v_cvt_pk_bf16_f32 v94, v60, v61
    v_cvt_pk_bf16_f32 v95, v62, v63
    buffer_store_dwordx2 v[88:89], v116, s[20:23], s37 offen sc1
    buffer_store_dwordx2 v[90:91], v117, s[20:23], s37 offen sc1
    buffer_store_dwordx2 v[92:93], v118, s[20:23], s37 offen sc1
    buffer_store_dwordx2 v[94:95], v119, s[20:23], s37 offen sc1
    s_branch L_q_sig
L_q0_v:
    s_mul_i32 s37, s32, 2560
    s_add_u32 s37, s37, 0x300500
    s_mov_b32 s36, 163840
    v_mul_u32_u24 v144, 320, v121
    s_mov_b32 s30, 0
    s_lshl_b32 s31, s26, 7
    s_add_u32 s30, s30, s31
    v_add_u32 v146, s30, v122
    v_mul_u32_u24 v147, 3277, v146
    v_lshrrev_b32 v147, 16, v147
    v_mul_u32_u24 v148, 20, v147
    v_sub_u32 v146, v146, v148
    v_lshl_add_u32 v146, v146, 4, v144
    v_mad_u32_u24 v104, v147, s36, v146
    s_mov_b32 s30, 32
    s_lshl_b32 s31, s26, 7
    s_add_u32 s30, s30, s31
    v_add_u32 v146, s30, v122
    v_mul_u32_u24 v147, 3277, v146
    v_lshrrev_b32 v147, 16, v147
    v_mul_u32_u24 v148, 20, v147
    v_sub_u32 v146, v146, v148
    v_lshl_add_u32 v146, v146, 4, v144
    v_mad_u32_u24 v105, v147, s36, v146
    s_mov_b32 s30, 64
    s_lshl_b32 s31, s26, 7
    s_add_u32 s30, s30, s31
    v_add_u32 v146, s30, v122
    v_mul_u32_u24 v147, 3277, v146
    v_lshrrev_b32 v147, 16, v147
    v_mul_u32_u24 v148, 20, v147
    v_sub_u32 v146, v146, v148
    v_lshl_add_u32 v146, v146, 4, v144
    v_mad_u32_u24 v106, v147, s36, v146
    s_mov_b32 s30, 96
    s_lshl_b32 s31, s26, 7
    s_add_u32 s30, s30, s31
    v_add_u32 v146, s30, v122
    v_mul_u32_u24 v147, 3277, v146
    v_lshrrev_b32 v147, 16, v147
    v_mul_u32_u24 v148, 20, v147
    v_sub_u32 v146, v146, v148
    v_lshl_add_u32 v146, v146, 4, v144
    v_mad_u32_u24 v107, v147, s36, v146
    s_barrier
    ds_read_b128 v[96:99], v131 offset:0
    ds_read_b64_tr_b16 v[64:65], v135 offset:0
    ds_read_b64_tr_b16 v[66:67], v135 offset:1024
    ds_read_b64_tr_b16 v[68:69], v136 offset:0
    ds_read_b64_tr_b16 v[70:71], v136 offset:1024
    ds_read_b64_tr_b16 v[72:73], v137 offset:0
    ds_read_b64_tr_b16 v[74:75], v137 offset:1024
    ds_read_b64_tr_b16 v[76:77], v138 offset:0
    ds_read_b64_tr_b16 v[78:79], v138 offset:1024
    s_waitcnt lgkmcnt(0)
    v_mfma_f32_32x32x16_bf16 v[0:15], v[96:99], v[64:67], 0
    ds_read_b128 v[100:103], v132 offset:0
    ds_read_b64_tr_b16 v[80:81], v135 offset:4096
    ds_read_b64_tr_b16 v[82:83], v135 offset:5120
    v_mfma_f32_32x32x16_bf16 v[16:31], v[96:99], v[68:71], 0
    ds_read_b64_tr_b16 v[84:85], v136 offset:4096
    ds_read_b64_tr_b16 v[86:87], v136 offset:5120
    ds_read_b64_tr_b16 v[88:89], v137 offset:4096
    v_mfma_f32_32x32x16_bf16 v[32:47], v[96:99], v[72:75], 0
    ds_read_b64_tr_b16 v[90:91], v137 offset:5120
    ds_read_b64_tr_b16 v[92:93], v138 offset:4096
    ds_read_b64_tr_b16 v[94:95], v138 offset:5120
    v_mfma_f32_32x32x16_bf16 v[48:63], v[96:99], v[76:79], 0
    s_waitcnt lgkmcnt(0)
    v_mfma_f32_32x32x16_bf16 v[0:15], v[100:103], v[80:83], v[0:15]
    ds_read_b128 v[96:99], v133 offset:0
    ds_read_b64_tr_b16 v[64:65], v135 offset:8192
    ds_read_b64_tr_b16 v[66:67], v135 offset:9216
    v_mfma_f32_32x32x16_bf16 v[16:31], v[100:103], v[84:87], v[16:31]
    ds_read_b64_tr_b16 v[68:69], v136 offset:8192
    ds_read_b64_tr_b16 v[70:71], v136 offset:9216
    ds_read_b64_tr_b16 v[72:73], v137 offset:8192
    v_mfma_f32_32x32x16_bf16 v[32:47], v[100:103], v[88:91], v[32:47]
    ds_read_b64_tr_b16 v[74:75], v137 offset:9216
    ds_read_b64_tr_b16 v[76:77], v138 offset:8192
    ds_read_b64_tr_b16 v[78:79], v138 offset:9216
    v_mfma_f32_32x32x16_bf16 v[48:63], v[100:103], v[92:95], v[48:63]
    s_waitcnt lgkmcnt(0)
    v_mfma_f32_32x32x16_bf16 v[0:15], v[96:99], v[64:67], v[0:15]
    ds_read_b128 v[100:103], v134 offset:0
    ds_read_b64_tr_b16 v[80:81], v135 offset:12288
    ds_read_b64_tr_b16 v[82:83], v135 offset:13312
    v_mfma_f32_32x32x16_bf16 v[16:31], v[96:99], v[68:71], v[16:31]
    ds_read_b64_tr_b16 v[84:85], v136 offset:12288
    ds_read_b64_tr_b16 v[86:87], v136 offset:13312
    ds_read_b64_tr_b16 v[88:89], v137 offset:12288
    v_mfma_f32_32x32x16_bf16 v[32:47], v[96:99], v[72:75], v[32:47]
    ds_read_b64_tr_b16 v[90:91], v137 offset:13312
    ds_read_b64_tr_b16 v[92:93], v138 offset:12288
    ds_read_b64_tr_b16 v[94:95], v138 offset:13312
    v_mfma_f32_32x32x16_bf16 v[48:63], v[96:99], v[76:79], v[48:63]
    s_waitcnt lgkmcnt(0)
    s_barrier
    v_mfma_f32_32x32x16_bf16 v[0:15], v[100:103], v[80:83], v[0:15]
    ds_read_b128 v[96:99], v131 offset:32768
    ds_read_b64_tr_b16 v[64:65], v135 offset:32768
    ds_read_b64_tr_b16 v[66:67], v135 offset:33792
    v_mfma_f32_32x32x16_bf16 v[16:31], v[100:103], v[84:87], v[16:31]
    ds_read_b64_tr_b16 v[68:69], v136 offset:32768
    ds_read_b64_tr_b16 v[70:71], v136 offset:33792
    ds_read_b64_tr_b16 v[72:73], v137 offset:32768
    v_mfma_f32_32x32x16_bf16 v[32:47], v[100:103], v[88:91], v[32:47]
    ds_read_b64_tr_b16 v[74:75], v137 offset:33792
    ds_read_b64_tr_b16 v[76:77], v138 offset:32768
    ds_read_b64_tr_b16 v[78:79], v138 offset:33792
    v_mfma_f32_32x32x16_bf16 v[48:63], v[100:103], v[92:95], v[48:63]
    s_waitcnt lgkmcnt(0)
    v_mfma_f32_32x32x16_bf16 v[0:15], v[96:99], v[64:67], v[0:15]
    ds_read_b128 v[100:103], v132 offset:32768
    ds_read_b64_tr_b16 v[80:81], v135 offset:36864
    ds_read_b64_tr_b16 v[82:83], v135 offset:37888
    v_mfma_f32_32x32x16_bf16 v[16:31], v[96:99], v[68:71], v[16:31]
    ds_read_b64_tr_b16 v[84:85], v136 offset:36864
    ds_read_b64_tr_b16 v[86:87], v136 offset:37888
    ds_read_b64_tr_b16 v[88:89], v137 offset:36864
    v_mfma_f32_32x32x16_bf16 v[32:47], v[96:99], v[72:75], v[32:47]
    ds_read_b64_tr_b16 v[90:91], v137 offset:37888
    ds_read_b64_tr_b16 v[92:93], v138 offset:36864
    ds_read_b64_tr_b16 v[94:95], v138 offset:37888
    v_mfma_f32_32x32x16_bf16 v[48:63], v[96:99], v[76:79], v[48:63]
    s_waitcnt lgkmcnt(0)
    v_mfma_f32_32x32x16_bf16 v[0:15], v[100:103], v[80:83], v[0:15]
    ds_read_b128 v[96:99], v133 offset:32768
    ds_read_b64_tr_b16 v[64:65], v135 offset:40960
    ds_read_b64_tr_b16 v[66:67], v135 offset:41984
    v_mfma_f32_32x32x16_bf16 v[16:31], v[100:103], v[84:87], v[16:31]
    ds_read_b64_tr_b16 v[68:69], v136 offset:40960
    ds_read_b64_tr_b16 v[70:71], v136 offset:41984
    ds_read_b64_tr_b16 v[72:73], v137 offset:40960
    v_mfma_f32_32x32x16_bf16 v[32:47], v[100:103], v[88:91], v[32:47]
    ds_read_b64_tr_b16 v[74:75], v137 offset:41984
    ds_read_b64_tr_b16 v[76:77], v138 offset:40960
    ds_read_b64_tr_b16 v[78:79], v138 offset:41984
    v_mfma_f32_32x32x16_bf16 v[48:63], v[100:103], v[92:95], v[48:63]
    s_waitcnt lgkmcnt(0)
    v_mfma_f32_32x32x16_bf16 v[0:15], v[96:99], v[64:67], v[0:15]
    ds_read_b128 v[100:103], v134 offset:32768
    ds_read_b64_tr_b16 v[80:81], v135 offset:45056
    ds_read_b64_tr_b16 v[82:83], v135 offset:46080
    v_mfma_f32_32x32x16_bf16 v[16:31], v[96:99], v[68:71], v[16:31]
    ds_read_b64_tr_b16 v[84:85], v136 offset:45056
    ds_read_b64_tr_b16 v[86:87], v136 offset:46080
    ds_read_b64_tr_b16 v[88:89], v137 offset:45056
    v_mfma_f32_32x32x16_bf16 v[32:47], v[96:99], v[72:75], v[32:47]
    ds_read_b64_tr_b16 v[90:91], v137 offset:46080
    ds_read_b64_tr_b16 v[92:93], v138 offset:45056
    ds_read_b64_tr_b16 v[94:95], v138 offset:46080
    v_mfma_f32_32x32x16_bf16 v[48:63], v[96:99], v[76:79], v[48:63]
    s_waitcnt lgkmcnt(0)
    s_barrier
    v_mfma_f32_32x32x16_bf16 v[0:15], v[100:103], v[80:83], v[0:15]
    v_xor_b32 v131, 0x10000, v131
    v_xor_b32 v132, 0x10000, v132
    v_xor_b32 v133, 0x10000, v133
    v_xor_b32 v134, 0x10000, v134
    v_xor_b32 v135, 0x10000, v135
    v_xor_b32 v136, 0x10000, v136
    v_xor_b32 v137, 0x10000, v137
    v_xor_b32 v138, 0x10000, v138
    ds_read_b128 v[96:99], v131 offset:0
    ds_read_b64_tr_b16 v[64:65], v135 offset:0
    ds_read_b64_tr_b16 v[66:67], v135 offset:1024
    v_mfma_f32_32x32x16_bf16 v[16:31], v[100:103], v[84:87], v[16:31]
    ds_read_b64_tr_b16 v[68:69], v136 offset:0
    ds_read_b64_tr_b16 v[70:71], v136 offset:1024
    ds_read_b64_tr_b16 v[72:73], v137 offset:0
    v_mfma_f32_32x32x16_bf16 v[32:47], v[100:103], v[88:91], v[32:47]
    ds_read_b64_tr_b16 v[74:75], v137 offset:1024
    ds_read_b64_tr_b16 v[76:77], v138 offset:0
    ds_read_b64_tr_b16 v[78:79], v138 offset:1024
    v_mfma_f32_32x32x16_bf16 v[48:63], v[100:103], v[92:95], v[48:63]
    s_waitcnt lgkmcnt(0)
    v_mfma_f32_32x32x16_bf16 v[0:15], v[96:99], v[64:67], v[0:15]
    ds_read_b128 v[100:103], v132 offset:0
    ds_read_b64_tr_b16 v[80:81], v135 offset:4096
    ds_read_b64_tr_b16 v[82:83], v135 offset:5120
    v_mfma_f32_32x32x16_bf16 v[16:31], v[96:99], v[68:71], v[16:31]
    ds_read_b64_tr_b16 v[84:85], v136 offset:4096
    ds_read_b64_tr_b16 v[86:87], v136 offset:5120
    ds_read_b64_tr_b16 v[88:89], v137 offset:4096
    v_mfma_f32_32x32x16_bf16 v[32:47], v[96:99], v[72:75], v[32:47]
    ds_read_b64_tr_b16 v[90:91], v137 offset:5120
    ds_read_b64_tr_b16 v[92:93], v138 offset:4096
    ds_read_b64_tr_b16 v[94:95], v138 offset:5120
    v_mfma_f32_32x32x16_bf16 v[48:63], v[96:99], v[76:79], v[48:63]
    s_waitcnt lgkmcnt(0)
    v_mfma_f32_32x32x16_bf16 v[0:15], v[100:103], v[80:83], v[0:15]
    ds_read_b128 v[96:99], v133 offset:0
    ds_read_b64_tr_b16 v[64:65], v135 offset:8192
    ds_read_b64_tr_b16 v[66:67], v135 offset:9216
    v_mfma_f32_32x32x16_bf16 v[16:31], v[100:103], v[84:87], v[16:31]
    ds_read_b64_tr_b16 v[68:69], v136 offset:8192
    ds_read_b64_tr_b16 v[70:71], v136 offset:9216
    ds_read_b64_tr_b16 v[72:73], v137 offset:8192
    v_mfma_f32_32x32x16_bf16 v[32:47], v[100:103], v[88:91], v[32:47]
    ds_read_b64_tr_b16 v[74:75], v137 offset:9216
    ds_read_b64_tr_b16 v[76:77], v138 offset:8192
    ds_read_b64_tr_b16 v[78:79], v138 offset:9216
    v_mfma_f32_32x32x16_bf16 v[48:63], v[100:103], v[92:95], v[48:63]
    s_waitcnt lgkmcnt(0)
    v_mfma_f32_32x32x16_bf16 v[0:15], v[96:99], v[64:67], v[0:15]
    ds_read_b128 v[100:103], v134 offset:0
    ds_read_b64_tr_b16 v[80:81], v135 offset:12288
    ds_read_b64_tr_b16 v[82:83], v135 offset:13312
    v_mfma_f32_32x32x16_bf16 v[16:31], v[96:99], v[68:71], v[16:31]
    ds_read_b64_tr_b16 v[84:85], v136 offset:12288
    ds_read_b64_tr_b16 v[86:87], v136 offset:13312
    ds_read_b64_tr_b16 v[88:89], v137 offset:12288
    v_mfma_f32_32x32x16_bf16 v[32:47], v[96:99], v[72:75], v[32:47]
    ds_read_b64_tr_b16 v[90:91], v137 offset:13312
    ds_read_b64_tr_b16 v[92:93], v138 offset:12288
    ds_read_b64_tr_b16 v[94:95], v138 offset:13312
    v_mfma_f32_32x32x16_bf16 v[48:63], v[96:99], v[76:79], v[48:63]
    s_waitcnt lgkmcnt(0)
    s_barrier
    v_mfma_f32_32x32x16_bf16 v[0:15], v[100:103], v[80:83], v[0:15]
    ds_read_b128 v[96:99], v131 offset:32768
    ds_read_b64_tr_b16 v[64:65], v135 offset:32768
    ds_read_b64_tr_b16 v[66:67], v135 offset:33792
    v_mfma_f32_32x32x16_bf16 v[16:31], v[100:103], v[84:87], v[16:31]
    ds_read_b64_tr_b16 v[68:69], v136 offset:32768
    ds_read_b64_tr_b16 v[70:71], v136 offset:33792
    ds_read_b64_tr_b16 v[72:73], v137 offset:32768
    v_mfma_f32_32x32x16_bf16 v[32:47], v[100:103], v[88:91], v[32:47]
    ds_read_b64_tr_b16 v[74:75], v137 offset:33792
    ds_read_b64_tr_b16 v[76:77], v138 offset:32768
    ds_read_b64_tr_b16 v[78:79], v138 offset:33792
    v_mfma_f32_32x32x16_bf16 v[48:63], v[100:103], v[92:95], v[48:63]
    s_waitcnt lgkmcnt(0)
    v_mfma_f32_32x32x16_bf16 v[0:15], v[96:99], v[64:67], v[0:15]
    ds_read_b128 v[100:103], v132 offset:32768
    ds_read_b64_tr_b16 v[80:81], v135 offset:36864
    ds_read_b64_tr_b16 v[82:83], v135 offset:37888
    v_mfma_f32_32x32x16_bf16 v[16:31], v[96:99], v[68:71], v[16:31]
    ds_read_b64_tr_b16 v[84:85], v136 offset:36864
    ds_read_b64_tr_b16 v[86:87], v136 offset:37888
    ds_read_b64_tr_b16 v[88:89], v137 offset:36864
    v_mfma_f32_32x32x16_bf16 v[32:47], v[96:99], v[72:75], v[32:47]
    ds_read_b64_tr_b16 v[90:91], v137 offset:37888
    ds_read_b64_tr_b16 v[92:93], v138 offset:36864
    ds_read_b64_tr_b16 v[94:95], v138 offset:37888
    v_mfma_f32_32x32x16_bf16 v[48:63], v[96:99], v[76:79], v[48:63]
    s_waitcnt lgkmcnt(0)
    v_mfma_f32_32x32x16_bf16 v[0:15], v[100:103], v[80:83], v[0:15]
    ds_read_b128 v[96:99], v133 offset:32768
    ds_read_b64_tr_b16 v[64:65], v135 offset:40960
    ds_read_b64_tr_b16 v[66:67], v135 offset:41984
    v_mfma_f32_32x32x16_bf16 v[16:31], v[100:103], v[84:87], v[16:31]
    ds_read_b64_tr_b16 v[68:69], v136 offset:40960
    ds_read_b64_tr_b16 v[70:71], v136 offset:41984
    ds_read_b64_tr_b16 v[72:73], v137 offset:40960
    v_mfma_f32_32x32x16_bf16 v[32:47], v[100:103], v[88:91], v[32:47]
    ds_read_b64_tr_b16 v[74:75], v137 offset:41984
    ds_read_b64_tr_b16 v[76:77], v138 offset:40960
    ds_read_b64_tr_b16 v[78:79], v138 offset:41984
    v_mfma_f32_32x32x16_bf16 v[48:63], v[100:103], v[92:95], v[48:63]
    s_waitcnt lgkmcnt(0)
    v_mfma_f32_32x32x16_bf16 v[0:15], v[96:99], v[64:67], v[0:15]
    ds_read_b128 v[100:103], v134 offset:32768
    ds_read_b64_tr_b16 v[80:81], v135 offset:45056
    ds_read_b64_tr_b16 v[82:83], v135 offset:46080
    v_mfma_f32_32x32x16_bf16 v[16:31], v[96:99], v[68:71], v[16:31]
    ds_read_b64_tr_b16 v[84:85], v136 offset:45056
    ds_read_b64_tr_b16 v[86:87], v136 offset:46080
    ds_read_b64_tr_b16 v[88:89], v137 offset:45056
    v_mfma_f32_32x32x16_bf16 v[32:47], v[96:99], v[72:75], v[32:47]
    ds_read_b64_tr_b16 v[90:91], v137 offset:46080
    ds_read_b64_tr_b16 v[92:93], v138 offset:45056
    ds_read_b64_tr_b16 v[94:95], v138 offset:46080
    v_mfma_f32_32x32x16_bf16 v[48:63], v[96:99], v[76:79], v[48:63]
    s_waitcnt lgkmcnt(0)
    s_barrier
    v_mfma_f32_32x32x16_bf16 v[0:15], v[100:103], v[80:83], v[0:15]
    v_xor_b32 v131, 0x10000, v131
    v_xor_b32 v132, 0x10000, v132
    v_xor_b32 v133, 0x10000, v133
    v_xor_b32 v134, 0x10000, v134
    v_xor_b32 v135, 0x10000, v135
    v_xor_b32 v136, 0x10000, v136
    v_xor_b32 v137, 0x10000, v137
    v_xor_b32 v138, 0x10000, v138
    ds_read_b128 v[96:99], v131 offset:0
    ds_read_b64_tr_b16 v[64:65], v135 offset:0
    ds_read_b64_tr_b16 v[66:67], v135 offset:1024
    v_mfma_f32_32x32x16_bf16 v[16:31], v[100:103], v[84:87], v[16:31]
    ds_read_b64_tr_b16 v[68:69], v136 offset:0
    ds_read_b64_tr_b16 v[70:71], v136 offset:1024
    ds_read_b64_tr_b16 v[72:73], v137 offset:0
    v_mfma_f32_32x32x16_bf16 v[32:47], v[100:103], v[88:91], v[32:47]
    ds_read_b64_tr_b16 v[74:75], v137 offset:1024
    ds_read_b64_tr_b16 v[76:77], v138 offset:0
    ds_read_b64_tr_b16 v[78:79], v138 offset:1024
    v_mfma_f32_32x32x16_bf16 v[48:63], v[100:103], v[92:95], v[48:63]
    s_waitcnt lgkmcnt(0)
    v_mfma_f32_32x32x16_bf16 v[0:15], v[96:99], v[64:67], v[0:15]
    ds_read_b128 v[100:103], v132 offset:0
    ds_read_b64_tr_b16 v[80:81], v135 offset:4096
    ds_read_b64_tr_b16 v[82:83], v135 offset:5120
    v_mfma_f32_32x32x16_bf16 v[16:31], v[96:99], v[68:71], v[16:31]
    ds_read_b64_tr_b16 v[84:85], v136 offset:4096
    ds_read_b64_tr_b16 v[86:87], v136 offset:5120
    ds_read_b64_tr_b16 v[88:89], v137 offset:4096
    v_mfma_f32_32x32x16_bf16 v[32:47], v[96:99], v[72:75], v[32:47]
    ds_read_b64_tr_b16 v[90:91], v137 offset:5120
    ds_read_b64_tr_b16 v[92:93], v138 offset:4096
    ds_read_b64_tr_b16 v[94:95], v138 offset:5120
    v_mfma_f32_32x32x16_bf16 v[48:63], v[96:99], v[76:79], v[48:63]
    s_waitcnt lgkmcnt(0)
    v_mfma_f32_32x32x16_bf16 v[0:15], v[100:103], v[80:83], v[0:15]
    ds_read_b128 v[96:99], v133 offset:0
    ds_read_b64_tr_b16 v[64:65], v135 offset:8192
    ds_read_b64_tr_b16 v[66:67], v135 offset:9216
    v_mfma_f32_32x32x16_bf16 v[16:31], v[100:103], v[84:87], v[16:31]
    ds_read_b64_tr_b16 v[68:69], v136 offset:8192
    ds_read_b64_tr_b16 v[70:71], v136 offset:9216
    ds_read_b64_tr_b16 v[72:73], v137 offset:8192
    v_mfma_f32_32x32x16_bf16 v[32:47], v[100:103], v[88:91], v[32:47]
    ds_read_b64_tr_b16 v[74:75], v137 offset:9216
    ds_read_b64_tr_b16 v[76:77], v138 offset:8192
    ds_read_b64_tr_b16 v[78:79], v138 offset:9216
    v_mfma_f32_32x32x16_bf16 v[48:63], v[100:103], v[92:95], v[48:63]
    s_waitcnt lgkmcnt(0)
    v_mfma_f32_32x32x16_bf16 v[0:15], v[96:99], v[64:67], v[0:15]
    ds_read_b128 v[100:103], v134 offset:0
    ds_read_b64_tr_b16 v[80:81], v135 offset:12288
    ds_read_b64_tr_b16 v[82:83], v135 offset:13312
    v_mfma_f32_32x32x16_bf16 v[16:31], v[96:99], v[68:71], v[16:31]
    ds_read_b64_tr_b16 v[84:85], v136 offset:12288
    ds_read_b64_tr_b16 v[86:87], v136 offset:13312
    ds_read_b64_tr_b16 v[88:89], v137 offset:12288
    v_mfma_f32_32x32x16_bf16 v[32:47], v[96:99], v[72:75], v[32:47]
    ds_read_b64_tr_b16 v[90:91], v137 offset:13312
    ds_read_b64_tr_b16 v[92:93], v138 offset:12288
    ds_read_b64_tr_b16 v[94:95], v138 offset:13312
    v_mfma_f32_32x32x16_bf16 v[48:63], v[96:99], v[76:79], v[48:63]
    s_waitcnt lgkmcnt(0)
    s_barrier
    v_mfma_f32_32x32x16_bf16 v[0:15], v[100:103], v[80:83], v[0:15]
    ds_read_b128 v[96:99], v131 offset:32768
    ds_read_b64_tr_b16 v[64:65], v135 offset:32768
    ds_read_b64_tr_b16 v[66:67], v135 offset:33792
    v_mfma_f32_32x32x16_bf16 v[16:31], v[100:103], v[84:87], v[16:31]
    ds_read_b64_tr_b16 v[68:69], v136 offset:32768
    ds_read_b64_tr_b16 v[70:71], v136 offset:33792
    ds_read_b64_tr_b16 v[72:73], v137 offset:32768
    v_mfma_f32_32x32x16_bf16 v[32:47], v[100:103], v[88:91], v[32:47]
    ds_read_b64_tr_b16 v[74:75], v137 offset:33792
    ds_read_b64_tr_b16 v[76:77], v138 offset:32768
    ds_read_b64_tr_b16 v[78:79], v138 offset:33792
    v_mfma_f32_32x32x16_bf16 v[48:63], v[100:103], v[92:95], v[48:63]
    s_waitcnt lgkmcnt(0)
    v_mfma_f32_32x32x16_bf16 v[0:15], v[96:99], v[64:67], v[0:15]
    ds_read_b128 v[100:103], v132 offset:32768
    ds_read_b64_tr_b16 v[80:81], v135 offset:36864
    ds_read_b64_tr_b16 v[82:83], v135 offset:37888
    v_mfma_f32_32x32x16_bf16 v[16:31], v[96:99], v[68:71], v[16:31]
    ds_read_b64_tr_b16 v[84:85], v136 offset:36864
    ds_read_b64_tr_b16 v[86:87], v136 offset:37888
    ds_read_b64_tr_b16 v[88:89], v137 offset:36864
    v_mfma_f32_32x32x16_bf16 v[32:47], v[96:99], v[72:75], v[32:47]
    ds_read_b64_tr_b16 v[90:91], v137 offset:37888
    ds_read_b64_tr_b16 v[92:93], v138 offset:36864
    ds_read_b64_tr_b16 v[94:95], v138 offset:37888
    v_mfma_f32_32x32x16_bf16 v[48:63], v[96:99], v[76:79], v[48:63]
    s_waitcnt lgkmcnt(0)
    v_mfma_f32_32x32x16_bf16 v[0:15], v[100:103], v[80:83], v[0:15]
    ds_read_b128 v[96:99], v133 offset:32768
    ds_read_b64_tr_b16 v[64:65], v135 offset:40960
    ds_read_b64_tr_b16 v[66:67], v135 offset:41984
    v_mfma_f32_32x32x16_bf16 v[16:31], v[100:103], v[84:87], v[16:31]
    ds_read_b64_tr_b16 v[68:69], v136 offset:40960
    ds_read_b64_tr_b16 v[70:71], v136 offset:41984
    ds_read_b64_tr_b16 v[72:73], v137 offset:40960
    v_mfma_f32_32x32x16_bf16 v[32:47], v[100:103], v[88:91], v[32:47]
    ds_read_b64_tr_b16 v[74:75], v137 offset:41984
    ds_read_b64_tr_b16 v[76:77], v138 offset:40960
    ds_read_b64_tr_b16 v[78:79], v138 offset:41984
    v_mfma_f32_32x32x16_bf16 v[48:63], v[100:103], v[92:95], v[48:63]
    s_waitcnt lgkmcnt(0)
    v_mfma_f32_32x32x16_bf16 v[0:15], v[96:99], v[64:67], v[0:15]
    ds_read_b128 v[100:103], v134 offset:32768
    ds_read_b64_tr_b16 v[80:81], v135 offset:45056
    ds_read_b64_tr_b16 v[82:83], v135 offset:46080
    v_mfma_f32_32x32x16_bf16 v[16:31], v[96:99], v[68:71], v[16:31]
    ds_read_b64_tr_b16 v[84:85], v136 offset:45056
    ds_read_b64_tr_b16 v[86:87], v136 offset:46080
    ds_read_b64_tr_b16 v[88:89], v137 offset:45056
    v_mfma_f32_32x32x16_bf16 v[32:47], v[96:99], v[72:75], v[32:47]
    ds_read_b64_tr_b16 v[90:91], v137 offset:46080
    ds_read_b64_tr_b16 v[92:93], v138 offset:45056
    ds_read_b64_tr_b16 v[94:95], v138 offset:46080
    v_mfma_f32_32x32x16_bf16 v[48:63], v[96:99], v[76:79], v[48:63]
    s_waitcnt lgkmcnt(0)
    s_barrier
    v_mfma_f32_32x32x16_bf16 v[0:15], v[100:103], v[80:83], v[0:15]
    v_xor_b32 v131, 0x10000, v131
    v_xor_b32 v132, 0x10000, v132
    v_xor_b32 v133, 0x10000, v133
    v_xor_b32 v134, 0x10000, v134
    v_xor_b32 v135, 0x10000, v135
    v_xor_b32 v136, 0x10000, v136
    v_xor_b32 v137, 0x10000, v137
    v_xor_b32 v138, 0x10000, v138
    ds_read_b128 v[96:99], v131 offset:0
    ds_read_b64_tr_b16 v[64:65], v135 offset:0
    ds_read_b64_tr_b16 v[66:67], v135 offset:1024
    v_mfma_f32_32x32x16_bf16 v[16:31], v[100:103], v[84:87], v[16:31]
    ds_read_b64_tr_b16 v[68:69], v136 offset:0
    ds_read_b64_tr_b16 v[70:71], v136 offset:1024
    ds_read_b64_tr_b16 v[72:73], v137 offset:0
    v_mfma_f32_32x32x16_bf16 v[32:47], v[100:103], v[88:91], v[32:47]
    ds_read_b64_tr_b16 v[74:75], v137 offset:1024
    ds_read_b64_tr_b16 v[76:77], v138 offset:0
    ds_read_b64_tr_b16 v[78:79], v138 offset:1024
    v_mfma_f32_32x32x16_bf16 v[48:63], v[100:103], v[92:95], v[48:63]
    s_waitcnt lgkmcnt(0)
    v_mfma_f32_32x32x16_bf16 v[0:15], v[96:99], v[64:67], v[0:15]
    ds_read_b128 v[100:103], v132 offset:0
    ds_read_b64_tr_b16 v[80:81], v135 offset:4096
    ds_read_b64_tr_b16 v[82:83], v135 offset:5120
    v_mfma_f32_32x32x16_bf16 v[16:31], v[96:99], v[68:71], v[16:31]
    ds_read_b64_tr_b16 v[84:85], v136 offset:4096
    ds_read_b64_tr_b16 v[86:87], v136 offset:5120
    ds_read_b64_tr_b16 v[88:89], v137 offset:4096
    v_mfma_f32_32x32x16_bf16 v[32:47], v[96:99], v[72:75], v[32:47]
    ds_read_b64_tr_b16 v[90:91], v137 offset:5120
    ds_read_b64_tr_b16 v[92:93], v138 offset:4096
    ds_read_b64_tr_b16 v[94:95], v138 offset:5120
    v_mfma_f32_32x32x16_bf16 v[48:63], v[96:99], v[76:79], v[48:63]
    s_waitcnt lgkmcnt(0)
    v_mfma_f32_32x32x16_bf16 v[0:15], v[100:103], v[80:83], v[0:15]
    ds_read_b128 v[96:99], v133 offset:0
    ds_read_b64_tr_b16 v[64:65], v135 offset:8192
    ds_read_b64_tr_b16 v[66:67], v135 offset:9216
    v_mfma_f32_32x32x16_bf16 v[16:31], v[100:103], v[84:87], v[16:31]
    ds_read_b64_tr_b16 v[68:69], v136 offset:8192
    ds_read_b64_tr_b16 v[70:71], v136 offset:9216
    ds_read_b64_tr_b16 v[72:73], v137 offset:8192
    v_mfma_f32_32x32x16_bf16 v[32:47], v[100:103], v[88:91], v[32:47]
    ds_read_b64_tr_b16 v[74:75], v137 offset:9216
    ds_read_b64_tr_b16 v[76:77], v138 offset:8192
    ds_read_b64_tr_b16 v[78:79], v138 offset:9216
    v_mfma_f32_32x32x16_bf16 v[48:63], v[100:103], v[92:95], v[48:63]
    s_waitcnt lgkmcnt(0)
    v_mfma_f32_32x32x16_bf16 v[0:15], v[96:99], v[64:67], v[0:15]
    ds_read_b128 v[100:103], v134 offset:0
    ds_read_b64_tr_b16 v[80:81], v135 offset:12288
    ds_read_b64_tr_b16 v[82:83], v135 offset:13312
    v_mfma_f32_32x32x16_bf16 v[16:31], v[96:99], v[68:71], v[16:31]
    ds_read_b64_tr_b16 v[84:85], v136 offset:12288
    ds_read_b64_tr_b16 v[86:87], v136 offset:13312
    ds_read_b64_tr_b16 v[88:89], v137 offset:12288
    v_mfma_f32_32x32x16_bf16 v[32:47], v[96:99], v[72:75], v[32:47]
    ds_read_b64_tr_b16 v[90:91], v137 offset:13312
    ds_read_b64_tr_b16 v[92:93], v138 offset:12288
    ds_read_b64_tr_b16 v[94:95], v138 offset:13312
    v_mfma_f32_32x32x16_bf16 v[48:63], v[96:99], v[76:79], v[48:63]
    s_waitcnt lgkmcnt(0)
    s_barrier
    v_mfma_f32_32x32x16_bf16 v[0:15], v[100:103], v[80:83], v[0:15]
    ds_read_b128 v[96:99], v131 offset:32768
    ds_read_b64_tr_b16 v[64:65], v135 offset:32768
    ds_read_b64_tr_b16 v[66:67], v135 offset:33792
    v_mfma_f32_32x32x16_bf16 v[16:31], v[100:103], v[84:87], v[16:31]
    ds_read_b64_tr_b16 v[68:69], v136 offset:32768
    ds_read_b64_tr_b16 v[70:71], v136 offset:33792
    ds_read_b64_tr_b16 v[72:73], v137 offset:32768
    v_mfma_f32_32x32x16_bf16 v[32:47], v[100:103], v[88:91], v[32:47]
    ds_read_b64_tr_b16 v[74:75], v137 offset:33792
    ds_read_b64_tr_b16 v[76:77], v138 offset:32768
    ds_read_b64_tr_b16 v[78:79], v138 offset:33792
    v_mfma_f32_32x32x16_bf16 v[48:63], v[100:103], v[92:95], v[48:63]
    s_waitcnt lgkmcnt(0)
    v_mfma_f32_32x32x16_bf16 v[0:15], v[96:99], v[64:67], v[0:15]
    ds_read_b128 v[100:103], v132 offset:32768
    ds_read_b64_tr_b16 v[80:81], v135 offset:36864
    ds_read_b64_tr_b16 v[82:83], v135 offset:37888
    v_mfma_f32_32x32x16_bf16 v[16:31], v[96:99], v[68:71], v[16:31]
    ds_read_b64_tr_b16 v[84:85], v136 offset:36864
    ds_read_b64_tr_b16 v[86:87], v136 offset:37888
    ds_read_b64_tr_b16 v[88:89], v137 offset:36864
    v_mfma_f32_32x32x16_bf16 v[32:47], v[96:99], v[72:75], v[32:47]
    ds_read_b64_tr_b16 v[90:91], v137 offset:37888
    ds_read_b64_tr_b16 v[92:93], v138 offset:36864
    ds_read_b64_tr_b16 v[94:95], v138 offset:37888
    v_mfma_f32_32x32x16_bf16 v[48:63], v[96:99], v[76:79], v[48:63]
    s_waitcnt lgkmcnt(0)
    v_mfma_f32_32x32x16_bf16 v[0:15], v[100:103], v[80:83], v[0:15]
    ds_read_b128 v[96:99], v133 offset:32768
    ds_read_b64_tr_b16 v[64:65], v135 offset:40960
    ds_read_b64_tr_b16 v[66:67], v135 offset:41984
    v_mfma_f32_32x32x16_bf16 v[16:31], v[100:103], v[84:87], v[16:31]
    ds_read_b64_tr_b16 v[68:69], v136 offset:40960
    ds_read_b64_tr_b16 v[70:71], v136 offset:41984
    ds_read_b64_tr_b16 v[72:73], v137 offset:40960
    v_mfma_f32_32x32x16_bf16 v[32:47], v[100:103], v[88:91], v[32:47]
    ds_read_b64_tr_b16 v[74:75], v137 offset:41984
    ds_read_b64_tr_b16 v[76:77], v138 offset:40960
    ds_read_b64_tr_b16 v[78:79], v138 offset:41984
    v_mfma_f32_32x32x16_bf16 v[48:63], v[100:103], v[92:95], v[48:63]
    s_waitcnt lgkmcnt(0)
    v_mfma_f32_32x32x16_bf16 v[0:15], v[96:99], v[64:67], v[0:15]
    ds_read_b128 v[100:103], v134 offset:32768
    ds_read_b64_tr_b16 v[80:81], v135 offset:45056
    ds_read_b64_tr_b16 v[82:83], v135 offset:46080
    v_mfma_f32_32x32x16_bf16 v[16:31], v[96:99], v[68:71], v[16:31]
    ds_read_b64_tr_b16 v[84:85], v136 offset:45056
    ds_read_b64_tr_b16 v[86:87], v136 offset:46080
    ds_read_b64_tr_b16 v[88:89], v137 offset:45056
    v_mfma_f32_32x32x16_bf16 v[32:47], v[96:99], v[72:75], v[32:47]
    ds_read_b64_tr_b16 v[90:91], v137 offset:46080
    ds_read_b64_tr_b16 v[92:93], v138 offset:45056
    ds_read_b64_tr_b16 v[94:95], v138 offset:46080
    v_mfma_f32_32x32x16_bf16 v[48:63], v[96:99], v[76:79], v[48:63]
    s_waitcnt lgkmcnt(0)
    s_barrier
    v_mfma_f32_32x32x16_bf16 v[0:15], v[100:103], v[80:83], v[0:15]
    v_xor_b32 v131, 0x10000, v131
    v_xor_b32 v132, 0x10000, v132
    v_xor_b32 v133, 0x10000, v133
    v_xor_b32 v134, 0x10000, v134
    v_xor_b32 v135, 0x10000, v135
    v_xor_b32 v136, 0x10000, v136
    v_xor_b32 v137, 0x10000, v137
    v_xor_b32 v138, 0x10000, v138
    ds_read_b128 v[96:99], v131 offset:0
    ds_read_b64_tr_b16 v[64:65], v135 offset:0
    ds_read_b64_tr_b16 v[66:67], v135 offset:1024
    v_mfma_f32_32x32x16_bf16 v[16:31], v[100:103], v[84:87], v[16:31]
    ds_read_b64_tr_b16 v[68:69], v136 offset:0
    ds_read_b64_tr_b16 v[70:71], v136 offset:1024
    ds_read_b64_tr_b16 v[72:73], v137 offset:0
    v_mfma_f32_32x32x16_bf16 v[32:47], v[100:103], v[88:91], v[32:47]
    ds_read_b64_tr_b16 v[74:75], v137 offset:1024
    ds_read_b64_tr_b16 v[76:77], v138 offset:0
    ds_read_b64_tr_b16 v[78:79], v138 offset:1024
    v_mfma_f32_32x32x16_bf16 v[48:63], v[100:103], v[92:95], v[48:63]
    s_waitcnt lgkmcnt(0)
    v_mfma_f32_32x32x16_bf16 v[0:15], v[96:99], v[64:67], v[0:15]
    ds_read_b128 v[100:103], v132 offset:0
    ds_read_b64_tr_b16 v[80:81], v135 offset:4096
    ds_read_b64_tr_b16 v[82:83], v135 offset:5120
    v_mfma_f32_32x32x16_bf16 v[16:31], v[96:99], v[68:71], v[16:31]
    ds_read_b64_tr_b16 v[84:85], v136 offset:4096
    ds_read_b64_tr_b16 v[86:87], v136 offset:5120
    ds_read_b64_tr_b16 v[88:89], v137 offset:4096
    v_mfma_f32_32x32x16_bf16 v[32:47], v[96:99], v[72:75], v[32:47]
    ds_read_b64_tr_b16 v[90:91], v137 offset:5120
    ds_read_b64_tr_b16 v[92:93], v138 offset:4096
    ds_read_b64_tr_b16 v[94:95], v138 offset:5120
    v_mfma_f32_32x32x16_bf16 v[48:63], v[96:99], v[76:79], v[48:63]
    s_waitcnt lgkmcnt(0)
    v_mfma_f32_32x32x16_bf16 v[0:15], v[100:103], v[80:83], v[0:15]
    ds_read_b128 v[96:99], v133 offset:0
    ds_read_b64_tr_b16 v[64:65], v135 offset:8192
    ds_read_b64_tr_b16 v[66:67], v135 offset:9216
    v_mfma_f32_32x32x16_bf16 v[16:31], v[100:103], v[84:87], v[16:31]
    ds_read_b64_tr_b16 v[68:69], v136 offset:8192
    ds_read_b64_tr_b16 v[70:71], v136 offset:9216
    ds_read_b64_tr_b16 v[72:73], v137 offset:8192
    v_mfma_f32_32x32x16_bf16 v[32:47], v[100:103], v[88:91], v[32:47]
    ds_read_b64_tr_b16 v[74:75], v137 offset:9216
    ds_read_b64_tr_b16 v[76:77], v138 offset:8192
    ds_read_b64_tr_b16 v[78:79], v138 offset:9216
    v_mfma_f32_32x32x16_bf16 v[48:63], v[100:103], v[92:95], v[48:63]
    s_waitcnt lgkmcnt(0)
    v_mfma_f32_32x32x16_bf16 v[0:15], v[96:99], v[64:67], v[0:15]
    ds_read_b128 v[100:103], v134 offset:0
    ds_read_b64_tr_b16 v[80:81], v135 offset:12288
    ds_read_b64_tr_b16 v[82:83], v135 offset:13312
    v_mfma_f32_32x32x16_bf16 v[16:31], v[96:99], v[68:71], v[16:31]
    ds_read_b64_tr_b16 v[84:85], v136 offset:12288
    ds_read_b64_tr_b16 v[86:87], v136 offset:13312
    ds_read_b64_tr_b16 v[88:89], v137 offset:12288
    v_mfma_f32_32x32x16_bf16 v[32:47], v[96:99], v[72:75], v[32:47]
    ds_read_b64_tr_b16 v[90:91], v137 offset:13312
    ds_read_b64_tr_b16 v[92:93], v138 offset:12288
    ds_read_b64_tr_b16 v[94:95], v138 offset:13312
    v_mfma_f32_32x32x16_bf16 v[48:63], v[96:99], v[76:79], v[48:63]
    s_waitcnt lgkmcnt(0)
    s_barrier
    v_mfma_f32_32x32x16_bf16 v[0:15], v[100:103], v[80:83], v[0:15]
    ds_read_b128 v[96:99], v131 offset:32768
    ds_read_b64_tr_b16 v[64:65], v135 offset:32768
    ds_read_b64_tr_b16 v[66:67], v135 offset:33792
    v_mfma_f32_32x32x16_bf16 v[16:31], v[100:103], v[84:87], v[16:31]
    ds_read_b64_tr_b16 v[68:69], v136 offset:32768
    ds_read_b64_tr_b16 v[70:71], v136 offset:33792
    ds_read_b64_tr_b16 v[72:73], v137 offset:32768
    v_mfma_f32_32x32x16_bf16 v[32:47], v[100:103], v[88:91], v[32:47]
    ds_read_b64_tr_b16 v[74:75], v137 offset:33792
    ds_read_b64_tr_b16 v[76:77], v138 offset:32768
    ds_read_b64_tr_b16 v[78:79], v138 offset:33792
    v_mfma_f32_32x32x16_bf16 v[48:63], v[100:103], v[92:95], v[48:63]
    s_waitcnt lgkmcnt(0)
    v_mfma_f32_32x32x16_bf16 v[0:15], v[96:99], v[64:67], v[0:15]
    ds_read_b128 v[100:103], v132 offset:32768
    ds_read_b64_tr_b16 v[80:81], v135 offset:36864
    ds_read_b64_tr_b16 v[82:83], v135 offset:37888
    v_mfma_f32_32x32x16_bf16 v[16:31], v[96:99], v[68:71], v[16:31]
    ds_read_b64_tr_b16 v[84:85], v136 offset:36864
    ds_read_b64_tr_b16 v[86:87], v136 offset:37888
    ds_read_b64_tr_b16 v[88:89], v137 offset:36864
    v_mfma_f32_32x32x16_bf16 v[32:47], v[96:99], v[72:75], v[32:47]
    ds_read_b64_tr_b16 v[90:91], v137 offset:37888
    ds_read_b64_tr_b16 v[92:93], v138 offset:36864
    ds_read_b64_tr_b16 v[94:95], v138 offset:37888
    v_mfma_f32_32x32x16_bf16 v[48:63], v[96:99], v[76:79], v[48:63]
    s_waitcnt lgkmcnt(0)
    v_mfma_f32_32x32x16_bf16 v[0:15], v[100:103], v[80:83], v[0:15]
    ds_read_b128 v[96:99], v133 offset:32768
    ds_read_b64_tr_b16 v[64:65], v135 offset:40960
    ds_read_b64_tr_b16 v[66:67], v135 offset:41984
    v_mfma_f32_32x32x16_bf16 v[16:31], v[100:103], v[84:87], v[16:31]
    ds_read_b64_tr_b16 v[68:69], v136 offset:40960
    ds_read_b64_tr_b16 v[70:71], v136 offset:41984
    ds_read_b64_tr_b16 v[72:73], v137 offset:40960
    v_mfma_f32_32x32x16_bf16 v[32:47], v[100:103], v[88:91], v[32:47]
    ds_read_b64_tr_b16 v[74:75], v137 offset:41984
    ds_read_b64_tr_b16 v[76:77], v138 offset:40960
    ds_read_b64_tr_b16 v[78:79], v138 offset:41984
    v_mfma_f32_32x32x16_bf16 v[48:63], v[100:103], v[92:95], v[48:63]
    s_waitcnt lgkmcnt(0)
    v_mfma_f32_32x32x16_bf16 v[0:15], v[96:99], v[64:67], v[0:15]
    ds_read_b128 v[100:103], v134 offset:32768
    ds_read_b64_tr_b16 v[80:81], v135 offset:45056
    ds_read_b64_tr_b16 v[82:83], v135 offset:46080
    v_mfma_f32_32x32x16_bf16 v[16:31], v[96:99], v[68:71], v[16:31]
    ds_read_b64_tr_b16 v[84:85], v136 offset:45056
    ds_read_b64_tr_b16 v[86:87], v136 offset:46080
    ds_read_b64_tr_b16 v[88:89], v137 offset:45056
    v_mfma_f32_32x32x16_bf16 v[32:47], v[96:99], v[72:75], v[32:47]
    ds_read_b64_tr_b16 v[90:91], v137 offset:46080
    ds_read_b64_tr_b16 v[92:93], v138 offset:45056
    ds_read_b64_tr_b16 v[94:95], v138 offset:46080
    v_mfma_f32_32x32x16_bf16 v[48:63], v[96:99], v[76:79], v[48:63]
    s_waitcnt lgkmcnt(0)
    v_mfma_f32_32x32x16_bf16 v[0:15], v[100:103], v[80:83], v[0:15]
    v_mfma_f32_32x32x16_bf16 v[16:31], v[100:103], v[84:87], v[16:31]
    v_mfma_f32_32x32x16_bf16 v[32:47], v[100:103], v[88:91], v[32:47]
    v_mfma_f32_32x32x16_bf16 v[48:63], v[100:103], v[92:95], v[48:63]
    s_lshl_b32 s30, s3, 8
    s_add_u32 s30, s30, 131072
    v_lshl_add_u32 v149, v121, 4, s30
    v_lshlrev_b32 v148, 2, v122
    v_add_u32 v148, 131072, v148
    ds_read_b128 v[150:153], v149 offset:0
    ds_read_b128 v[166:169], v149 offset:128
    ds_read_b128 v[154:157], v149 offset:32
    ds_read_b128 v[170:173], v149 offset:160
    ds_read_b128 v[158:161], v149 offset:64
    ds_read_b128 v[174:177], v149 offset:192
    ds_read_b128 v[162:165], v149 offset:96
    ds_read_b128 v[178:181], v149 offset:224
    ds_read_b32 v182, v148 offset:2048
    ds_read_b32 v184, v148 offset:2176
    ds_read_b32 v186, v148 offset:2304
    ds_read_b32 v188, v148 offset:2432
    s_waitcnt lgkmcnt(3)
    v_pk_fma_f32 v[0:1], v[150:151], v[182:183], v[0:1] op_sel_hi:[1,0,1]
    v_pk_fma_f32 v[2:3], v[152:153], v[182:183], v[2:3] op_sel_hi:[1,0,1]
    v_pk_fma_f32 v[4:5], v[154:155], v[182:183], v[4:5] op_sel_hi:[1,0,1]
    v_pk_fma_f32 v[6:7], v[156:157], v[182:183], v[6:7] op_sel_hi:[1,0,1]
    v_pk_fma_f32 v[8:9], v[158:159], v[182:183], v[8:9] op_sel_hi:[1,0,1]
    v_pk_fma_f32 v[10:11], v[160:161], v[182:183], v[10:11] op_sel_hi:[1,0,1]
    v_pk_fma_f32 v[12:13], v[162:163], v[182:183], v[12:13] op_sel_hi:[1,0,1]
    v_pk_fma_f32 v[14:15], v[164:165], v[182:183], v[14:15] op_sel_hi:[1,0,1]
    v_pk_mul_f32 v[0:1], v[0:1], v[166:167]
    v_pk_mul_f32 v[2:3], v[2:3], v[168:169]
    v_pk_mul_f32 v[4:5], v[4:5], v[170:171]
    v_pk_mul_f32 v[6:7], v[6:7], v[172:173]
    v_pk_mul_f32 v[8:9], v[8:9], v[174:175]
    v_pk_mul_f32 v[10:11], v[10:11], v[176:177]
    v_pk_mul_f32 v[12:13], v[12:13], v[178:179]
    v_pk_mul_f32 v[14:15], v[14:15], v[180:181]
    v_cvt_pk_bf16_f32 v64, v0, v1
    v_cvt_pk_bf16_f32 v65, v2, v3
    v_cvt_pk_bf16_f32 v66, v4, v5
    v_cvt_pk_bf16_f32 v67, v6, v7
    v_cvt_pk_bf16_f32 v68, v8, v9
    v_cvt_pk_bf16_f32 v69, v10, v11
    v_cvt_pk_bf16_f32 v70, v12, v13
    v_cvt_pk_bf16_f32 v71, v14, v15
    buffer_store_dwordx4 v[64:67], v104, s[20:23], s37 offen offset:0 sc1
    buffer_store_dwordx4 v[68:71], v104, s[20:23], s37 offen offset:640 sc1
    s_waitcnt lgkmcnt(2)
    v_pk_fma_f32 v[16:17], v[150:151], v[184:185], v[16:17] op_sel_hi:[1,0,1]
    v_pk_fma_f32 v[18:19], v[152:153], v[184:185], v[18:19] op_sel_hi:[1,0,1]
    v_pk_fma_f32 v[20:21], v[154:155], v[184:185], v[20:21] op_sel_hi:[1,0,1]
    v_pk_fma_f32 v[22:23], v[156:157], v[184:185], v[22:23] op_sel_hi:[1,0,1]
    v_pk_fma_f32 v[24:25], v[158:159], v[184:185], v[24:25] op_sel_hi:[1,0,1]
    v_pk_fma_f32 v[26:27], v[160:161], v[184:185], v[26:27] op_sel_hi:[1,0,1]
    v_pk_fma_f32 v[28:29], v[162:163], v[184:185], v[28:29] op_sel_hi:[1,0,1]
    v_pk_fma_f32 v[30:31], v[164:165], v[184:185], v[30:31] op_sel_hi:[1,0,1]
    v_pk_mul_f32 v[16:17], v[16:17], v[166:167]
    v_pk_mul_f32 v[18:19], v[18:19], v[168:169]
    v_pk_mul_f32 v[20:21], v[20:21], v[170:171]
    v_pk_mul_f32 v[22:23], v[22:23], v[172:173]
    v_pk_mul_f32 v[24:25], v[24:25], v[174:175]
    v_pk_mul_f32 v[26:27], v[26:27], v[176:177]
    v_pk_mul_f32 v[28:29], v[28:29], v[178:179]
    v_pk_mul_f32 v[30:31], v[30:31], v[180:181]
    v_cvt_pk_bf16_f32 v72, v16, v17
    v_cvt_pk_bf16_f32 v73, v18, v19
    v_cvt_pk_bf16_f32 v74, v20, v21
    v_cvt_pk_bf16_f32 v75, v22, v23
    v_cvt_pk_bf16_f32 v76, v24, v25
    v_cvt_pk_bf16_f32 v77, v26, v27
    v_cvt_pk_bf16_f32 v78, v28, v29
    v_cvt_pk_bf16_f32 v79, v30, v31
    buffer_store_dwordx4 v[72:75], v105, s[20:23], s37 offen offset:0 sc1
    buffer_store_dwordx4 v[76:79], v105, s[20:23], s37 offen offset:640 sc1
    s_waitcnt lgkmcnt(1)
    v_pk_fma_f32 v[32:33], v[150:151], v[186:187], v[32:33] op_sel_hi:[1,0,1]
    v_pk_fma_f32 v[34:35], v[152:153], v[186:187], v[34:35] op_sel_hi:[1,0,1]
    v_pk_fma_f32 v[36:37], v[154:155], v[186:187], v[36:37] op_sel_hi:[1,0,1]
    v_pk_fma_f32 v[38:39], v[156:157], v[186:187], v[38:39] op_sel_hi:[1,0,1]
    v_pk_fma_f32 v[40:41], v[158:159], v[186:187], v[40:41] op_sel_hi:[1,0,1]
    v_pk_fma_f32 v[42:43], v[160:161], v[186:187], v[42:43] op_sel_hi:[1,0,1]
    v_pk_fma_f32 v[44:45], v[162:163], v[186:187], v[44:45] op_sel_hi:[1,0,1]
    v_pk_fma_f32 v[46:47], v[164:165], v[186:187], v[46:47] op_sel_hi:[1,0,1]
    v_pk_mul_f32 v[32:33], v[32:33], v[166:167]
    v_pk_mul_f32 v[34:35], v[34:35], v[168:169]
    v_pk_mul_f32 v[36:37], v[36:37], v[170:171]
    v_pk_mul_f32 v[38:39], v[38:39], v[172:173]
    v_pk_mul_f32 v[40:41], v[40:41], v[174:175]
    v_pk_mul_f32 v[42:43], v[42:43], v[176:177]
    v_pk_mul_f32 v[44:45], v[44:45], v[178:179]
    v_pk_mul_f32 v[46:47], v[46:47], v[180:181]
    v_cvt_pk_bf16_f32 v80, v32, v33
    v_cvt_pk_bf16_f32 v81, v34, v35
    v_cvt_pk_bf16_f32 v82, v36, v37
    v_cvt_pk_bf16_f32 v83, v38, v39
    v_cvt_pk_bf16_f32 v84, v40, v41
    v_cvt_pk_bf16_f32 v85, v42, v43
    v_cvt_pk_bf16_f32 v86, v44, v45
    v_cvt_pk_bf16_f32 v87, v46, v47
    buffer_store_dwordx4 v[80:83], v106, s[20:23], s37 offen offset:0 sc1
    buffer_store_dwordx4 v[84:87], v106, s[20:23], s37 offen offset:640 sc1
    s_waitcnt lgkmcnt(0)
    v_pk_fma_f32 v[48:49], v[150:151], v[188:189], v[48:49] op_sel_hi:[1,0,1]
    v_pk_fma_f32 v[50:51], v[152:153], v[188:189], v[50:51] op_sel_hi:[1,0,1]
    v_pk_fma_f32 v[52:53], v[154:155], v[188:189], v[52:53] op_sel_hi:[1,0,1]
    v_pk_fma_f32 v[54:55], v[156:157], v[188:189], v[54:55] op_sel_hi:[1,0,1]
    v_pk_fma_f32 v[56:57], v[158:159], v[188:189], v[56:57] op_sel_hi:[1,0,1]
    v_pk_fma_f32 v[58:59], v[160:161], v[188:189], v[58:59] op_sel_hi:[1,0,1]
    v_pk_fma_f32 v[60:61], v[162:163], v[188:189], v[60:61] op_sel_hi:[1,0,1]
    v_pk_fma_f32 v[62:63], v[164:165], v[188:189], v[62:63] op_sel_hi:[1,0,1]
    v_pk_mul_f32 v[48:49], v[48:49], v[166:167]
    v_pk_mul_f32 v[50:51], v[50:51], v[168:169]
    v_pk_mul_f32 v[52:53], v[52:53], v[170:171]
    v_pk_mul_f32 v[54:55], v[54:55], v[172:173]
    v_pk_mul_f32 v[56:57], v[56:57], v[174:175]
    v_pk_mul_f32 v[58:59], v[58:59], v[176:177]
    v_pk_mul_f32 v[60:61], v[60:61], v[178:179]
    v_pk_mul_f32 v[62:63], v[62:63], v[180:181]
    v_cvt_pk_bf16_f32 v88, v48, v49
    v_cvt_pk_bf16_f32 v89, v50, v51
    v_cvt_pk_bf16_f32 v90, v52, v53
    v_cvt_pk_bf16_f32 v91, v54, v55
    v_cvt_pk_bf16_f32 v92, v56, v57
    v_cvt_pk_bf16_f32 v93, v58, v59
    v_cvt_pk_bf16_f32 v94, v60, v61
    v_cvt_pk_bf16_f32 v95, v62, v63
    buffer_store_dwordx4 v[88:91], v107, s[20:23], s37 offen offset:0 sc1
    buffer_store_dwordx4 v[92:95], v107, s[20:23], s37 offen offset:640 sc1
    s_branch L_q_sig
L_q0_repack:
    s_getpc_b64 s[30:31]
L_pc:
    s_mul_i32 s33, s24, 6144
    v_lshl_add_u32 v2, v252, 7, s33
    v_min_u32 v2, L_end-L_pc, v2
    v_mov_b32 v3, s31
    v_add_co_u32 v2, vcc, s30, v2
    s_nop 1
    v_addc_co_u32 v3, vcc, 0, v3, vcc
    global_load_dword v41, v[2:3], off
    s_mov_b32 s34, s2
    s_sub_u32 s30, s2, 240
    s_mov_b32 s16, s72
    s_mov_b32 s17, s73
    s_mov_b32 s18, 0xc8000
    s_mov_b32 s19, 0x20000
    v_lshlrev_b32 v1, 4, v252
    s_mul_i32 s31, s30, 51200
    s_lshl_b32 s33, s24, 10
    s_mov_b32 m0, s33
    s_add_u32 s31, s31, s33
    buffer_load_dwordx4 v1, s[16:19], s31 offen lds
    s_add_u32 m0, m0, 8192
    s_add_u32 s31, s31, 8192
    buffer_load_dwordx4 v1, s[16:19], s31 offen lds
    s_add_u32 m0, m0, 8192
    s_add_u32 s31, s31, 8192
    buffer_load_dwordx4 v1, s[16:19], s31 offen lds
    s_add_u32 m0, m0, 8192
    s_add_u32 s31, s31, 8192
    buffer_load_dwordx4 v1, s[16:19], s31 offen lds
    s_add_u32 m0, m0, 8192
    s_add_u32 s31, s31, 8192
    buffer_load_dwordx4 v1, s[16:19], s31 offen lds
    s_add_u32 m0, m0, 8192
    s_add_u32 s31, s31, 8192
    buffer_load_dwordx4 v1, s[16:19], s31 offen lds
    s_add_u32 m0, m0, 8192
    s_add_u32 s31, s31, 8192
    s_cmp_ge_u32 s24, 2
    s_cbranch_scc1 L_q0_rp1
    buffer_load_dwordx4 v1, s[16:19], s31 offen lds
    s_add_u32 m0, m0, 8192
    s_add_u32 s31, s31, 8192
L_q0_rp1:
    v_lshrrev_b32 v2, 4, v252
    v_bfe_u32 v3, v252, 2, 2
    v_lshrrev_b32 v4, 1, v2
    v_mad_u32_u24 v4, v4, 20, v3
    v_and_b32 v5, 1, v2
    v_lshl_add_u32 v4, v5, 2, v4
    v_mul_u32_u24 v4, 1280, v4
    v_and_b32 v5, 3, v252
    s_mul_i32 s33, s24, 160
    v_lshl_add_u32 v10, v5, 4, s33
    v_lshl_add_u32 v5, v5, 3, s33
    v_add_u32 v11, v4, v5
    v_add_u32 v4, v4, v10
    v_add_u32 v6, 16, v3
    v_mul_u32_u24 v6, 1280, v6
    v_add_u32 v7, v6, v5
    v_add_u32 v6, v6, v10
    v_lshrrev_b32 v40, 1, v2
    v_lshl_add_u32 v6, v40, 6, v6
    v_and_b32 v40, 1, v2
    v_lshl_add_u32 v6, v40, 3, v6
    s_mul_i32 s35, s24, 102400
    s_add_u32 s35, s35, 0x80000
    s_mul_i32 s36, s30, 5120
    s_add_u32 s36, s36, s35
    s_add_u32 s39, s36, 4096
    s_lshr_b32 s37, s30, 2
    s_add_u32 s37, s37, 16
    s_mul_i32 s37, s37, 5120
    s_add_u32 s37, s37, s35
    s_and_b32 s38, s30, 3
    s_lshl_b32 s38, s38, 8
    s_add_u32 s37, s37, s38
    v_and_b32 v8, 15, v252
    v_lshlrev_b32 v8, 4, v8
    v_lshl_add_u32 v9, v2, 10, v8
    v_add_u32 v8, 4096, v8
    s_waitcnt vmcnt(0)
    s_barrier
    ds_read_b64_tr_b16 v[12:13], v4 offset:0
    ds_read_b64_tr_b16 v[14:15], v4 offset:10240
    ds_read_b64_tr_b16 v[16:17], v4 offset:8
    ds_read_b64_tr_b16 v[18:19], v4 offset:10248
    ds_read_b64_tr_b16 v[20:21], v4 offset:64
    ds_read_b64_tr_b16 v[22:23], v4 offset:10304
    ds_read_b64_tr_b16 v[24:25], v4 offset:72
    ds_read_b64_tr_b16 v[26:27], v4 offset:10312
    ds_read_b64_tr_b16 v[28:29], v11 offset:128
    ds_read_b64_tr_b16 v[30:31], v11 offset:10368
    ds_read_b64_tr_b16 v[32:33], v6 offset:0
    ds_read_b64_tr_b16 v[36:37], v7 offset:128
    ds_read_b64_tr_b16 v[34:35], v6 offset:25600
    ds_read_b64_tr_b16 v[38:39], v7 offset:25728
    s_waitcnt lgkmcnt(0)
    buffer_store_dwordx4 v[12:15], v1, s[4:7], s36 offen offset:0 sc1
    buffer_store_dwordx4 v[16:19], v1, s[4:7], s36 offen offset:1024 sc1
    buffer_store_dwordx4 v[20:23], v1, s[4:7], s36 offen offset:2048 sc1
    buffer_store_dwordx4 v[24:27], v1, s[4:7], s36 offen offset:3072 sc1
    buffer_store_dwordx4 v[28:31], v1, s[4:7], s39 offen sc1
    buffer_store_dwordx4 v[32:35], v9, s[4:7], s37 offen sc1
    buffer_store_dwordx4 v[36:39], v8, s[4:7], s37 offen sc1
    s_branch L_q_sig
L_next:
    s_mov_b32 s91, 1
    s_add_u32 s96, s96, 1310720
    s_add_u32 s20, s88, 0x2a00000
    s_addc_u32 s21, s89, 0
    s_add_u32 s95, s95, 128
    s_cmp_lt_u32 s2, 240
    s_cbranch_scc1 L_q1_run
    v_mov_b32 v250, s90
    v_lshlrev_b32 v251, 15, v252
    s_waitcnt vmcnt(0) lgkmcnt(0)
    s_barrier
    s_cmp_lg_u32 s24, 3
    s_cbranch_scc1 L_sig1
    s_mov_b64 exec, 1
    buffer_store_dword v250, v251, s[4:7], s97 offen sc1
    s_mov_b64 exec, -1
L_sig1:
    s_mov_b32 s34, s2
    s_branch L_q_sig
L_q1_run:
    s_and_b32 s30, s2, 7
    s_mul_i32 s30, s30, 30
    s_lshr_b32 s31, s2, 3
    s_add_u32 s34, s30, s31
    s_mul_i32 s31, s34, 205
    s_lshr_b32 s31, s31, 10
    s_mul_i32 s30, s31, 5
    s_sub_u32 s26, s34, s30
    s_and_b32 s25, s31, 15
    s_lshr_b32 s27, s31, 4
    s_lshl_b32 s30, s25, 2
    s_add_u32 s32, s30, s3
    s_mul_i32 s30, s27, 5
    s_add_u32 s40, s30, s26
    s_lshl_b32 s34, s40, 4
    s_add_u32 s34, s34, s25
    s_cmp_lt_u32 s24, 4
    s_cbranch_scc1 L_q1_c
    s_barrier
    v_and_b32 v8, 15, v252
    v_lshlrev_b32 v8, 7, v8
    s_lshl_b32 s44, s25, 4
    s_lshl_b32 s44, s44, 7
    s_add_u32 s44, s44, s96
    s_sub_u32 s44, s44, 262144
    s_lshl_b32 s30, s3, 12
    s_add_u32 s30, s30, 98304
    v_lshl_add_u32 v9, v252, 4, s30
    s_waitcnt vmcnt(24)
    ds_write_b128 v9, v[112:115] offset:0
    ds_write_b128 v9, v[116:119] offset:1024
    ds_write_b128 v9, v[120:123] offset:2048
    ds_write_b128 v9, v[124:127] offset:3072
    ds_write_b128 v9, v[128:131] offset:16384
    ds_write_b128 v9, v[132:135] offset:17408
    ds_write_b128 v9, v[136:139] offset:18432
    ds_write_b128 v9, v[140:143] offset:19456
    ds_write_b128 v9, v[144:147] offset:32768
    ds_write_b128 v9, v[148:151] offset:33792
    ds_write_b128 v9, v[152:155] offset:34816
    ds_write_b128 v9, v[156:159] offset:35840
    ds_write_b128 v9, v[160:163] offset:49152
    ds_write_b128 v9, v[164:167] offset:50176
    ds_write_b128 v9, v[168:171] offset:51200
    ds_write_b128 v9, v[172:175] offset:52224
    s_waitcnt lgkmcnt(0)
    s_waitcnt vmcnt(0)
    s_barrier
    s_branch L_q_sig
L_q1_c:
    v_lshrrev_b32 v112, 5, v252
    v_and_b32 v113, 31, v252
    v_lshlrev_b32 v114, 4, v252
    v_bfe_u32 v122, v252, 2, 2
    v_lshl_add_u32 v123, v112, 3, v122
    v_lshlrev_b32 v123, 8, v123
    v_lshl_add_u32 v123, v122, 6, v123
    v_and_b32 v124, 16, v252
    v_lshl_add_u32 v123, v124, 1, v123
    v_and_b32 v124, 3, v252
    v_lshl_add_u32 v123, v124, 3, v123
    v_add_u32 v116, 0, v123
    v_xor_b32 v117, 64, v116
    v_xor_b32 v118, 128, v116
    v_xor_b32 v119, 192, v116
    v_and_b32 v115, 7, v252
    v_lshlrev_b32 v115, 7, v115
    s_lshr_b32 s44, s32, 1
    s_lshl_b32 s44, s44, 3
    s_lshl_b32 s44, s44, 7
    s_add_u32 s44, s44, s96
    s_sub_u32 s44, s44, 262144
    s_mul_i32 s28, s32, 40960
    s_add_u32 s28, s28, 0x200000
    s_lshl_b32 s45, s32, 8
    s_add_u32 s45, s45, 0x60000
    s_lshl_b32 s46, s40, 9
    s_add_u32 s46, s46, 0x68000
    s_cmp_eq_u32 s27, 2
    s_cbranch_scc1 L_q1_v
    s_mov_b32 s36, 163840
    s_cmp_eq_u32 s27, 0
    s_cselect_b32 s36, 81920, s36
    s_cselect_b32 s38, 0, 0x300000
    s_cselect_b32 s39, 0x3ea52b5c, 1.0
    s_cselect_b64 vcc, -1, 0
    s_lshr_b32 s37, s36, 6
    s_mul_i32 s37, s37, s32
    s_add_u32 s37, s37, s38
    v_and_b32 v122, 19, v113
    v_and_b32 v123, 4, v113
    v_lshl_or_b32 v122, v123, 1, v122
    v_and_b32 v123, 8, v113
    v_lshrrev_b32 v123, 1, v123
    v_or_b32 v122, v122, v123
    v_cndmask_b32 v122, v113, v122, vcc
    v_lshlrev_b32 v123, 4, v122
    v_lshl_add_u32 v123, v112, 3, v123
    v_lshlrev_b32 v122, 3, v122
    v_mad_u32_u24 v122, v112, s36, v122
    v_add_u32 v122, 1024, v122
    s_mov_b32 s30, 0
    s_lshl_b32 s31, s26, 4
    s_add_u32 s30, s30, s31
    s_add_u32 s31, s30, 0
    s_mul_i32 s41, s31, 205
    s_lshr_b32 s41, s41, 10
    s_mul_i32 s42, s41, 5
    s_sub_u32 s31, s31, s42
    s_mul_i32 s41, s41, s36
    s_lshl_b32 s41, s41, 1
    s_lshl_b32 s42, s31, 9
    s_sub_u32 s43, s36, 1536
    s_cmp_gt_u32 s31, 2
    s_cselect_b32 s43, s43, 0
    s_add_u32 s42, s42, s43
    s_cmp_eq_u32 s31, 2
    s_cselect_b32 s42, 0, s42
    s_cselect_b64 vcc, -1, 0
    s_add_u32 s41, s41, s42
    v_cndmask_b32 v124, v123, v122, vcc
    v_add_u32 v96, s41, v124
    s_add_u32 s31, s30, 1
    s_mul_i32 s41, s31, 205
    s_lshr_b32 s41, s41, 10
    s_mul_i32 s42, s41, 5
    s_sub_u32 s31, s31, s42
    s_mul_i32 s41, s41, s36
    s_lshl_b32 s41, s41, 1
    s_lshl_b32 s42, s31, 9
    s_sub_u32 s43, s36, 1536
    s_cmp_gt_u32 s31, 2
    s_cselect_b32 s43, s43, 0
    s_add_u32 s42, s42, s43
    s_cmp_eq_u32 s31, 2
    s_cselect_b32 s42, 0, s42
    s_cselect_b64 vcc, -1, 0
    s_add_u32 s41, s41, s42
    v_cndmask_b32 v124, v123, v122, vcc
    v_add_u32 v97, s41, v124
    s_add_u32 s31, s30, 2
    s_mul_i32 s41, s31, 205
    s_lshr_b32 s41, s41, 10
    s_mul_i32 s42, s41, 5
    s_sub_u32 s31, s31, s42
    s_mul_i32 s41, s41, s36
    s_lshl_b32 s41, s41, 1
    s_lshl_b32 s42, s31, 9
    s_sub_u32 s43, s36, 1536
    s_cmp_gt_u32 s31, 2
    s_cselect_b32 s43, s43, 0
    s_add_u32 s42, s42, s43
    s_cmp_eq_u32 s31, 2
    s_cselect_b32 s42, 0, s42
    s_cselect_b64 vcc, -1, 0
    s_add_u32 s41, s41, s42
    v_cndmask_b32 v124, v123, v122, vcc
    v_add_u32 v98, s41, v124
    s_add_u32 s31, s30, 3
    s_mul_i32 s41, s31, 205
    s_lshr_b32 s41, s41, 10
    s_mul_i32 s42, s41, 5
    s_sub_u32 s31, s31, s42
    s_mul_i32 s41, s41, s36
    s_lshl_b32 s41, s41, 1
    s_lshl_b32 s42, s31, 9
    s_sub_u32 s43, s36, 1536
    s_cmp_gt_u32 s31, 2
    s_cselect_b32 s43, s43, 0
    s_add_u32 s42, s42, s43
    s_cmp_eq_u32 s31, 2
    s_cselect_b32 s42, 0, s42
    s_cselect_b64 vcc, -1, 0
    s_add_u32 s41, s41, s42
    v_cndmask_b32 v124, v123, v122, vcc
    v_add_u32 v99, s41, v124
    s_mov_b32 s30, 4
    s_lshl_b32 s31, s26, 4
    s_add_u32 s30, s30, s31
    s_add_u32 s31, s30, 0
    s_mul_i32 s41, s31, 205
    s_lshr_b32 s41, s41, 10
    s_mul_i32 s42, s41, 5
    s_sub_u32 s31, s31, s42
    s_mul_i32 s41, s41, s36
    s_lshl_b32 s41, s41, 1
    s_lshl_b32 s42, s31, 9
    s_sub_u32 s43, s36, 1536
    s_cmp_gt_u32 s31, 2
    s_cselect_b32 s43, s43, 0
    s_add_u32 s42, s42, s43
    s_cmp_eq_u32 s31, 2
    s_cselect_b32 s42, 0, s42
    s_cselect_b64 vcc, -1, 0
    s_add_u32 s41, s41, s42
    v_cndmask_b32 v124, v123, v122, vcc
    v_add_u32 v100, s41, v124
    s_add_u32 s31, s30, 1
    s_mul_i32 s41, s31, 205
    s_lshr_b32 s41, s41, 10
    s_mul_i32 s42, s41, 5
    s_sub_u32 s31, s31, s42
    s_mul_i32 s41, s41, s36
    s_lshl_b32 s41, s41, 1
    s_lshl_b32 s42, s31, 9
    s_sub_u32 s43, s36, 1536
    s_cmp_gt_u32 s31, 2
    s_cselect_b32 s43, s43, 0
    s_add_u32 s42, s42, s43
    s_cmp_eq_u32 s31, 2
    s_cselect_b32 s42, 0, s42
    s_cselect_b64 vcc, -1, 0
    s_add_u32 s41, s41, s42
    v_cndmask_b32 v124, v123, v122, vcc
    v_add_u32 v101, s41, v124
    s_add_u32 s31, s30, 2
    s_mul_i32 s41, s31, 205
    s_lshr_b32 s41, s41, 10
    s_mul_i32 s42, s41, 5
    s_sub_u32 s31, s31, s42
    s_mul_i32 s41, s41, s36
    s_lshl_b32 s41, s41, 1
    s_lshl_b32 s42, s31, 9
    s_sub_u32 s43, s36, 1536
    s_cmp_gt_u32 s31, 2
    s_cselect_b32 s43, s43, 0
    s_add_u32 s42, s42, s43
    s_cmp_eq_u32 s31, 2
    s_cselect_b32 s42, 0, s42
    s_cselect_b64 vcc, -1, 0
    s_add_u32 s41, s41, s42
    v_cndmask_b32 v124, v123, v122, vcc
    v_add_u32 v102, s41, v124
    s_add_u32 s31, s30, 3
    s_mul_i32 s41, s31, 205
    s_lshr_b32 s41, s41, 10
    s_mul_i32 s42, s41, 5
    s_sub_u32 s31, s31, s42
    s_mul_i32 s41, s41, s36
    s_lshl_b32 s41, s41, 1
    s_lshl_b32 s42, s31, 9
    s_sub_u32 s43, s36, 1536
    s_cmp_gt_u32 s31, 2
    s_cselect_b32 s43, s43, 0
    s_add_u32 s42, s42, s43
    s_cmp_eq_u32 s31, 2
    s_cselect_b32 s42, 0, s42
    s_cselect_b64 vcc, -1, 0
    s_add_u32 s41, s41, s42
    v_cndmask_b32 v124, v123, v122, vcc
    v_add_u32 v103, s41, v124
    v_mov_b32 v250, s90
    v_lshlrev_b32 v251, 15, v252
    s_waitcnt vmcnt(0) lgkmcnt(0)
    s_barrier
    s_cmp_lg_u32 s24, 3
    s_cbranch_scc1 L_sig2
    s_mov_b64 exec, 1
    buffer_store_dword v250, v251, s[4:7], s97 offen sc1
    s_mov_b64 exec, -1
L_sig2:
    s_mov_b32 s30, 8
    s_lshl_b32 s31, s26, 4
    s_add_u32 s30, s30, s31
    s_add_u32 s31, s30, 0
    s_mul_i32 s41, s31, 205
    s_lshr_b32 s41, s41, 10
    s_mul_i32 s42, s41, 5
    s_sub_u32 s31, s31, s42
    s_mul_i32 s41, s41, s36
    s_lshl_b32 s41, s41, 1
    s_lshl_b32 s42, s31, 9
    s_sub_u32 s43, s36, 1536
    s_cmp_gt_u32 s31, 2
    s_cselect_b32 s43, s43, 0
    s_add_u32 s42, s42, s43
    s_cmp_eq_u32 s31, 2
    s_cselect_b32 s42, 0, s42
    s_cselect_b64 vcc, -1, 0
    s_add_u32 s41, s41, s42
    v_cndmask_b32 v124, v123, v122, vcc
    v_add_u32 v104, s41, v124
    s_add_u32 s31, s30, 1
    s_mul_i32 s41, s31, 205
    s_lshr_b32 s41, s41, 10
    s_mul_i32 s42, s41, 5
    s_sub_u32 s31, s31, s42
    s_mul_i32 s41, s41, s36
    s_lshl_b32 s41, s41, 1
    s_lshl_b32 s42, s31, 9
    s_sub_u32 s43, s36, 1536
    s_cmp_gt_u32 s31, 2
    s_cselect_b32 s43, s43, 0
    s_add_u32 s42, s42, s43
    s_cmp_eq_u32 s31, 2
    s_cselect_b32 s42, 0, s42
    s_cselect_b64 vcc, -1, 0
    s_add_u32 s41, s41, s42
    v_cndmask_b32 v124, v123, v122, vcc
    v_add_u32 v105, s41, v124
    s_add_u32 s31, s30, 2
    s_mul_i32 s41, s31, 205
    s_lshr_b32 s41, s41, 10
    s_mul_i32 s42, s41, 5
    s_sub_u32 s31, s31, s42
    s_mul_i32 s41, s41, s36
    s_lshl_b32 s41, s41, 1
    s_lshl_b32 s42, s31, 9
    s_sub_u32 s43, s36, 1536
    s_cmp_gt_u32 s31, 2
    s_cselect_b32 s43, s43, 0
    s_add_u32 s42, s42, s43
    s_cmp_eq_u32 s31, 2
    s_cselect_b32 s42, 0, s42
    s_cselect_b64 vcc, -1, 0
    s_add_u32 s41, s41, s42
    v_cndmask_b32 v124, v123, v122, vcc
    v_add_u32 v106, s41, v124
    s_add_u32 s31, s30, 3
    s_mul_i32 s41, s31, 205
    s_lshr_b32 s41, s41, 10
    s_mul_i32 s42, s41, 5
    s_sub_u32 s31, s31, s42
    s_mul_i32 s41, s41, s36
    s_lshl_b32 s41, s41, 1
    s_lshl_b32 s42, s31, 9
    s_sub_u32 s43, s36, 1536
    s_cmp_gt_u32 s31, 2
    s_cselect_b32 s43, s43, 0
    s_add_u32 s42, s42, s43
    s_cmp_eq_u32 s31, 2
    s_cselect_b32 s42, 0, s42
    s_cselect_b64 vcc, -1, 0
    s_add_u32 s41, s41, s42
    v_cndmask_b32 v124, v123, v122, vcc
    v_add_u32 v107, s41, v124
    s_mov_b32 s30, 12
    s_lshl_b32 s31, s26, 4
    s_add_u32 s30, s30, s31
    s_add_u32 s31, s30, 0
    s_mul_i32 s41, s31, 205
    s_lshr_b32 s41, s41, 10
    s_mul_i32 s42, s41, 5
    s_sub_u32 s31, s31, s42
    s_mul_i32 s41, s41, s36
    s_lshl_b32 s41, s41, 1
    s_lshl_b32 s42, s31, 9
    s_sub_u32 s43, s36, 1536
    s_cmp_gt_u32 s31, 2
    s_cselect_b32 s43, s43, 0
    s_add_u32 s42, s42, s43
    s_cmp_eq_u32 s31, 2
    s_cselect_b32 s42, 0, s42
    s_cselect_b64 vcc, -1, 0
    s_add_u32 s41, s41, s42
    v_cndmask_b32 v124, v123, v122, vcc
    v_add_u32 v108, s41, v124
    s_add_u32 s31, s30, 1
    s_mul_i32 s41, s31, 205
    s_lshr_b32 s41, s41, 10
    s_mul_i32 s42, s41, 5
    s_sub_u32 s31, s31, s42
    s_mul_i32 s41, s41, s36
    s_lshl_b32 s41, s41, 1
    s_lshl_b32 s42, s31, 9
    s_sub_u32 s43, s36, 1536
    s_cmp_gt_u32 s31, 2
    s_cselect_b32 s43, s43, 0
    s_add_u32 s42, s42, s43
    s_cmp_eq_u32 s31, 2
    s_cselect_b32 s42, 0, s42
    s_cselect_b64 vcc, -1, 0
    s_add_u32 s41, s41, s42
    v_cndmask_b32 v124, v123, v122, vcc
    v_add_u32 v109, s41, v124
    s_add_u32 s31, s30, 2
    s_mul_i32 s41, s31, 205
    s_lshr_b32 s41, s41, 10
    s_mul_i32 s42, s41, 5
    s_sub_u32 s31, s31, s42
    s_mul_i32 s41, s41, s36
    s_lshl_b32 s41, s41, 1
    s_lshl_b32 s42, s31, 9
    s_sub_u32 s43, s36, 1536
    s_cmp_gt_u32 s31, 2
    s_cselect_b32 s43, s43, 0
    s_add_u32 s42, s42, s43
    s_cmp_eq_u32 s31, 2
    s_cselect_b32 s42, 0, s42
    s_cselect_b64 vcc, -1, 0
    s_add_u32 s41, s41, s42
    v_cndmask_b32 v124, v123, v122, vcc
    v_add_u32 v110, s41, v124
    s_add_u32 s31, s30, 3
    s_mul_i32 s41, s31, 205
    s_lshr_b32 s41, s41, 10
    s_mul_i32 s42, s41, 5
    s_sub_u32 s31, s31, s42
    s_mul_i32 s41, s41, s36
    s_lshl_b32 s41, s41, 1
    s_lshl_b32 s42, s31, 9
    s_sub_u32 s43, s36, 1536
    s_cmp_gt_u32 s31, 2
    s_cselect_b32 s43, s43, 0
    s_add_u32 s42, s42, s43
    s_cmp_eq_u32 s31, 2
    s_cselect_b32 s42, 0, s42
    s_cselect_b64 vcc, -1, 0
    s_add_u32 s41, s41, s42
    v_cndmask_b32 v124, v123, v122, vcc
    v_add_u32 v111, s41, v124
    v_and_b32 v122, 19, v113
    v_and_b32 v123, 4, v113
    v_lshl_or_b32 v122, v123, 1, v122
    v_and_b32 v123, 8, v113
    v_lshrrev_b32 v123, 1, v123
    v_or_b32 v122, v122, v123
    v_lshlrev_b32 v128, 3, v122
    v_lshlrev_b32 v129, 4, v112
    s_mov_b32 s31, 0x3acccccd
    s_barrier
    ds_read_b64_tr_b16 v[64:65], v116 offset:0
    ds_read_b64_tr_b16 v[66:67], v116 offset:1024
    ds_read_b64_tr_b16 v[68:69], v117 offset:0
    ds_read_b64_tr_b16 v[70:71], v117 offset:1024
    ds_read_b64_tr_b16 v[72:73], v118 offset:0
    ds_read_b64_tr_b16 v[74:75], v118 offset:1024
    ds_read_b64_tr_b16 v[76:77], v119 offset:0
    ds_read_b64_tr_b16 v[78:79], v119 offset:1024
    s_mov_b32 s61, 0x40000
L_poll3:
    buffer_load_dword v250, v115, s[4:7], s44 offen sc1
    s_sub_u32 s61, s61, 1
    s_waitcnt vmcnt(0)
    s_cbranch_scc1 L_pollx4
    v_cmp_ne_u32 vcc, s90, v250
    s_cbranch_vccz L_pollx4
    s_mov_b64 exec, vcc
    s_sleep 1
    s_branch L_poll3
L_pollx4:
    s_mov_b64 exec, -1
    buffer_load_dwordx4 v[136:139], v114, s[4:7], s28 offen offset:0 sc1
    buffer_load_dwordx4 v[140:143], v114, s[4:7], s28 offen offset:1024 sc1
    buffer_load_dwordx4 v[144:147], v114, s[4:7], s28 offen offset:2048 sc1
    buffer_load_dwordx4 v[148:151], v114, s[4:7], s28 offen offset:3072 sc1
    s_add_u32 s28, s28, 4096
    buffer_load_dwordx4 v[152:155], v114, s[4:7], s28 offen offset:0 sc1
    buffer_load_dwordx4 v[156:159], v114, s[4:7], s28 offen offset:1024 sc1
    buffer_load_dwordx4 v[160:163], v114, s[4:7], s28 offen offset:2048 sc1
    buffer_load_dwordx4 v[164:167], v114, s[4:7], s28 offen offset:3072 sc1
    s_add_u32 s28, s28, 4096
    buffer_load_dwordx2 v[120:121], v128, s[4:7], s45 offen sc1
    s_waitcnt vmcnt(8) lgkmcnt(0)
    v_mfma_f32_32x32x16_bf16 v[0:15], v[64:67], v[136:139], 0
    ds_read_b64_tr_b16 v[80:81], v116 offset:4096
    ds_read_b64_tr_b16 v[82:83], v116 offset:5120
    ds_read_b64_tr_b16 v[84:85], v117 offset:4096
    v_mfma_f32_32x32x16_bf16 v[16:31], v[68:71], v[136:139], 0
    ds_read_b64_tr_b16 v[86:87], v117 offset:5120
    ds_read_b64_tr_b16 v[88:89], v118 offset:4096
    ds_read_b64_tr_b16 v[90:91], v118 offset:5120
    v_mfma_f32_32x32x16_bf16 v[32:47], v[72:75], v[136:139], 0
    ds_read_b64_tr_b16 v[92:93], v119 offset:4096
    ds_read_b64_tr_b16 v[94:95], v119 offset:5120
    v_mfma_f32_32x32x16_bf16 v[48:63], v[76:79], v[136:139], 0
    buffer_load_dwordx4 v[168:171], v114, s[4:7], s28 offen offset:0 sc1
    buffer_load_dwordx4 v[172:175], v114, s[4:7], s28 offen offset:1024 sc1
    s_waitcnt vmcnt(9) lgkmcnt(0)
    v_mfma_f32_32x32x16_bf16 v[0:15], v[80:83], v[140:143], v[0:15]
    ds_read_b64_tr_b16 v[64:65], v116 offset:8192
    ds_read_b64_tr_b16 v[66:67], v116 offset:9216
    ds_read_b64_tr_b16 v[68:69], v117 offset:8192
    v_mfma_f32_32x32x16_bf16 v[16:31], v[84:87], v[140:143], v[16:31]
    ds_read_b64_tr_b16 v[70:71], v117 offset:9216
    ds_read_b64_tr_b16 v[72:73], v118 offset:8192
    ds_read_b64_tr_b16 v[74:75], v118 offset:9216
    v_mfma_f32_32x32x16_bf16 v[32:47], v[88:91], v[140:143], v[32:47]
    ds_read_b64_tr_b16 v[76:77], v119 offset:8192
    ds_read_b64_tr_b16 v[78:79], v119 offset:9216
    v_mfma_f32_32x32x16_bf16 v[48:63], v[92:95], v[140:143], v[48:63]
    buffer_load_dwordx4 v[176:179], v114, s[4:7], s28 offen offset:2048 sc1
    buffer_load_dwordx4 v[180:183], v114, s[4:7], s28 offen offset:3072 sc1
    s_add_u32 s28, s28, 4096
    s_waitcnt vmcnt(10) lgkmcnt(0)
    v_mfma_f32_32x32x16_bf16 v[0:15], v[64:67], v[144:147], v[0:15]
    ds_read_b64_tr_b16 v[80:81], v116 offset:12288
    ds_read_b64_tr_b16 v[82:83], v116 offset:13312
    ds_read_b64_tr_b16 v[84:85], v117 offset:12288
    v_mfma_f32_32x32x16_bf16 v[16:31], v[68:71], v[144:147], v[16:31]
    ds_read_b64_tr_b16 v[86:87], v117 offset:13312
    ds_read_b64_tr_b16 v[88:89], v118 offset:12288
    ds_read_b64_tr_b16 v[90:91], v118 offset:13312
    v_mfma_f32_32x32x16_bf16 v[32:47], v[72:75], v[144:147], v[32:47]
    ds_read_b64_tr_b16 v[92:93], v119 offset:12288
    ds_read_b64_tr_b16 v[94:95], v119 offset:13312
    v_mfma_f32_32x32x16_bf16 v[48:63], v[76:79], v[144:147], v[48:63]
    buffer_load_dwordx4 v[184:187], v114, s[4:7], s28 offen offset:0 sc1
    buffer_load_dwordx4 v[188:191], v114, s[4:7], s28 offen offset:1024 sc1
    s_waitcnt vmcnt(11) lgkmcnt(0)
    v_mfma_f32_32x32x16_bf16 v[0:15], v[80:83], v[148:151], v[0:15]
    ds_read_b64_tr_b16 v[64:65], v116 offset:16384
    ds_read_b64_tr_b16 v[66:67], v116 offset:17408
    ds_read_b64_tr_b16 v[68:69], v117 offset:16384
    v_mfma_f32_32x32x16_bf16 v[16:31], v[84:87], v[148:151], v[16:31]
    ds_read_b64_tr_b16 v[70:71], v117 offset:17408
    ds_read_b64_tr_b16 v[72:73], v118 offset:16384
    ds_read_b64_tr_b16 v[74:75], v118 offset:17408
    v_mfma_f32_32x32x16_bf16 v[32:47], v[88:91], v[148:151], v[32:47]
    ds_read_b64_tr_b16 v[76:77], v119 offset:16384
    ds_read_b64_tr_b16 v[78:79], v119 offset:17408
    v_mfma_f32_32x32x16_bf16 v[48:63], v[92:95], v[148:151], v[48:63]
    buffer_load_dwordx4 v[192:195], v114, s[4:7], s28 offen offset:2048 sc1
    buffer_load_dwordx4 v[196:199], v114, s[4:7], s28 offen offset:3072 sc1
    s_add_u32 s28, s28, 4096
    s_waitcnt vmcnt(12) lgkmcnt(0)
    v_mfma_f32_32x32x16_bf16 v[0:15], v[64:67], v[152:155], v[0:15]
    ds_read_b64_tr_b16 v[80:81], v116 offset:20480
    ds_read_b64_tr_b16 v[82:83], v116 offset:21504
    ds_read_b64_tr_b16 v[84:85], v117 offset:20480
    v_mfma_f32_32x32x16_bf16 v[16:31], v[68:71], v[152:155], v[16:31]
    ds_read_b64_tr_b16 v[86:87], v117 offset:21504
    ds_read_b64_tr_b16 v[88:89], v118 offset:20480
    ds_read_b64_tr_b16 v[90:91], v118 offset:21504
    v_mfma_f32_32x32x16_bf16 v[32:47], v[72:75], v[152:155], v[32:47]
    ds_read_b64_tr_b16 v[92:93], v119 offset:20480
    ds_read_b64_tr_b16 v[94:95], v119 offset:21504
    v_mfma_f32_32x32x16_bf16 v[48:63], v[76:79], v[152:155], v[48:63]
    buffer_load_dwordx4 v[200:203], v114, s[4:7], s28 offen offset:0 sc1
    buffer_load_dwordx4 v[204:207], v114, s[4:7], s28 offen offset:1024 sc1
    s_waitcnt vmcnt(13) lgkmcnt(0)
    v_mfma_f32_32x32x16_bf16 v[0:15], v[80:83], v[156:159], v[0:15]
    ds_read_b64_tr_b16 v[64:65], v116 offset:24576
    ds_read_b64_tr_b16 v[66:67], v116 offset:25600
    ds_read_b64_tr_b16 v[68:69], v117 offset:24576
    v_mfma_f32_32x32x16_bf16 v[16:31], v[84:87], v[156:159], v[16:31]
    ds_read_b64_tr_b16 v[70:71], v117 offset:25600
    ds_read_b64_tr_b16 v[72:73], v118 offset:24576
    ds_read_b64_tr_b16 v[74:75], v118 offset:25600
    v_mfma_f32_32x32x16_bf16 v[32:47], v[88:91], v[156:159], v[32:47]
    ds_read_b64_tr_b16 v[76:77], v119 offset:24576
    ds_read_b64_tr_b16 v[78:79], v119 offset:25600
    v_mfma_f32_32x32x16_bf16 v[48:63], v[92:95], v[156:159], v[48:63]
    buffer_load_dwordx4 v[208:211], v114, s[4:7], s28 offen offset:2048 sc1
    buffer_load_dwordx4 v[212:215], v114, s[4:7], s28 offen offset:3072 sc1
    s_add_u32 s28, s28, 4096
    s_waitcnt vmcnt(14) lgkmcnt(0)
    v_mfma_f32_32x32x16_bf16 v[0:15], v[64:67], v[160:163], v[0:15]
    ds_read_b64_tr_b16 v[80:81], v116 offset:28672
    ds_read_b64_tr_b16 v[82:83], v116 offset:29696
    ds_read_b64_tr_b16 v[84:85], v117 offset:28672
    v_mfma_f32_32x32x16_bf16 v[16:31], v[68:71], v[160:163], v[16:31]
    ds_read_b64_tr_b16 v[86:87], v117 offset:29696
    ds_read_b64_tr_b16 v[88:89], v118 offset:28672
    ds_read_b64_tr_b16 v[90:91], v118 offset:29696
    v_mfma_f32_32x32x16_bf16 v[32:47], v[72:75], v[160:163], v[32:47]
    ds_read_b64_tr_b16 v[92:93], v119 offset:28672
    ds_read_b64_tr_b16 v[94:95], v119 offset:29696
    v_mfma_f32_32x32x16_bf16 v[48:63], v[76:79], v[160:163], v[48:63]
    buffer_load_dwordx4 v[136:139], v114, s[4:7], s28 offen offset:0 sc1
    buffer_load_dwordx4 v[140:143], v114, s[4:7], s28 offen offset:1024 sc1
    s_waitcnt vmcnt(15) lgkmcnt(0)
    v_mfma_f32_32x32x16_bf16 v[0:15], v[80:83], v[164:167], v[0:15]
    ds_read_b64_tr_b16 v[64:65], v116 offset:32768
    ds_read_b64_tr_b16 v[66:67], v116 offset:33792
    ds_read_b64_tr_b16 v[68:69], v117 offset:32768
    v_mfma_f32_32x32x16_bf16 v[16:31], v[84:87], v[164:167], v[16:31]
    ds_read_b64_tr_b16 v[70:71], v117 offset:33792
    ds_read_b64_tr_b16 v[72:73], v118 offset:32768
    ds_read_b64_tr_b16 v[74:75], v118 offset:33792
    v_mfma_f32_32x32x16_bf16 v[32:47], v[88:91], v[164:167], v[32:47]
    ds_read_b64_tr_b16 v[76:77], v119 offset:32768
    ds_read_b64_tr_b16 v[78:79], v119 offset:33792
    v_mfma_f32_32x32x16_bf16 v[48:63], v[92:95], v[164:167], v[48:63]
    buffer_load_dwordx4 v[144:147], v114, s[4:7], s28 offen offset:2048 sc1
    buffer_load_dwordx4 v[148:151], v114, s[4:7], s28 offen offset:3072 sc1
    s_add_u32 s28, s28, 4096
    s_waitcnt vmcnt(15) lgkmcnt(0)
    v_mfma_f32_32x32x16_bf16 v[0:15], v[64:67], v[168:171], v[0:15]
    ds_read_b64_tr_b16 v[80:81], v116 offset:36864
    ds_read_b64_tr_b16 v[82:83], v116 offset:37888
    ds_read_b64_tr_b16 v[84:85], v117 offset:36864
    v_mfma_f32_32x32x16_bf16 v[16:31], v[68:71], v[168:171], v[16:31]
    ds_read_b64_tr_b16 v[86:87], v117 offset:37888
    ds_read_b64_tr_b16 v[88:89], v118 offset:36864
    ds_read_b64_tr_b16 v[90:91], v118 offset:37888
    v_mfma_f32_32x32x16_bf16 v[32:47], v[72:75], v[168:171], v[32:47]
    ds_read_b64_tr_b16 v[92:93], v119 offset:36864
    ds_read_b64_tr_b16 v[94:95], v119 offset:37888
    v_mfma_f32_32x32x16_bf16 v[48:63], v[76:79], v[168:171], v[48:63]
    buffer_load_dwordx4 v[152:155], v114, s[4:7], s28 offen offset:0 sc1
    buffer_load_dwordx4 v[156:159], v114, s[4:7], s28 offen offset:1024 sc1
    s_waitcnt vmcnt(16) lgkmcnt(0)
    v_mfma_f32_32x32x16_bf16 v[0:15], v[80:83], v[172:175], v[0:15]
    ds_read_b64_tr_b16 v[64:65], v116 offset:40960
    ds_read_b64_tr_b16 v[66:67], v116 offset:41984
    ds_read_b64_tr_b16 v[68:69], v117 offset:40960
    v_mfma_f32_32x32x16_bf16 v[16:31], v[84:87], v[172:175], v[16:31]
    ds_read_b64_tr_b16 v[70:71], v117 offset:41984
    ds_read_b64_tr_b16 v[72:73], v118 offset:40960
    ds_read_b64_tr_b16 v[74:75], v118 offset:41984
    v_mfma_f32_32x32x16_bf16 v[32:47], v[88:91], v[172:175], v[32:47]
    ds_read_b64_tr_b16 v[76:77], v119 offset:40960
    ds_read_b64_tr_b16 v[78:79], v119 offset:41984
    v_mfma_f32_32x32x16_bf16 v[48:63], v[92:95], v[172:175], v[48:63]
    buffer_load_dwordx4 v[160:163], v114, s[4:7], s28 offen offset:2048 sc1
    buffer_load_dwordx4 v[164:167], v114, s[4:7], s28 offen offset:3072 sc1
    s_add_u32 s28, s28, 4096
    s_waitcnt vmcnt(17) lgkmcnt(0)
    v_mfma_f32_32x32x16_bf16 v[0:15], v[64:67], v[176:179], v[0:15]
    ds_read_b64_tr_b16 v[80:81], v116 offset:45056
    ds_read_b64_tr_b16 v[82:83], v116 offset:46080
    ds_read_b64_tr_b16 v[84:85], v117 offset:45056
    v_mul_f32 v120, 0xbacccccd, v120
    v_mfma_f32_32x32x16_bf16 v[16:31], v[68:71], v[176:179], v[16:31]
    ds_read_b64_tr_b16 v[86:87], v117 offset:46080
    ds_read_b64_tr_b16 v[88:89], v118 offset:45056
    ds_read_b64_tr_b16 v[90:91], v118 offset:46080
    v_mul_f32 v122, v120, v120
    v_mfma_f32_32x32x16_bf16 v[32:47], v[72:75], v[176:179], v[32:47]
    ds_read_b64_tr_b16 v[92:93], v119 offset:45056
    ds_read_b64_tr_b16 v[94:95], v119 offset:46080
    v_fma_f32 v121, v121, s31, -v122
    v_mfma_f32_32x32x16_bf16 v[48:63], v[76:79], v[176:179], v[48:63]
    v_max_f32 v121, 0, v121
    v_add_f32 v121, 0x3727c5ac, v121
    v_rsq_f32 v121, v121
    s_nop 0
    buffer_load_dwordx4 v[168:171], v114, s[4:7], s28 offen offset:0 sc1
    buffer_load_dwordx4 v[172:175], v114, s[4:7], s28 offen offset:1024 sc1
    s_waitcnt vmcnt(18) lgkmcnt(0)
    v_mfma_f32_32x32x16_bf16 v[0:15], v[80:83], v[180:183], v[0:15]
    ds_read_b64_tr_b16 v[64:65], v116 offset:49152
    ds_read_b64_tr_b16 v[66:67], v116 offset:50176
    ds_read_b64_tr_b16 v[68:69], v117 offset:49152
    v_mul_f32 v121, s39, v121
    v_mfma_f32_32x32x16_bf16 v[16:31], v[84:87], v[180:183], v[16:31]
    ds_read_b64_tr_b16 v[70:71], v117 offset:50176
    ds_read_b64_tr_b16 v[72:73], v118 offset:49152
    ds_read_b64_tr_b16 v[74:75], v118 offset:50176
    v_mfma_f32_32x32x16_bf16 v[32:47], v[88:91], v[180:183], v[32:47]
    ds_read_b64_tr_b16 v[76:77], v119 offset:49152
    ds_read_b64_tr_b16 v[78:79], v119 offset:50176
    v_mfma_f32_32x32x16_bf16 v[48:63], v[92:95], v[180:183], v[48:63]
    buffer_load_dwordx4 v[176:179], v114, s[4:7], s28 offen offset:2048 sc1
    buffer_load_dwordx4 v[180:183], v114, s[4:7], s28 offen offset:3072 sc1
    s_add_u32 s28, s28, 4096
    s_waitcnt vmcnt(19) lgkmcnt(0)
    v_mfma_f32_32x32x16_bf16 v[0:15], v[64:67], v[184:187], v[0:15]
    ds_read_b64_tr_b16 v[80:81], v116 offset:53248
    ds_read_b64_tr_b16 v[82:83], v116 offset:54272
    ds_read_b64_tr_b16 v[84:85], v117 offset:53248
    v_mfma_f32_32x32x16_bf16 v[16:31], v[68:71], v[184:187], v[16:31]
    ds_read_b64_tr_b16 v[86:87], v117 offset:54272
    ds_read_b64_tr_b16 v[88:89], v118 offset:53248
    ds_read_b64_tr_b16 v[90:91], v118 offset:54272
    v_mfma_f32_32x32x16_bf16 v[32:47], v[72:75], v[184:187], v[32:47]
    ds_read_b64_tr_b16 v[92:93], v119 offset:53248
    ds_read_b64_tr_b16 v[94:95], v119 offset:54272
    v_mfma_f32_32x32x16_bf16 v[48:63], v[76:79], v[184:187], v[48:63]
    buffer_load_dwordx4 v[184:187], v114, s[4:7], s28 offen offset:0 sc1
    s_waitcnt vmcnt(19) lgkmcnt(0)
    v_mfma_f32_32x32x16_bf16 v[0:15], v[80:83], v[188:191], v[0:15]
    ds_read_b64_tr_b16 v[64:65], v116 offset:57344
    ds_read_b64_tr_b16 v[66:67], v116 offset:58368
    ds_read_b64_tr_b16 v[68:69], v117 offset:57344
    v_mfma_f32_32x32x16_bf16 v[16:31], v[84:87], v[188:191], v[16:31]
    ds_read_b64_tr_b16 v[70:71], v117 offset:58368
    ds_read_b64_tr_b16 v[72:73], v118 offset:57344
    ds_read_b64_tr_b16 v[74:75], v118 offset:58368
    v_mfma_f32_32x32x16_bf16 v[32:47], v[88:91], v[188:191], v[32:47]
    ds_read_b64_tr_b16 v[76:77], v119 offset:57344
    ds_read_b64_tr_b16 v[78:79], v119 offset:58368
    v_mfma_f32_32x32x16_bf16 v[48:63], v[92:95], v[188:191], v[48:63]
    buffer_load_dwordx4 v[188:191], v114, s[4:7], s28 offen offset:1024 sc1
    s_waitcnt vmcnt(19) lgkmcnt(0)
    v_mfma_f32_32x32x16_bf16 v[0:15], v[64:67], v[192:195], v[0:15]
    ds_read_b64_tr_b16 v[80:81], v116 offset:61440
    ds_read_b64_tr_b16 v[82:83], v116 offset:62464
    ds_read_b64_tr_b16 v[84:85], v117 offset:61440
    v_mfma_f32_32x32x16_bf16 v[16:31], v[68:71], v[192:195], v[16:31]
    ds_read_b64_tr_b16 v[86:87], v117 offset:62464
    ds_read_b64_tr_b16 v[88:89], v118 offset:61440
    ds_read_b64_tr_b16 v[90:91], v118 offset:62464
    v_mfma_f32_32x32x16_bf16 v[32:47], v[72:75], v[192:195], v[32:47]
    ds_read_b64_tr_b16 v[92:93], v119 offset:61440
    ds_read_b64_tr_b16 v[94:95], v119 offset:62464
    v_mfma_f32_32x32x16_bf16 v[48:63], v[76:79], v[192:195], v[48:63]
    buffer_load_dwordx4 v[192:195], v114, s[4:7], s28 offen offset:2048 sc1
    s_waitcnt vmcnt(19) lgkmcnt(0)
    v_mfma_f32_32x32x16_bf16 v[0:15], v[80:83], v[196:199], v[0:15]
    v_add_u32 v116, 0x10000, v116
    v_add_u32 v117, 0x10000, v117
    v_add_u32 v118, 0x10000, v118
    v_add_u32 v119, 0x10000, v119
    v_mfma_f32_32x32x16_bf16 v[16:31], v[84:87], v[196:199], v[16:31]
    ds_read_b64_tr_b16 v[64:65], v116 offset:0
    ds_read_b64_tr_b16 v[66:67], v116 offset:1024
    ds_read_b64_tr_b16 v[68:69], v117 offset:0
    ds_read_b64_tr_b16 v[70:71], v117 offset:1024
    v_mfma_f32_32x32x16_bf16 v[32:47], v[88:91], v[196:199], v[32:47]
    ds_read_b64_tr_b16 v[72:73], v118 offset:0
    ds_read_b64_tr_b16 v[74:75], v118 offset:1024
    ds_read_b64_tr_b16 v[76:77], v119 offset:0
    ds_read_b64_tr_b16 v[78:79], v119 offset:1024
    v_mfma_f32_32x32x16_bf16 v[48:63], v[92:95], v[196:199], v[48:63]
    buffer_load_dwordx4 v[196:199], v114, s[4:7], s28 offen offset:3072 sc1
    s_add_u32 s28, s28, 4096
    s_waitcnt vmcnt(19) lgkmcnt(0)
    v_mfma_f32_32x32x16_bf16 v[0:15], v[64:67], v[200:203], v[0:15]
    ds_read_b64_tr_b16 v[80:81], v116 offset:4096
    ds_read_b64_tr_b16 v[82:83], v116 offset:5120
    ds_read_b64_tr_b16 v[84:85], v117 offset:4096
    v_mfma_f32_32x32x16_bf16 v[16:31], v[68:71], v[200:203], v[16:31]
    ds_read_b64_tr_b16 v[86:87], v117 offset:5120
    ds_read_b64_tr_b16 v[88:89], v118 offset:4096
    ds_read_b64_tr_b16 v[90:91], v118 offset:5120
    v_mfma_f32_32x32x16_bf16 v[32:47], v[72:75], v[200:203], v[32:47]
    ds_read_b64_tr_b16 v[92:93], v119 offset:4096
    ds_read_b64_tr_b16 v[94:95], v119 offset:5120
    v_mfma_f32_32x32x16_bf16 v[48:63], v[76:79], v[200:203], v[48:63]
    buffer_load_dwordx4 v[200:203], v114, s[4:7], s28 offen offset:0 sc1
    s_waitcnt vmcnt(19) lgkmcnt(0)
    v_mfma_f32_32x32x16_bf16 v[0:15], v[80:83], v[204:207], v[0:15]
    ds_read_b64_tr_b16 v[64:65], v116 offset:8192
    ds_read_b64_tr_b16 v[66:67], v116 offset:9216
    ds_read_b64_tr_b16 v[68:69], v117 offset:8192
    v_mfma_f32_32x32x16_bf16 v[16:31], v[84:87], v[204:207], v[16:31]
    ds_read_b64_tr_b16 v[70:71], v117 offset:9216
    ds_read_b64_tr_b16 v[72:73], v118 offset:8192
    ds_read_b64_tr_b16 v[74:75], v118 offset:9216
    v_mfma_f32_32x32x16_bf16 v[32:47], v[88:91], v[204:207], v[32:47]
    ds_read_b64_tr_b16 v[76:77], v119 offset:8192
    ds_read_b64_tr_b16 v[78:79], v119 offset:9216
    v_mfma_f32_32x32x16_bf16 v[48:63], v[92:95], v[204:207], v[48:63]
    buffer_load_dwordx4 v[204:207], v114, s[4:7], s28 offen offset:1024 sc1
    s_waitcnt vmcnt(19) lgkmcnt(0)
    v_mfma_f32_32x32x16_bf16 v[0:15], v[64:67], v[208:211], v[0:15]
    ds_read_b64_tr_b16 v[80:81], v116 offset:12288
    ds_read_b64_tr_b16 v[82:83], v116 offset:13312
    ds_read_b64_tr_b16 v[84:85], v117 offset:12288
    v_mfma_f32_32x32x16_bf16 v[16:31], v[68:71], v[208:211], v[16:31]
    ds_read_b64_tr_b16 v[86:87], v117 offset:13312
    ds_read_b64_tr_b16 v[88:89], v118 offset:12288
    ds_read_b64_tr_b16 v[90:91], v118 offset:13312
    v_mfma_f32_32x32x16_bf16 v[32:47], v[72:75], v[208:211], v[32:47]
    ds_read_b64_tr_b16 v[92:93], v119 offset:12288
    ds_read_b64_tr_b16 v[94:95], v119 offset:13312
    v_mfma_f32_32x32x16_bf16 v[48:63], v[76:79], v[208:211], v[48:63]
    buffer_load_dwordx4 v[208:211], v114, s[4:7], s28 offen offset:2048 sc1
    s_waitcnt vmcnt(19) lgkmcnt(0)
    v_mfma_f32_32x32x16_bf16 v[0:15], v[80:83], v[212:215], v[0:15]
    ds_read_b64_tr_b16 v[64:65], v116 offset:16384
    ds_read_b64_tr_b16 v[66:67], v116 offset:17408
    ds_read_b64_tr_b16 v[68:69], v117 offset:16384
    v_mfma_f32_32x32x16_bf16 v[16:31], v[84:87], v[212:215], v[16:31]
    ds_read_b64_tr_b16 v[70:71], v117 offset:17408
    ds_read_b64_tr_b16 v[72:73], v118 offset:16384
    ds_read_b64_tr_b16 v[74:75], v118 offset:17408
    v_mfma_f32_32x32x16_bf16 v[32:47], v[88:91], v[212:215], v[32:47]
    ds_read_b64_tr_b16 v[76:77], v119 offset:16384
    ds_read_b64_tr_b16 v[78:79], v119 offset:17408
    v_mfma_f32_32x32x16_bf16 v[48:63], v[92:95], v[212:215], v[48:63]
    buffer_load_dwordx4 v[212:215], v114, s[4:7], s28 offen offset:3072 sc1
    s_add_u32 s28, s28, 4096
    s_waitcnt vmcnt(19) lgkmcnt(0)
    v_mfma_f32_32x32x16_bf16 v[0:15], v[64:67], v[136:139], v[0:15]
    ds_read_b64_tr_b16 v[80:81], v116 offset:20480
    ds_read_b64_tr_b16 v[82:83], v116 offset:21504
    ds_read_b64_tr_b16 v[84:85], v117 offset:20480
    v_mfma_f32_32x32x16_bf16 v[16:31], v[68:71], v[136:139], v[16:31]
    ds_read_b64_tr_b16 v[86:87], v117 offset:21504
    ds_read_b64_tr_b16 v[88:89], v118 offset:20480
    ds_read_b64_tr_b16 v[90:91], v118 offset:21504
    v_mfma_f32_32x32x16_bf16 v[32:47], v[72:75], v[136:139], v[32:47]
    ds_read_b64_tr_b16 v[92:93], v119 offset:20480
    ds_read_b64_tr_b16 v[94:95], v119 offset:21504
    v_mfma_f32_32x32x16_bf16 v[48:63], v[76:79], v[136:139], v[48:63]
    buffer_load_dwordx4 v[216:219], v129, s[4:7], s46 offen offset:0 sc1
    buffer_load_dwordx4 v[220:223], v129, s[4:7], s46 offen offset:32 sc1
    buffer_load_dwordx4 v[224:227], v129, s[4:7], s46 offen offset:64 sc1
    buffer_load_dwordx4 v[228:231], v129, s[4:7], s46 offen offset:96 sc1
    buffer_load_dwordx4 v[232:235], v129, s[4:7], s46 offen offset:128 sc1
    buffer_load_dwordx4 v[236:239], v129, s[4:7], s46 offen offset:160 sc1
    buffer_load_dwordx4 v[240:243], v129, s[4:7], s46 offen offset:192 sc1
    buffer_load_dwordx4 v[244:247], v129, s[4:7], s46 offen offset:224 sc1
    s_waitcnt vmcnt(26) lgkmcnt(0)
    v_mfma_f32_32x32x16_bf16 v[0:15], v[80:83], v[140:143], v[0:15]
    ds_read_b64_tr_b16 v[64:65], v116 offset:24576
    ds_read_b64_tr_b16 v[66:67], v116 offset:25600
    ds_read_b64_tr_b16 v[68:69], v117 offset:24576
    v_mfma_f32_32x32x16_bf16 v[16:31], v[84:87], v[140:143], v[16:31]
    ds_read_b64_tr_b16 v[70:71], v117 offset:25600
    ds_read_b64_tr_b16 v[72:73], v118 offset:24576
    ds_read_b64_tr_b16 v[74:75], v118 offset:25600
    v_mfma_f32_32x32x16_bf16 v[32:47], v[88:91], v[140:143], v[32:47]
    ds_read_b64_tr_b16 v[76:77], v119 offset:24576
    ds_read_b64_tr_b16 v[78:79], v119 offset:25600
    v_mfma_f32_32x32x16_bf16 v[48:63], v[92:95], v[140:143], v[48:63]
    s_waitcnt vmcnt(25) lgkmcnt(0)
    v_mfma_f32_32x32x16_bf16 v[0:15], v[64:67], v[144:147], v[0:15]
    ds_read_b64_tr_b16 v[80:81], v116 offset:28672
    ds_read_b64_tr_b16 v[82:83], v116 offset:29696
    ds_read_b64_tr_b16 v[84:85], v117 offset:28672
    v_mfma_f32_32x32x16_bf16 v[16:31], v[68:71], v[144:147], v[16:31]
    ds_read_b64_tr_b16 v[86:87], v117 offset:29696
    ds_read_b64_tr_b16 v[88:89], v118 offset:28672
    ds_read_b64_tr_b16 v[90:91], v118 offset:29696
    v_mfma_f32_32x32x16_bf16 v[32:47], v[72:75], v[144:147], v[32:47]
    ds_read_b64_tr_b16 v[92:93], v119 offset:28672
    ds_read_b64_tr_b16 v[94:95], v119 offset:29696
    v_mfma_f32_32x32x16_bf16 v[48:63], v[76:79], v[144:147], v[48:63]
    s_waitcnt vmcnt(24) lgkmcnt(0)
    v_mfma_f32_32x32x16_bf16 v[0:15], v[80:83], v[148:151], v[0:15]
    v_add_u32 v116, 0x8000, v116
    v_add_u32 v117, 0x8000, v117
    v_add_u32 v118, 0x8000, v118
    v_add_u32 v119, 0x8000, v119
    v_mfma_f32_32x32x16_bf16 v[16:31], v[84:87], v[148:151], v[16:31]
    ds_read_b64_tr_b16 v[64:65], v116 offset:0
    ds_read_b64_tr_b16 v[66:67], v116 offset:1024
    ds_read_b64_tr_b16 v[68:69], v116 offset:4096
    ds_read_b64_tr_b16 v[70:71], v116 offset:5120
    v_mfma_f32_32x32x16_bf16 v[32:47], v[88:91], v[148:151], v[32:47]
    ds_read_b64_tr_b16 v[72:73], v116 offset:8192
    ds_read_b64_tr_b16 v[74:75], v116 offset:9216
    ds_read_b64_tr_b16 v[76:77], v116 offset:12288
    ds_read_b64_tr_b16 v[78:79], v116 offset:13312
    v_mfma_f32_32x32x16_bf16 v[48:63], v[92:95], v[148:151], v[48:63]
    s_waitcnt vmcnt(20) lgkmcnt(0)
    v_mfma_f32_32x32x16_bf16 v[0:15], v[64:67], v[152:155], v[0:15]
    ds_read_b64_tr_b16 v[80:81], v116 offset:16384
    ds_read_b64_tr_b16 v[82:83], v116 offset:17408
    ds_read_b64_tr_b16 v[84:85], v116 offset:20480
    v_mfma_f32_32x32x16_bf16 v[0:15], v[68:71], v[156:159], v[0:15]
    ds_read_b64_tr_b16 v[86:87], v116 offset:21504
    ds_read_b64_tr_b16 v[88:89], v116 offset:24576
    ds_read_b64_tr_b16 v[90:91], v116 offset:25600
    v_mfma_f32_32x32x16_bf16 v[0:15], v[72:75], v[160:163], v[0:15]
    ds_read_b64_tr_b16 v[92:93], v116 offset:28672
    ds_read_b64_tr_b16 v[94:95], v116 offset:29696
    v_mfma_f32_32x32x16_bf16 v[0:15], v[76:79], v[164:167], v[0:15]
    buffer_load_dwordx4 v[136:139], v129, s[4:7], s46 offen offset:256 sc1
    buffer_load_dwordx4 v[140:143], v129, s[4:7], s46 offen offset:288 sc1
    buffer_load_dwordx4 v[144:147], v129, s[4:7], s46 offen offset:320 sc1
    buffer_load_dwordx4 v[148:151], v129, s[4:7], s46 offen offset:352 sc1
    s_waitcnt vmcnt(20) lgkmcnt(0)
    v_mfma_f32_32x32x16_bf16 v[0:15], v[80:83], v[168:171], v[0:15]
    ds_read_b64_tr_b16 v[64:65], v116 offset:32768
    ds_read_b64_tr_b16 v[66:67], v116 offset:33792
    ds_read_b64_tr_b16 v[68:69], v116 offset:36864
    v_mfma_f32_32x32x16_bf16 v[0:15], v[84:87], v[172:175], v[0:15]
    ds_read_b64_tr_b16 v[70:71], v116 offset:37888
    ds_read_b64_tr_b16 v[72:73], v116 offset:40960
    ds_read_b64_tr_b16 v[74:75], v116 offset:41984
    v_mfma_f32_32x32x16_bf16 v[0:15], v[88:91], v[176:179], v[0:15]
    ds_read_b64_tr_b16 v[76:77], v116 offset:45056
    ds_read_b64_tr_b16 v[78:79], v116 offset:46080
    v_mfma_f32_32x32x16_bf16 v[0:15], v[92:95], v[180:183], v[0:15]
    s_waitcnt vmcnt(16) lgkmcnt(0)
    v_mfma_f32_32x32x16_bf16 v[0:15], v[64:67], v[184:187], v[0:15]
    ds_read_b64_tr_b16 v[80:81], v116 offset:49152
    ds_read_b64_tr_b16 v[82:83], v116 offset:50176
    ds_read_b64_tr_b16 v[84:85], v116 offset:53248
    v_mfma_f32_32x32x16_bf16 v[0:15], v[68:71], v[188:191], v[0:15]
    ds_read_b64_tr_b16 v[86:87], v116 offset:54272
    ds_read_b64_tr_b16 v[88:89], v116 offset:57344
    ds_read_b64_tr_b16 v[90:91], v116 offset:58368
    v_mfma_f32_32x32x16_bf16 v[0:15], v[72:75], v[192:195], v[0:15]
    ds_read_b64_tr_b16 v[92:93], v116 offset:61440
    ds_read_b64_tr_b16 v[94:95], v116 offset:62464
    v_mfma_f32_32x32x16_bf16 v[0:15], v[76:79], v[196:199], v[0:15]
    s_waitcnt vmcnt(12) lgkmcnt(0)
    v_mfma_f32_32x32x16_bf16 v[0:15], v[80:83], v[200:203], v[0:15]
    ds_read_b64_tr_b16 v[64:65], v117 offset:0
    ds_read_b64_tr_b16 v[66:67], v117 offset:1024
    ds_read_b64_tr_b16 v[68:69], v117 offset:4096
    v_mfma_f32_32x32x16_bf16 v[0:15], v[84:87], v[204:207], v[0:15]
    ds_read_b64_tr_b16 v[70:71], v117 offset:5120
    ds_read_b64_tr_b16 v[72:73], v117 offset:8192
    ds_read_b64_tr_b16 v[74:75], v117 offset:9216
    v_mfma_f32_32x32x16_bf16 v[0:15], v[88:91], v[208:211], v[0:15]
    ds_read_b64_tr_b16 v[76:77], v117 offset:12288
    ds_read_b64_tr_b16 v[78:79], v117 offset:13312
    v_mfma_f32_32x32x16_bf16 v[0:15], v[92:95], v[212:215], v[0:15]
    s_waitcnt vmcnt(4) lgkmcnt(0)
    v_mfma_f32_32x32x16_bf16 v[16:31], v[64:67], v[152:155], v[16:31]
    ds_read_b64_tr_b16 v[80:81], v117 offset:16384
    ds_read_b64_tr_b16 v[82:83], v117 offset:17408
    ds_read_b64_tr_b16 v[84:85], v117 offset:20480
    v_mfma_f32_32x32x16_bf16 v[16:31], v[68:71], v[156:159], v[16:31]
    ds_read_b64_tr_b16 v[86:87], v117 offset:21504
    ds_read_b64_tr_b16 v[88:89], v117 offset:24576
    ds_read_b64_tr_b16 v[90:91], v117 offset:25600
    v_mfma_f32_32x32x16_bf16 v[16:31], v[72:75], v[160:163], v[16:31]
    ds_read_b64_tr_b16 v[92:93], v117 offset:28672
    ds_read_b64_tr_b16 v[94:95], v117 offset:29696
    v_mfma_f32_32x32x16_bf16 v[16:31], v[76:79], v[164:167], v[16:31]
    v_fmac_f32 v0, v216, v120
    v_fmac_f32 v1, v217, v120
    v_fmac_f32 v2, v218, v120
    v_fmac_f32 v3, v219, v120
    v_mul_f32 v0, v0, v121
    v_mul_f32 v1, v1, v121
    s_waitcnt vmcnt(20) lgkmcnt(0)
    v_mfma_f32_32x32x16_bf16 v[16:31], v[80:83], v[168:171], v[16:31]
    ds_read_b64_tr_b16 v[64:65], v117 offset:32768
    ds_read_b64_tr_b16 v[66:67], v117 offset:33792
    ds_read_b64_tr_b16 v[68:69], v117 offset:36864
    v_mul_f32 v2, v2, v121
    v_mul_f32 v3, v3, v121
    v_cvt_pk_bf16_f32 v0, v0, v1
    v_mfma_f32_32x32x16_bf16 v[16:31], v[84:87], v[172:175], v[16:31]
    ds_read_b64_tr_b16 v[70:71], v117 offset:37888
    ds_read_b64_tr_b16 v[72:73], v117 offset:40960
    ds_read_b64_tr_b16 v[74:75], v117 offset:41984
    v_cvt_pk_bf16_f32 v1, v2, v3
    buffer_store_dwordx2 v[0:1], v96, s[20:23], s37 offen sc1
    v_fmac_f32 v4, v220, v120
    v_mfma_f32_32x32x16_bf16 v[16:31], v[88:91], v[176:179], v[16:31]
    ds_read_b64_tr_b16 v[76:77], v117 offset:45056
    ds_read_b64_tr_b16 v[78:79], v117 offset:46080
    v_fmac_f32 v5, v221, v120
    v_fmac_f32 v6, v222, v120
    v_fmac_f32 v7, v223, v120
    v_mfma_f32_32x32x16_bf16 v[16:31], v[92:95], v[180:183], v[16:31]
    v_mul_f32 v4, v4, v121
    v_mul_f32 v5, v5, v121
    v_mul_f32 v6, v6, v121
    v_mul_f32 v7, v7, v121
    v_cvt_pk_bf16_f32 v4, v4, v5
    v_cvt_pk_bf16_f32 v5, v6, v7
    s_waitcnt vmcnt(17) lgkmcnt(0)
    v_mfma_f32_32x32x16_bf16 v[16:31], v[64:67], v[184:187], v[16:31]
    ds_read_b64_tr_b16 v[80:81], v117 offset:49152
    ds_read_b64_tr_b16 v[82:83], v117 offset:50176
    ds_read_b64_tr_b16 v[84:85], v117 offset:53248
    buffer_store_dwordx2 v[4:5], v97, s[20:23], s37 offen sc1
    v_fmac_f32 v8, v224, v120
    v_fmac_f32 v9, v225, v120
    v_mfma_f32_32x32x16_bf16 v[16:31], v[68:71], v[188:191], v[16:31]
    ds_read_b64_tr_b16 v[86:87], v117 offset:54272
    ds_read_b64_tr_b16 v[88:89], v117 offset:57344
    ds_read_b64_tr_b16 v[90:91], v117 offset:58368
    v_fmac_f32 v10, v226, v120
    v_fmac_f32 v11, v227, v120
    v_mul_f32 v8, v8, v121
    v_mfma_f32_32x32x16_bf16 v[16:31], v[72:75], v[192:195], v[16:31]
    ds_read_b64_tr_b16 v[92:93], v117 offset:61440
    ds_read_b64_tr_b16 v[94:95], v117 offset:62464
    v_mul_f32 v9, v9, v121
    v_mul_f32 v10, v10, v121
    v_mul_f32 v11, v11, v121
    v_mfma_f32_32x32x16_bf16 v[16:31], v[76:79], v[196:199], v[16:31]
    v_cvt_pk_bf16_f32 v8, v8, v9
    v_cvt_pk_bf16_f32 v9, v10, v11
    buffer_store_dwordx2 v[8:9], v98, s[20:23], s37 offen sc1
    v_fmac_f32 v12, v228, v120
    v_fmac_f32 v13, v229, v120
    v_fmac_f32 v14, v230, v120
    s_waitcnt vmcnt(15) lgkmcnt(0)
    v_mfma_f32_32x32x16_bf16 v[16:31], v[80:83], v[200:203], v[16:31]
    ds_read_b64_tr_b16 v[64:65], v118 offset:0
    ds_read_b64_tr_b16 v[66:67], v118 offset:1024
    ds_read_b64_tr_b16 v[68:69], v118 offset:4096
    v_fmac_f32 v15, v231, v120
    v_mul_f32 v12, v12, v121
    v_mul_f32 v13, v13, v121
    v_mfma_f32_32x32x16_bf16 v[16:31], v[84:87], v[204:207], v[16:31]
    ds_read_b64_tr_b16 v[70:71], v118 offset:5120
    ds_read_b64_tr_b16 v[72:73], v118 offset:8192
    ds_read_b64_tr_b16 v[74:75], v118 offset:9216
    v_mul_f32 v14, v14, v121
    v_mul_f32 v15, v15, v121
    v_cvt_pk_bf16_f32 v12, v12, v13
    v_mfma_f32_32x32x16_bf16 v[16:31], v[88:91], v[208:211], v[16:31]
    ds_read_b64_tr_b16 v[76:77], v118 offset:12288
    ds_read_b64_tr_b16 v[78:79], v118 offset:13312
    v_cvt_pk_bf16_f32 v13, v14, v15
    buffer_store_dwordx2 v[12:13], v99, s[20:23], s37 offen sc1
    v_mfma_f32_32x32x16_bf16 v[16:31], v[92:95], v[212:215], v[16:31]
    buffer_load_dwordx4 v[216:219], v129, s[4:7], s46 offen offset:384 sc1
    buffer_load_dwordx4 v[220:223], v129, s[4:7], s46 offen offset:416 sc1
    buffer_load_dwordx4 v[224:227], v129, s[4:7], s46 offen offset:448 sc1
    buffer_load_dwordx4 v[228:231], v129, s[4:7], s46 offen offset:480 sc1
    s_waitcnt vmcnt(12) lgkmcnt(0)
    v_mfma_f32_32x32x16_bf16 v[32:47], v[64:67], v[152:155], v[32:47]
    ds_read_b64_tr_b16 v[80:81], v118 offset:16384
    ds_read_b64_tr_b16 v[82:83], v118 offset:17408
    ds_read_b64_tr_b16 v[84:85], v118 offset:20480
    v_mfma_f32_32x32x16_bf16 v[32:47], v[68:71], v[156:159], v[32:47]
    ds_read_b64_tr_b16 v[86:87], v118 offset:21504
    ds_read_b64_tr_b16 v[88:89], v118 offset:24576
    ds_read_b64_tr_b16 v[90:91], v118 offset:25600
    v_mfma_f32_32x32x16_bf16 v[32:47], v[72:75], v[160:163], v[32:47]
    ds_read_b64_tr_b16 v[92:93], v118 offset:28672
    ds_read_b64_tr_b16 v[94:95], v118 offset:29696
    v_mfma_f32_32x32x16_bf16 v[32:47], v[76:79], v[164:167], v[32:47]
    v_fmac_f32 v16, v232, v120
    v_fmac_f32 v17, v233, v120
    v_fmac_f32 v18, v234, v120
    v_fmac_f32 v19, v235, v120
    v_mul_f32 v16, v16, v121
    v_mul_f32 v17, v17, v121
    s_waitcnt vmcnt(28) lgkmcnt(0)
    v_mfma_f32_32x32x16_bf16 v[32:47], v[80:83], v[168:171], v[32:47]
    ds_read_b64_tr_b16 v[64:65], v118 offset:32768
    ds_read_b64_tr_b16 v[66:67], v118 offset:33792
    ds_read_b64_tr_b16 v[68:69], v118 offset:36864
    v_mul_f32 v18, v18, v121
    v_mul_f32 v19, v19, v121
    v_cvt_pk_bf16_f32 v16, v16, v17
    v_mfma_f32_32x32x16_bf16 v[32:47], v[84:87], v[172:175], v[32:47]
    ds_read_b64_tr_b16 v[70:71], v118 offset:37888
    ds_read_b64_tr_b16 v[72:73], v118 offset:40960
    ds_read_b64_tr_b16 v[74:75], v118 offset:41984
    v_cvt_pk_bf16_f32 v17, v18, v19
    buffer_store_dwordx2 v[16:17], v100, s[20:23], s37 offen sc1
    v_fmac_f32 v20, v236, v120
    v_mfma_f32_32x32x16_bf16 v[32:47], v[88:91], v[176:179], v[32:47]
    ds_read_b64_tr_b16 v[76:77], v118 offset:45056
    ds_read_b64_tr_b16 v[78:79], v118 offset:46080
    v_fmac_f32 v21, v237, v120
    v_fmac_f32 v22, v238, v120
    v_fmac_f32 v23, v239, v120
    v_mfma_f32_32x32x16_bf16 v[32:47], v[92:95], v[180:183], v[32:47]
    v_mul_f32 v20, v20, v121
    v_mul_f32 v21, v21, v121
    v_mul_f32 v22, v22, v121
    v_mul_f32 v23, v23, v121
    v_cvt_pk_bf16_f32 v20, v20, v21
    v_cvt_pk_bf16_f32 v21, v22, v23
    s_waitcnt vmcnt(25) lgkmcnt(0)
    v_mfma_f32_32x32x16_bf16 v[32:47], v[64:67], v[184:187], v[32:47]
    ds_read_b64_tr_b16 v[80:81], v118 offset:49152
    ds_read_b64_tr_b16 v[82:83], v118 offset:50176
    ds_read_b64_tr_b16 v[84:85], v118 offset:53248
    buffer_store_dwordx2 v[20:21], v101, s[20:23], s37 offen sc1
    v_fmac_f32 v24, v240, v120
    v_fmac_f32 v25, v241, v120
    v_mfma_f32_32x32x16_bf16 v[32:47], v[68:71], v[188:191], v[32:47]
    ds_read_b64_tr_b16 v[86:87], v118 offset:54272
    ds_read_b64_tr_b16 v[88:89], v118 offset:57344
    ds_read_b64_tr_b16 v[90:91], v118 offset:58368
    v_fmac_f32 v26, v242, v120
    v_fmac_f32 v27, v243, v120
    v_mul_f32 v24, v24, v121
    v_mfma_f32_32x32x16_bf16 v[32:47], v[72:75], v[192:195], v[32:47]
    ds_read_b64_tr_b16 v[92:93], v118 offset:61440
    ds_read_b64_tr_b16 v[94:95], v118 offset:62464
    v_mul_f32 v25, v25, v121
    v_mul_f32 v26, v26, v121
    v_mul_f32 v27, v27, v121
    v_mfma_f32_32x32x16_bf16 v[32:47], v[76:79], v[196:199], v[32:47]
    v_cvt_pk_bf16_f32 v24, v24, v25
    v_cvt_pk_bf16_f32 v25, v26, v27
    buffer_store_dwordx2 v[24:25], v102, s[20:23], s37 offen sc1
    v_fmac_f32 v28, v244, v120
    v_fmac_f32 v29, v245, v120
    v_fmac_f32 v30, v246, v120
    s_waitcnt vmcnt(23) lgkmcnt(0)
    v_mfma_f32_32x32x16_bf16 v[32:47], v[80:83], v[200:203], v[32:47]
    ds_read_b64_tr_b16 v[64:65], v119 offset:0
    ds_read_b64_tr_b16 v[66:67], v119 offset:1024
    ds_read_b64_tr_b16 v[68:69], v119 offset:4096
    v_fmac_f32 v31, v247, v120
    v_mul_f32 v28, v28, v121
    v_mul_f32 v29, v29, v121
    v_mfma_f32_32x32x16_bf16 v[32:47], v[84:87], v[204:207], v[32:47]
    ds_read_b64_tr_b16 v[70:71], v119 offset:5120
    ds_read_b64_tr_b16 v[72:73], v119 offset:8192
    ds_read_b64_tr_b16 v[74:75], v119 offset:9216
    v_mul_f32 v30, v30, v121
    v_mul_f32 v31, v31, v121
    v_cvt_pk_bf16_f32 v28, v28, v29
    v_mfma_f32_32x32x16_bf16 v[32:47], v[88:91], v[208:211], v[32:47]
    ds_read_b64_tr_b16 v[76:77], v119 offset:12288
    ds_read_b64_tr_b16 v[78:79], v119 offset:13312
    v_cvt_pk_bf16_f32 v29, v30, v31
    buffer_store_dwordx2 v[28:29], v103, s[20:23], s37 offen sc1
    v_mfma_f32_32x32x16_bf16 v[32:47], v[92:95], v[212:215], v[32:47]
    s_waitcnt vmcnt(12) lgkmcnt(0)
    v_mfma_f32_32x32x16_bf16 v[48:63], v[64:67], v[152:155], v[48:63]
    ds_read_b64_tr_b16 v[80:81], v119 offset:16384
    ds_read_b64_tr_b16 v[82:83], v119 offset:17408
    ds_read_b64_tr_b16 v[84:85], v119 offset:20480
    v_mfma_f32_32x32x16_bf16 v[48:63], v[68:71], v[156:159], v[48:63]
    ds_read_b64_tr_b16 v[86:87], v119 offset:21504
    ds_read_b64_tr_b16 v[88:89], v119 offset:24576
    ds_read_b64_tr_b16 v[90:91], v119 offset:25600
    v_mfma_f32_32x32x16_bf16 v[48:63], v[72:75], v[160:163], v[48:63]
    ds_read_b64_tr_b16 v[92:93], v119 offset:28672
    ds_read_b64_tr_b16 v[94:95], v119 offset:29696
    v_mfma_f32_32x32x16_bf16 v[48:63], v[76:79], v[164:167], v[48:63]
    v_fmac_f32 v32, v136, v120
    v_fmac_f32 v33, v137, v120
    v_fmac_f32 v34, v138, v120
    v_fmac_f32 v35, v139, v120
    v_mul_f32 v32, v32, v121
    v_mul_f32 v33, v33, v121
    s_waitcnt vmcnt(32) lgkmcnt(0)
    v_mfma_f32_32x32x16_bf16 v[48:63], v[80:83], v[168:171], v[48:63]
    ds_read_b64_tr_b16 v[64:65], v119 offset:32768
    ds_read_b64_tr_b16 v[66:67], v119 offset:33792
    ds_read_b64_tr_b16 v[68:69], v119 offset:36864
    v_mul_f32 v34, v34, v121
    v_mul_f32 v35, v35, v121
    v_cvt_pk_bf16_f32 v32, v32, v33
    v_mfma_f32_32x32x16_bf16 v[48:63], v[84:87], v[172:175], v[48:63]
    ds_read_b64_tr_b16 v[70:71], v119 offset:37888
    ds_read_b64_tr_b16 v[72:73], v119 offset:40960
    ds_read_b64_tr_b16 v[74:75], v119 offset:41984
    v_cvt_pk_bf16_f32 v33, v34, v35
    buffer_store_dwordx2 v[32:33], v104, s[20:23], s37 offen sc1
    v_fmac_f32 v36, v140, v120
    v_mfma_f32_32x32x16_bf16 v[48:63], v[88:91], v[176:179], v[48:63]
    ds_read_b64_tr_b16 v[76:77], v119 offset:45056
    ds_read_b64_tr_b16 v[78:79], v119 offset:46080
    v_fmac_f32 v37, v141, v120
    v_fmac_f32 v38, v142, v120
    v_fmac_f32 v39, v143, v120
    v_mfma_f32_32x32x16_bf16 v[48:63], v[92:95], v[180:183], v[48:63]
    v_mul_f32 v36, v36, v121
    v_mul_f32 v37, v37, v121
    v_mul_f32 v38, v38, v121
    v_mul_f32 v39, v39, v121
    v_cvt_pk_bf16_f32 v36, v36, v37
    v_cvt_pk_bf16_f32 v37, v38, v39
    s_waitcnt vmcnt(29) lgkmcnt(0)
    v_mfma_f32_32x32x16_bf16 v[48:63], v[64:67], v[184:187], v[48:63]
    ds_read_b64_tr_b16 v[80:81], v119 offset:49152
    ds_read_b64_tr_b16 v[82:83], v119 offset:50176
    ds_read_b64_tr_b16 v[84:85], v119 offset:53248
    buffer_store_dwordx2 v[36:37], v105, s[20:23], s37 offen sc1
    v_fmac_f32 v40, v144, v120
    v_fmac_f32 v41, v145, v120
    v_mfma_f32_32x32x16_bf16 v[48:63], v[68:71], v[188:191], v[48:63]
    ds_read_b64_tr_b16 v[86:87], v119 offset:54272
    ds_read_b64_tr_b16 v[88:89], v119 offset:57344
    ds_read_b64_tr_b16 v[90:91], v119 offset:58368
    v_fmac_f32 v42, v146, v120
    v_fmac_f32 v43, v147, v120
    v_mul_f32 v40, v40, v121
    v_mfma_f32_32x32x16_bf16 v[48:63], v[72:75], v[192:195], v[48:63]
    ds_read_b64_tr_b16 v[92:93], v119 offset:61440
    ds_read_b64_tr_b16 v[94:95], v119 offset:62464
    v_mul_f32 v41, v41, v121
    v_mul_f32 v42, v42, v121
    v_mul_f32 v43, v43, v121
    v_mfma_f32_32x32x16_bf16 v[48:63], v[76:79], v[196:199], v[48:63]
    v_cvt_pk_bf16_f32 v40, v40, v41
    v_cvt_pk_bf16_f32 v41, v42, v43
    buffer_store_dwordx2 v[40:41], v106, s[20:23], s37 offen sc1
    v_fmac_f32 v44, v148, v120
    v_fmac_f32 v45, v149, v120
    v_fmac_f32 v46, v150, v120
    s_waitcnt vmcnt(27) lgkmcnt(0)
    v_mfma_f32_32x32x16_bf16 v[48:63], v[80:83], v[200:203], v[48:63]
    v_fmac_f32 v47, v151, v120
    v_mul_f32 v44, v44, v121
    v_mul_f32 v45, v45, v121
    v_mul_f32 v46, v46, v121
    v_mul_f32 v47, v47, v121
    v_cvt_pk_bf16_f32 v44, v44, v45
    v_mfma_f32_32x32x16_bf16 v[48:63], v[84:87], v[204:207], v[48:63]
    v_cvt_pk_bf16_f32 v45, v46, v47
    buffer_store_dwordx2 v[44:45], v107, s[20:23], s37 offen sc1
    v_mfma_f32_32x32x16_bf16 v[48:63], v[88:91], v[208:211], v[48:63]
    v_mfma_f32_32x32x16_bf16 v[48:63], v[92:95], v[212:215], v[48:63]
    s_waitcnt vmcnt(8)
    s_nop 7
    s_nop 3
    v_fmac_f32 v48, v216, v120
    v_fmac_f32 v49, v217, v120
    v_fmac_f32 v50, v218, v120
    v_fmac_f32 v51, v219, v120
    v_mul_f32 v48, v48, v121
    v_mul_f32 v49, v49, v121
    v_mul_f32 v50, v50, v121
    v_mul_f32 v51, v51, v121
    v_cvt_pk_bf16_f32 v48, v48, v49
    v_cvt_pk_bf16_f32 v49, v50, v51
    buffer_store_dwordx2 v[48:49], v108, s[20:23], s37 offen sc1
    v_fmac_f32 v52, v220, v120
    v_fmac_f32 v53, v221, v120
    v_fmac_f32 v54, v222, v120
    v_fmac_f32 v55, v223, v120
    v_mul_f32 v52, v52, v121
    v_mul_f32 v53, v53, v121
    v_mul_f32 v54, v54, v121
    v_mul_f32 v55, v55, v121
    v_cvt_pk_bf16_f32 v52, v52, v53
    v_cvt_pk_bf16_f32 v53, v54, v55
    buffer_store_dwordx2 v[52:53], v109, s[20:23], s37 offen sc1
    v_fmac_f32 v56, v224, v120
    v_fmac_f32 v57, v225, v120
    v_fmac_f32 v58, v226, v120
    v_fmac_f32 v59, v227, v120
    v_mul_f32 v56, v56, v121
    v_mul_f32 v57, v57, v121
    v_mul_f32 v58, v58, v121
    v_mul_f32 v59, v59, v121
    v_cvt_pk_bf16_f32 v56, v56, v57
    v_cvt_pk_bf16_f32 v57, v58, v59
    buffer_store_dwordx2 v[56:57], v110, s[20:23], s37 offen sc1
    v_fmac_f32 v60, v228, v120
    v_fmac_f32 v61, v229, v120
    v_fmac_f32 v62, v230, v120
    v_fmac_f32 v63, v231, v120
    v_mul_f32 v60, v60, v121
    v_mul_f32 v61, v61, v121
    v_mul_f32 v62, v62, v121
    v_mul_f32 v63, v63, v121
    v_cvt_pk_bf16_f32 v60, v60, v61
    v_cvt_pk_bf16_f32 v61, v62, v63
    buffer_store_dwordx2 v[60:61], v111, s[20:23], s37 offen sc1
    s_branch L_q_sig
L_q1_v:
    s_mul_i32 s37, s32, 2560
    s_add_u32 s37, s37, 0x300500
    s_mov_b32 s36, 163840
    v_mul_u32_u24 v122, 320, v112
    s_mov_b32 s30, 0
    s_lshl_b32 s31, s26, 7
    s_add_u32 s30, s30, s31
    v_add_u32 v124, s30, v113
    v_mul_u32_u24 v125, 3277, v124
    v_lshrrev_b32 v125, 16, v125
    v_mul_u32_u24 v126, 20, v125
    v_sub_u32 v124, v124, v126
    v_lshl_add_u32 v124, v124, 4, v122
    v_mad_u32_u24 v96, v125, s36, v124
    s_mov_b32 s30, 32
    s_lshl_b32 s31, s26, 7
    s_add_u32 s30, s30, s31
    v_add_u32 v124, s30, v113
    v_mul_u32_u24 v125, 3277, v124
    v_lshrrev_b32 v125, 16, v125
    v_mul_u32_u24 v126, 20, v125
    v_sub_u32 v124, v124, v126
    v_lshl_add_u32 v124, v124, 4, v122
    v_mad_u32_u24 v97, v125, s36, v124
    s_mov_b32 s30, 64
    s_lshl_b32 s31, s26, 7
    s_add_u32 s30, s30, s31
    v_add_u32 v124, s30, v113
    v_mul_u32_u24 v125, 3277, v124
    v_lshrrev_b32 v125, 16, v125
    v_mul_u32_u24 v126, 20, v125
    v_sub_u32 v124, v124, v126
    v_lshl_add_u32 v124, v124, 4, v122
    v_mad_u32_u24 v98, v125, s36, v124
    s_mov_b32 s30, 96
    s_lshl_b32 s31, s26, 7
    s_add_u32 s30, s30, s31
    v_add_u32 v124, s30, v113
    v_mul_u32_u24 v125, 3277, v124
    v_lshrrev_b32 v125, 16, v125
    v_mul_u32_u24 v126, 20, v125
    v_sub_u32 v124, v124, v126
    v_lshl_add_u32 v124, v124, 4, v122
    v_mad_u32_u24 v99, v125, s36, v124
    v_mov_b32 v250, s90
    v_lshlrev_b32 v251, 15, v252
    s_waitcnt vmcnt(0) lgkmcnt(0)
    s_barrier
    s_cmp_lg_u32 s24, 3
    s_cbranch_scc1 L_sig5
    s_mov_b64 exec, 1
    buffer_store_dword v250, v251, s[4:7], s97 offen sc1
    s_mov_b64 exec, -1
L_sig5:
    v_lshlrev_b32 v128, 6, v112
    v_lshlrev_b32 v129, 2, v113
    s_mov_b32 s31, 0x3acccccd
    s_barrier
    ds_read_b64_tr_b16 v[64:65], v116 offset:0
    ds_read_b64_tr_b16 v[66:67], v116 offset:1024
    ds_read_b64_tr_b16 v[68:69], v117 offset:0
    ds_read_b64_tr_b16 v[70:71], v117 offset:1024
    ds_read_b64_tr_b16 v[72:73], v118 offset:0
    ds_read_b64_tr_b16 v[74:75], v118 offset:1024
    ds_read_b64_tr_b16 v[76:77], v119 offset:0
    ds_read_b64_tr_b16 v[78:79], v119 offset:1024
    s_mov_b32 s61, 0x40000
L_poll6:
    buffer_load_dword v250, v115, s[4:7], s44 offen sc1
    s_sub_u32 s61, s61, 1
    s_waitcnt vmcnt(0)
    s_cbranch_scc1 L_pollx7
    v_cmp_ne_u32 vcc, s90, v250
    s_cbranch_vccz L_pollx7
    s_mov_b64 exec, vcc
    s_sleep 1
    s_branch L_poll6
L_pollx7:
    s_mov_b64 exec, -1
    buffer_load_dwordx4 v[136:139], v114, s[4:7], s28 offen offset:0 sc1
    buffer_load_dwordx4 v[140:143], v114, s[4:7], s28 offen offset:1024 sc1
    buffer_load_dwordx4 v[144:147], v114, s[4:7], s28 offen offset:2048 sc1
    buffer_load_dwordx4 v[148:151], v114, s[4:7], s28 offen offset:3072 sc1
    s_add_u32 s28, s28, 4096
    buffer_load_dwordx4 v[152:155], v114, s[4:7], s28 offen offset:0 sc1
    buffer_load_dwordx4 v[156:159], v114, s[4:7], s28 offen offset:1024 sc1
    buffer_load_dwordx4 v[160:163], v114, s[4:7], s28 offen offset:2048 sc1
    buffer_load_dwordx4 v[164:167], v114, s[4:7], s28 offen offset:3072 sc1
    s_add_u32 s28, s28, 4096
    buffer_load_dwordx4 v[216:219], v128, s[4:7], s45 offen offset:0 sc1
    buffer_load_dwordx4 v[220:223], v128, s[4:7], s45 offen offset:16 sc1
    buffer_load_dwordx4 v[224:227], v128, s[4:7], s45 offen offset:32 sc1
    buffer_load_dwordx4 v[228:231], v128, s[4:7], s45 offen offset:48 sc1
    buffer_load_dwordx4 v[232:235], v128, s[4:7], s45 offen offset:128 sc1
    buffer_load_dwordx4 v[236:239], v128, s[4:7], s45 offen offset:144 sc1
    buffer_load_dwordx4 v[240:243], v128, s[4:7], s45 offen offset:160 sc1
    buffer_load_dwordx4 v[244:247], v128, s[4:7], s45 offen offset:176 sc1
    buffer_load_dword v100, v129, s[4:7], s46 offen offset:0 sc1
    buffer_load_dword v101, v129, s[4:7], s46 offen offset:128 sc1
    buffer_load_dword v102, v129, s[4:7], s46 offen offset:256 sc1
    buffer_load_dword v103, v129, s[4:7], s46 offen offset:384 sc1
    s_waitcnt vmcnt(19) lgkmcnt(0)
    v_mfma_f32_32x32x16_bf16 v[0:15], v[136:139], v[64:67], 0
    ds_read_b64_tr_b16 v[80:81], v116 offset:4096
    ds_read_b64_tr_b16 v[82:83], v116 offset:5120
    ds_read_b64_tr_b16 v[84:85], v117 offset:4096
    v_mfma_f32_32x32x16_bf16 v[16:31], v[136:139], v[68:71], 0
    ds_read_b64_tr_b16 v[86:87], v117 offset:5120
    ds_read_b64_tr_b16 v[88:89], v118 offset:4096
    ds_read_b64_tr_b16 v[90:91], v118 offset:5120
    v_mfma_f32_32x32x16_bf16 v[32:47], v[136:139], v[72:75], 0
    ds_read_b64_tr_b16 v[92:93], v119 offset:4096
    ds_read_b64_tr_b16 v[94:95], v119 offset:5120
    v_mfma_f32_32x32x16_bf16 v[48:63], v[136:139], v[76:79], 0
    buffer_load_dwordx4 v[168:171], v114, s[4:7], s28 offen offset:0 sc1
    buffer_load_dwordx4 v[172:175], v114, s[4:7], s28 offen offset:1024 sc1
    s_waitcnt vmcnt(20) lgkmcnt(0)
    v_mfma_f32_32x32x16_bf16 v[0:15], v[140:143], v[80:83], v[0:15]
    ds_read_b64_tr_b16 v[64:65], v116 offset:8192
    ds_read_b64_tr_b16 v[66:67], v116 offset:9216
    ds_read_b64_tr_b16 v[68:69], v117 offset:8192
    v_mfma_f32_32x32x16_bf16 v[16:31], v[140:143], v[84:87], v[16:31]
    ds_read_b64_tr_b16 v[70:71], v117 offset:9216
    ds_read_b64_tr_b16 v[72:73], v118 offset:8192
    ds_read_b64_tr_b16 v[74:75], v118 offset:9216
    v_mfma_f32_32x32x16_bf16 v[32:47], v[140:143], v[88:91], v[32:47]
    ds_read_b64_tr_b16 v[76:77], v119 offset:8192
    ds_read_b64_tr_b16 v[78:79], v119 offset:9216
    v_mfma_f32_32x32x16_bf16 v[48:63], v[140:143], v[92:95], v[48:63]
    buffer_load_dwordx4 v[176:179], v114, s[4:7], s28 offen offset:2048 sc1
    buffer_load_dwordx4 v[180:183], v114, s[4:7], s28 offen offset:3072 sc1
    s_add_u32 s28, s28, 4096
    s_waitcnt vmcnt(21) lgkmcnt(0)
    v_mfma_f32_32x32x16_bf16 v[0:15], v[144:147], v[64:67], v[0:15]
    ds_read_b64_tr_b16 v[80:81], v116 offset:12288
    ds_read_b64_tr_b16 v[82:83], v116 offset:13312
    ds_read_b64_tr_b16 v[84:85], v117 offset:12288
    v_mfma_f32_32x32x16_bf16 v[16:31], v[144:147], v[68:71], v[16:31]
    ds_read_b64_tr_b16 v[86:87], v117 offset:13312
    ds_read_b64_tr_b16 v[88:89], v118 offset:12288
    ds_read_b64_tr_b16 v[90:91], v118 offset:13312
    v_mfma_f32_32x32x16_bf16 v[32:47], v[144:147], v[72:75], v[32:47]
    ds_read_b64_tr_b16 v[92:93], v119 offset:12288
    ds_read_b64_tr_b16 v[94:95], v119 offset:13312
    v_mfma_f32_32x32x16_bf16 v[48:63], v[144:147], v[76:79], v[48:63]
    buffer_load_dwordx4 v[184:187], v114, s[4:7], s28 offen offset:0 sc1
    buffer_load_dwordx4 v[188:191], v114, s[4:7], s28 offen offset:1024 sc1
    s_waitcnt vmcnt(22) lgkmcnt(0)
    v_mfma_f32_32x32x16_bf16 v[0:15], v[148:151], v[80:83], v[0:15]
    ds_read_b64_tr_b16 v[64:65], v116 offset:16384
    ds_read_b64_tr_b16 v[66:67], v116 offset:17408
    ds_read_b64_tr_b16 v[68:69], v117 offset:16384
    v_mfma_f32_32x32x16_bf16 v[16:31], v[148:151], v[84:87], v[16:31]
    ds_read_b64_tr_b16 v[70:71], v117 offset:17408
    ds_read_b64_tr_b16 v[72:73], v118 offset:16384
    ds_read_b64_tr_b16 v[74:75], v118 offset:17408
    v_mfma_f32_32x32x16_bf16 v[32:47], v[148:151], v[88:91], v[32:47]
    ds_read_b64_tr_b16 v[76:77], v119 offset:16384
    ds_read_b64_tr_b16 v[78:79], v119 offset:17408
    v_mfma_f32_32x32x16_bf16 v[48:63], v[148:151], v[92:95], v[48:63]
    buffer_load_dwordx4 v[192:195], v114, s[4:7], s28 offen offset:2048 sc1
    buffer_load_dwordx4 v[196:199], v114, s[4:7], s28 offen offset:3072 sc1
    s_add_u32 s28, s28, 4096
    s_waitcnt vmcnt(23) lgkmcnt(0)
    v_mfma_f32_32x32x16_bf16 v[0:15], v[152:155], v[64:67], v[0:15]
    ds_read_b64_tr_b16 v[80:81], v116 offset:20480
    ds_read_b64_tr_b16 v[82:83], v116 offset:21504
    ds_read_b64_tr_b16 v[84:85], v117 offset:20480
    v_mfma_f32_32x32x16_bf16 v[16:31], v[152:155], v[68:71], v[16:31]
    ds_read_b64_tr_b16 v[86:87], v117 offset:21504
    ds_read_b64_tr_b16 v[88:89], v118 offset:20480
    ds_read_b64_tr_b16 v[90:91], v118 offset:21504
    v_mfma_f32_32x32x16_bf16 v[32:47], v[152:155], v[72:75], v[32:47]
    ds_read_b64_tr_b16 v[92:93], v119 offset:20480
    ds_read_b64_tr_b16 v[94:95], v119 offset:21504
    v_mfma_f32_32x32x16_bf16 v[48:63], v[152:155], v[76:79], v[48:63]
    buffer_load_dwordx4 v[200:203], v114, s[4:7], s28 offen offset:0 sc1
    buffer_load_dwordx4 v[204:207], v114, s[4:7], s28 offen offset:1024 sc1
    s_waitcnt vmcnt(24) lgkmcnt(0)
    v_mfma_f32_32x32x16_bf16 v[0:15], v[156:159], v[80:83], v[0:15]
    ds_read_b64_tr_b16 v[64:65], v116 offset:24576
    ds_read_b64_tr_b16 v[66:67], v116 offset:25600
    ds_read_b64_tr_b16 v[68:69], v117 offset:24576
    v_mfma_f32_32x32x16_bf16 v[16:31], v[156:159], v[84:87], v[16:31]
    ds_read_b64_tr_b16 v[70:71], v117 offset:25600
    ds_read_b64_tr_b16 v[72:73], v118 offset:24576
    ds_read_b64_tr_b16 v[74:75], v118 offset:25600
    v_mfma_f32_32x32x16_bf16 v[32:47], v[156:159], v[88:91], v[32:47]
    ds_read_b64_tr_b16 v[76:77], v119 offset:24576
    ds_read_b64_tr_b16 v[78:79], v119 offset:25600
    v_mfma_f32_32x32x16_bf16 v[48:63], v[156:159], v[92:95], v[48:63]
    buffer_load_dwordx4 v[208:211], v114, s[4:7], s28 offen offset:2048 sc1
    buffer_load_dwordx4 v[212:215], v114, s[4:7], s28 offen offset:3072 sc1
    s_add_u32 s28, s28, 4096
    s_waitcnt vmcnt(25) lgkmcnt(0)
    v_mfma_f32_32x32x16_bf16 v[0:15], v[160:163], v[64:67], v[0:15]
    ds_read_b64_tr_b16 v[80:81], v116 offset:28672
    ds_read_b64_tr_b16 v[82:83], v116 offset:29696
    ds_read_b64_tr_b16 v[84:85], v117 offset:28672
    v_mfma_f32_32x32x16_bf16 v[16:31], v[160:163], v[68:71], v[16:31]
    ds_read_b64_tr_b16 v[86:87], v117 offset:29696
    ds_read_b64_tr_b16 v[88:89], v118 offset:28672
    ds_read_b64_tr_b16 v[90:91], v118 offset:29696
    v_mfma_f32_32x32x16_bf16 v[32:47], v[160:163], v[72:75], v[32:47]
    ds_read_b64_tr_b16 v[92:93], v119 offset:28672
    ds_read_b64_tr_b16 v[94:95], v119 offset:29696
    v_mfma_f32_32x32x16_bf16 v[48:63], v[160:163], v[76:79], v[48:63]
    buffer_load_dwordx4 v[136:139], v114, s[4:7], s28 offen offset:0 sc1
    buffer_load_dwordx4 v[140:143], v114, s[4:7], s28 offen offset:1024 sc1
    s_waitcnt vmcnt(26) lgkmcnt(0)
    v_mfma_f32_32x32x16_bf16 v[0:15], v[164:167], v[80:83], v[0:15]
    ds_read_b64_tr_b16 v[64:65], v116 offset:32768
    ds_read_b64_tr_b16 v[66:67], v116 offset:33792
    ds_read_b64_tr_b16 v[68:69], v117 offset:32768
    v_mfma_f32_32x32x16_bf16 v[16:31], v[164:167], v[84:87], v[16:31]
    ds_read_b64_tr_b16 v[70:71], v117 offset:33792
    ds_read_b64_tr_b16 v[72:73], v118 offset:32768
    ds_read_b64_tr_b16 v[74:75], v118 offset:33792
    v_mfma_f32_32x32x16_bf16 v[32:47], v[164:167], v[88:91], v[32:47]
    ds_read_b64_tr_b16 v[76:77], v119 offset:32768
    ds_read_b64_tr_b16 v[78:79], v119 offset:33792
    v_mfma_f32_32x32x16_bf16 v[48:63], v[164:167], v[92:95], v[48:63]
    buffer_load_dwordx4 v[144:147], v114, s[4:7], s28 offen offset:2048 sc1
    buffer_load_dwordx4 v[148:151], v114, s[4:7], s28 offen offset:3072 sc1
    s_add_u32 s28, s28, 4096
    s_waitcnt vmcnt(15) lgkmcnt(0)
    v_mfma_f32_32x32x16_bf16 v[0:15], v[168:171], v[64:67], v[0:15]
    ds_read_b64_tr_b16 v[80:81], v116 offset:36864
    ds_read_b64_tr_b16 v[82:83], v116 offset:37888
    ds_read_b64_tr_b16 v[84:85], v117 offset:36864
    v_mfma_f32_32x32x16_bf16 v[16:31], v[168:171], v[68:71], v[16:31]
    ds_read_b64_tr_b16 v[86:87], v117 offset:37888
    ds_read_b64_tr_b16 v[88:89], v118 offset:36864
    ds_read_b64_tr_b16 v[90:91], v118 offset:37888
    v_mfma_f32_32x32x16_bf16 v[32:47], v[168:171], v[72:75], v[32:47]
    ds_read_b64_tr_b16 v[92:93], v119 offset:36864
    ds_read_b64_tr_b16 v[94:95], v119 offset:37888
    v_mfma_f32_32x32x16_bf16 v[48:63], v[168:171], v[76:79], v[48:63]
    buffer_load_dwordx4 v[152:155], v114, s[4:7], s28 offen offset:0 sc1
    buffer_load_dwordx4 v[156:159], v114, s[4:7], s28 offen offset:1024 sc1
    s_waitcnt vmcnt(16) lgkmcnt(0)
    v_mfma_f32_32x32x16_bf16 v[0:15], v[172:175], v[80:83], v[0:15]
    ds_read_b64_tr_b16 v[64:65], v116 offset:40960
    ds_read_b64_tr_b16 v[66:67], v116 offset:41984
    ds_read_b64_tr_b16 v[68:69], v117 offset:40960
    v_mfma_f32_32x32x16_bf16 v[16:31], v[172:175], v[84:87], v[16:31]
    ds_read_b64_tr_b16 v[70:71], v117 offset:41984
    ds_read_b64_tr_b16 v[72:73], v118 offset:40960
    ds_read_b64_tr_b16 v[74:75], v118 offset:41984
    v_mfma_f32_32x32x16_bf16 v[32:47], v[172:175], v[88:91], v[32:47]
    ds_read_b64_tr_b16 v[76:77], v119 offset:40960
    ds_read_b64_tr_b16 v[78:79], v119 offset:41984
    v_mfma_f32_32x32x16_bf16 v[48:63], v[172:175], v[92:95], v[48:63]
    buffer_load_dwordx4 v[160:163], v114, s[4:7], s28 offen offset:2048 sc1
    buffer_load_dwordx4 v[164:167], v114, s[4:7], s28 offen offset:3072 sc1
    s_add_u32 s28, s28, 4096
    s_waitcnt vmcnt(17) lgkmcnt(0)
    v_mfma_f32_32x32x16_bf16 v[0:15], v[176:179], v[64:67], v[0:15]
    ds_read_b64_tr_b16 v[80:81], v116 offset:45056
    ds_read_b64_tr_b16 v[82:83], v116 offset:46080
    ds_read_b64_tr_b16 v[84:85], v117 offset:45056
    v_mul_f32 v216, 0xbacccccd, v216
    v_mfma_f32_32x32x16_bf16 v[16:31], v[176:179], v[68:71], v[16:31]
    ds_read_b64_tr_b16 v[86:87], v117 offset:46080
    ds_read_b64_tr_b16 v[88:89], v118 offset:45056
    ds_read_b64_tr_b16 v[90:91], v118 offset:46080
    v_mul_f32 v218, 0xbacccccd, v218
    v_mfma_f32_32x32x16_bf16 v[32:47], v[176:179], v[72:75], v[32:47]
    ds_read_b64_tr_b16 v[92:93], v119 offset:45056
    ds_read_b64_tr_b16 v[94:95], v119 offset:46080
    v_mul_f32 v220, 0xbacccccd, v220
    v_mfma_f32_32x32x16_bf16 v[48:63], v[176:179], v[76:79], v[48:63]
    v_mul_f32 v222, 0xbacccccd, v222
    v_mul_f32 v122, v216, v216
    v_mul_f32 v123, v218, v218
    v_mul_f32 v124, v220, v220
    buffer_load_dwordx4 v[168:171], v114, s[4:7], s28 offen offset:0 sc1
    buffer_load_dwordx4 v[172:175], v114, s[4:7], s28 offen offset:1024 sc1
    s_waitcnt vmcnt(18) lgkmcnt(0)
    v_mfma_f32_32x32x16_bf16 v[0:15], v[180:183], v[80:83], v[0:15]
    ds_read_b64_tr_b16 v[64:65], v116 offset:49152
    ds_read_b64_tr_b16 v[66:67], v116 offset:50176
    ds_read_b64_tr_b16 v[68:69], v117 offset:49152
    v_mul_f32 v125, v222, v222
    v_mfma_f32_32x32x16_bf16 v[16:31], v[180:183], v[84:87], v[16:31]
    ds_read_b64_tr_b16 v[70:71], v117 offset:50176
    ds_read_b64_tr_b16 v[72:73], v118 offset:49152
    ds_read_b64_tr_b16 v[74:75], v118 offset:50176
    v_fma_f32 v217, v217, s31, -v122
    v_mfma_f32_32x32x16_bf16 v[32:47], v[180:183], v[88:91], v[32:47]
    ds_read_b64_tr_b16 v[76:77], v119 offset:49152
    ds_read_b64_tr_b16 v[78:79], v119 offset:50176
    v_fma_f32 v219, v219, s31, -v123
    v_mfma_f32_32x32x16_bf16 v[48:63], v[180:183], v[92:95], v[48:63]
    v_fma_f32 v221, v221, s31, -v124
    v_fma_f32 v223, v223, s31, -v125
    v_max_f32 v217, 0, v217
    v_max_f32 v219, 0, v219
    buffer_load_dwordx4 v[176:179], v114, s[4:7], s28 offen offset:2048 sc1
    buffer_load_dwordx4 v[180:183], v114, s[4:7], s28 offen offset:3072 sc1
    s_add_u32 s28, s28, 4096
    s_waitcnt vmcnt(19) lgkmcnt(0)
    v_mfma_f32_32x32x16_bf16 v[0:15], v[184:187], v[64:67], v[0:15]
    ds_read_b64_tr_b16 v[80:81], v116 offset:53248
    ds_read_b64_tr_b16 v[82:83], v116 offset:54272
    ds_read_b64_tr_b16 v[84:85], v117 offset:53248
    v_max_f32 v221, 0, v221
    v_mfma_f32_32x32x16_bf16 v[16:31], v[184:187], v[68:71], v[16:31]
    ds_read_b64_tr_b16 v[86:87], v117 offset:54272
    ds_read_b64_tr_b16 v[88:89], v118 offset:53248
    ds_read_b64_tr_b16 v[90:91], v118 offset:54272
    v_max_f32 v223, 0, v223
    v_mfma_f32_32x32x16_bf16 v[32:47], v[184:187], v[72:75], v[32:47]
    ds_read_b64_tr_b16 v[92:93], v119 offset:53248
    ds_read_b64_tr_b16 v[94:95], v119 offset:54272
    v_add_f32 v217, 0x3727c5ac, v217
    v_mfma_f32_32x32x16_bf16 v[48:63], v[184:187], v[76:79], v[48:63]
    v_add_f32 v219, 0x3727c5ac, v219
    v_add_f32 v221, 0x3727c5ac, v221
    v_add_f32 v223, 0x3727c5ac, v223
    v_rsq_f32 v217, v217
    buffer_load_dwordx4 v[184:187], v114, s[4:7], s28 offen offset:0 sc1
    s_waitcnt vmcnt(19) lgkmcnt(0)
    v_mfma_f32_32x32x16_bf16 v[0:15], v[188:191], v[80:83], v[0:15]
    ds_read_b64_tr_b16 v[64:65], v116 offset:57344
    ds_read_b64_tr_b16 v[66:67], v116 offset:58368
    ds_read_b64_tr_b16 v[68:69], v117 offset:57344
    v_rsq_f32 v219, v219
    v_mfma_f32_32x32x16_bf16 v[16:31], v[188:191], v[84:87], v[16:31]
    ds_read_b64_tr_b16 v[70:71], v117 offset:58368
    ds_read_b64_tr_b16 v[72:73], v118 offset:57344
    ds_read_b64_tr_b16 v[74:75], v118 offset:58368
    v_rsq_f32 v221, v221
    v_mfma_f32_32x32x16_bf16 v[32:47], v[188:191], v[88:91], v[32:47]
    ds_read_b64_tr_b16 v[76:77], v119 offset:57344
    ds_read_b64_tr_b16 v[78:79], v119 offset:58368
    v_rsq_f32 v223, v223
    v_mfma_f32_32x32x16_bf16 v[48:63], v[188:191], v[92:95], v[48:63]
    v_mul_f32 v224, 0xbacccccd, v224
    v_mul_f32 v226, 0xbacccccd, v226
    v_mul_f32 v228, 0xbacccccd, v228
    v_mul_f32 v230, 0xbacccccd, v230
    buffer_load_dwordx4 v[188:191], v114, s[4:7], s28 offen offset:1024 sc1
    s_waitcnt vmcnt(19) lgkmcnt(0)
    v_mfma_f32_32x32x16_bf16 v[0:15], v[192:195], v[64:67], v[0:15]
    ds_read_b64_tr_b16 v[80:81], v116 offset:61440
    ds_read_b64_tr_b16 v[82:83], v116 offset:62464
    ds_read_b64_tr_b16 v[84:85], v117 offset:61440
    v_mul_f32 v122, v224, v224
    v_mfma_f32_32x32x16_bf16 v[16:31], v[192:195], v[68:71], v[16:31]
    ds_read_b64_tr_b16 v[86:87], v117 offset:62464
    ds_read_b64_tr_b16 v[88:89], v118 offset:61440
    ds_read_b64_tr_b16 v[90:91], v118 offset:62464
    v_mul_f32 v123, v226, v226
    v_mfma_f32_32x32x16_bf16 v[32:47], v[192:195], v[72:75], v[32:47]
    ds_read_b64_tr_b16 v[92:93], v119 offset:61440
    ds_read_b64_tr_b16 v[94:95], v119 offset:62464
    v_mul_f32 v124, v228, v228
    v_mfma_f32_32x32x16_bf16 v[48:63], v[192:195], v[76:79], v[48:63]
    v_mul_f32 v125, v230, v230
    v_fma_f32 v225, v225, s31, -v122
    v_fma_f32 v227, v227, s31, -v123
    v_fma_f32 v229, v229, s31, -v124
    buffer_load_dwordx4 v[192:195], v114, s[4:7], s28 offen offset:2048 sc1
    s_waitcnt vmcnt(19) lgkmcnt(0)
    v_mfma_f32_32x32x16_bf16 v[0:15], v[196:199], v[80:83], v[0:15]
    v_add_u32 v116, 0x10000, v116
    v_add_u32 v117, 0x10000, v117
    v_add_u32 v118, 0x10000, v118
    v_add_u32 v119, 0x10000, v119
    v_fma_f32 v231, v231, s31, -v125
    v_mfma_f32_32x32x16_bf16 v[16:31], v[196:199], v[84:87], v[16:31]
    ds_read_b64_tr_b16 v[64:65], v116 offset:0
    ds_read_b64_tr_b16 v[66:67], v116 offset:1024
    ds_read_b64_tr_b16 v[68:69], v117 offset:0
    ds_read_b64_tr_b16 v[70:71], v117 offset:1024
    v_max_f32 v225, 0, v225
    v_mfma_f32_32x32x16_bf16 v[32:47], v[196:199], v[88:91], v[32:47]
    ds_read_b64_tr_b16 v[72:73], v118 offset:0
    ds_read_b64_tr_b16 v[74:75], v118 offset:1024
    ds_read_b64_tr_b16 v[76:77], v119 offset:0
    ds_read_b64_tr_b16 v[78:79], v119 offset:1024
    v_max_f32 v227, 0, v227
    v_mfma_f32_32x32x16_bf16 v[48:63], v[196:199], v[92:95], v[48:63]
    v_max_f32 v229, 0, v229
    v_max_f32 v231, 0, v231
    v_add_f32 v225, 0x3727c5ac, v225
    v_add_f32 v227, 0x3727c5ac, v227
    buffer_load_dwordx4 v[196:199], v114, s[4:7], s28 offen offset:3072 sc1
    s_add_u32 s28, s28, 4096
    s_waitcnt vmcnt(19) lgkmcnt(0)
    v_mfma_f32_32x32x16_bf16 v[0:15], v[200:203], v[64:67], v[0:15]
    ds_read_b64_tr_b16 v[80:81], v116 offset:4096
    ds_read_b64_tr_b16 v[82:83], v116 offset:5120
    ds_read_b64_tr_b16 v[84:85], v117 offset:4096
    v_add_f32 v229, 0x3727c5ac, v229
    v_mfma_f32_32x32x16_bf16 v[16:31], v[200:203], v[68:71], v[16:31]
    ds_read_b64_tr_b16 v[86:87], v117 offset:5120
    ds_read_b64_tr_b16 v[88:89], v118 offset:4096
    ds_read_b64_tr_b16 v[90:91], v118 offset:5120
    v_add_f32 v231, 0x3727c5ac, v231
    v_mfma_f32_32x32x16_bf16 v[32:47], v[200:203], v[72:75], v[32:47]
    ds_read_b64_tr_b16 v[92:93], v119 offset:4096
    ds_read_b64_tr_b16 v[94:95], v119 offset:5120
    v_rsq_f32 v225, v225
    v_mfma_f32_32x32x16_bf16 v[48:63], v[200:203], v[76:79], v[48:63]
    v_rsq_f32 v227, v227
    v_rsq_f32 v229, v229
    v_rsq_f32 v231, v231
    v_mul_f32 v232, 0xbacccccd, v232
    buffer_load_dwordx4 v[200:203], v114, s[4:7], s28 offen offset:0 sc1
    s_waitcnt vmcnt(19) lgkmcnt(0)
    v_mfma_f32_32x32x16_bf16 v[0:15], v[204:207], v[80:83], v[0:15]
    ds_read_b64_tr_b16 v[64:65], v116 offset:8192
    ds_read_b64_tr_b16 v[66:67], v116 offset:9216
    ds_read_b64_tr_b16 v[68:69], v117 offset:8192
    v_mul_f32 v234, 0xbacccccd, v234
    v_mfma_f32_32x32x16_bf16 v[16:31], v[204:207], v[84:87], v[16:31]
    ds_read_b64_tr_b16 v[70:71], v117 offset:9216
    ds_read_b64_tr_b16 v[72:73], v118 offset:8192
    ds_read_b64_tr_b16 v[74:75], v118 offset:9216
    v_mul_f32 v236, 0xbacccccd, v236
    v_mfma_f32_32x32x16_bf16 v[32:47], v[204:207], v[88:91], v[32:47]
    ds_read_b64_tr_b16 v[76:77], v119 offset:8192
    ds_read_b64_tr_b16 v[78:79], v119 offset:9216
    v_mul_f32 v238, 0xbacccccd, v238
    v_mfma_f32_32x32x16_bf16 v[48:63], v[204:207], v[92:95], v[48:63]
    v_mul_f32 v122, v232, v232
    v_mul_f32 v123, v234, v234
    v_mul_f32 v124, v236, v236
    v_mul_f32 v125, v238, v238
    buffer_load_dwordx4 v[204:207], v114, s[4:7], s28 offen offset:1024 sc1
    s_waitcnt vmcnt(19) lgkmcnt(0)
    v_mfma_f32_32x32x16_bf16 v[0:15], v[208:211], v[64:67], v[0:15]
    ds_read_b64_tr_b16 v[80:81], v116 offset:12288
    ds_read_b64_tr_b16 v[82:83], v116 offset:13312
    ds_read_b64_tr_b16 v[84:85], v117 offset:12288
    v_fma_f32 v233, v233, s31, -v122
    v_mfma_f32_32x32x16_bf16 v[16:31], v[208:211], v[68:71], v[16:31]
    ds_read_b64_tr_b16 v[86:87], v117 offset:13312
    ds_read_b64_tr_b16 v[88:89], v118 offset:12288
    ds_read_b64_tr_b16 v[90:91], v118 offset:13312
    v_fma_f32 v235, v235, s31, -v123
    v_mfma_f32_32x32x16_bf16 v[32:47], v[208:211], v[72:75], v[32:47]
    ds_read_b64_tr_b16 v[92:93], v119 offset:12288
    ds_read_b64_tr_b16 v[94:95], v119 offset:13312
    v_fma_f32 v237, v237, s31, -v124
    v_mfma_f32_32x32x16_bf16 v[48:63], v[208:211], v[76:79], v[48:63]
    v_fma_f32 v239, v239, s31, -v125
    v_max_f32 v233, 0, v233
    v_max_f32 v235, 0, v235
    v_max_f32 v237, 0, v237
    buffer_load_dwordx4 v[208:211], v114, s[4:7], s28 offen offset:2048 sc1
    s_waitcnt vmcnt(19) lgkmcnt(0)
    v_mfma_f32_32x32x16_bf16 v[0:15], v[212:215], v[80:83], v[0:15]
    ds_read_b64_tr_b16 v[64:65], v116 offset:16384
    ds_read_b64_tr_b16 v[66:67], v116 offset:17408
    ds_read_b64_tr_b16 v[68:69], v117 offset:16384
    v_max_f32 v239, 0, v239
    v_mfma_f32_32x32x16_bf16 v[16:31], v[212:215], v[84:87], v[16:31]
    ds_read_b64_tr_b16 v[70:71], v117 offset:17408
    ds_read_b64_tr_b16 v[72:73], v118 offset:16384
    ds_read_b64_tr_b16 v[74:75], v118 offset:17408
    v_add_f32 v233, 0x3727c5ac, v233
    v_mfma_f32_32x32x16_bf16 v[32:47], v[212:215], v[88:91], v[32:47]
    ds_read_b64_tr_b16 v[76:77], v119 offset:16384
    ds_read_b64_tr_b16 v[78:79], v119 offset:17408
    v_add_f32 v235, 0x3727c5ac, v235
    v_mfma_f32_32x32x16_bf16 v[48:63], v[212:215], v[92:95], v[48:63]
    v_add_f32 v237, 0x3727c5ac, v237
    v_add_f32 v239, 0x3727c5ac, v239
    v_rsq_f32 v233, v233
    v_rsq_f32 v235, v235
    buffer_load_dwordx4 v[212:215], v114, s[4:7], s28 offen offset:3072 sc1
    s_add_u32 s28, s28, 4096
    s_waitcnt vmcnt(19) lgkmcnt(0)
    v_mfma_f32_32x32x16_bf16 v[0:15], v[136:139], v[64:67], v[0:15]
    ds_read_b64_tr_b16 v[80:81], v116 offset:20480
    ds_read_b64_tr_b16 v[82:83], v116 offset:21504
    ds_read_b64_tr_b16 v[84:85], v117 offset:20480
    v_rsq_f32 v237, v237
    v_mfma_f32_32x32x16_bf16 v[16:31], v[136:139], v[68:71], v[16:31]
    ds_read_b64_tr_b16 v[86:87], v117 offset:21504
    ds_read_b64_tr_b16 v[88:89], v118 offset:20480
    ds_read_b64_tr_b16 v[90:91], v118 offset:21504
    v_rsq_f32 v239, v239
    v_mfma_f32_32x32x16_bf16 v[32:47], v[136:139], v[72:75], v[32:47]
    ds_read_b64_tr_b16 v[92:93], v119 offset:20480
    ds_read_b64_tr_b16 v[94:95], v119 offset:21504
    v_mul_f32 v240, 0xbacccccd, v240
    v_mfma_f32_32x32x16_bf16 v[48:63], v[136:139], v[76:79], v[48:63]
    v_mul_f32 v242, 0xbacccccd, v242
    v_mul_f32 v244, 0xbacccccd, v244
    v_mul_f32 v246, 0xbacccccd, v246
    v_mul_f32 v122, v240, v240
    s_waitcnt vmcnt(18) lgkmcnt(0)
    v_mfma_f32_32x32x16_bf16 v[0:15], v[140:143], v[80:83], v[0:15]
    ds_read_b64_tr_b16 v[64:65], v116 offset:24576
    ds_read_b64_tr_b16 v[66:67], v116 offset:25600
    ds_read_b64_tr_b16 v[68:69], v117 offset:24576
    v_mul_f32 v123, v242, v242
    v_mfma_f32_32x32x16_bf16 v[16:31], v[140:143], v[84:87], v[16:31]
    ds_read_b64_tr_b16 v[70:71], v117 offset:25600
    ds_read_b64_tr_b16 v[72:73], v118 offset:24576
    ds_read_b64_tr_b16 v[74:75], v118 offset:25600
    v_mul_f32 v124, v244, v244
    v_mfma_f32_32x32x16_bf16 v[32:47], v[140:143], v[88:91], v[32:47]
    ds_read_b64_tr_b16 v[76:77], v119 offset:24576
    ds_read_b64_tr_b16 v[78:79], v119 offset:25600
    v_mul_f32 v125, v246, v246
    v_mfma_f32_32x32x16_bf16 v[48:63], v[140:143], v[92:95], v[48:63]
    v_fma_f32 v241, v241, s31, -v122
    v_fma_f32 v243, v243, s31, -v123
    v_fma_f32 v245, v245, s31, -v124
    v_fma_f32 v247, v247, s31, -v125
    s_waitcnt vmcnt(17) lgkmcnt(0)
    v_mfma_f32_32x32x16_bf16 v[0:15], v[144:147], v[64:67], v[0:15]
    ds_read_b64_tr_b16 v[80:81], v116 offset:28672
    ds_read_b64_tr_b16 v[82:83], v116 offset:29696
    ds_read_b64_tr_b16 v[84:85], v117 offset:28672
    v_max_f32 v241, 0, v241
    v_mfma_f32_32x32x16_bf16 v[16:31], v[144:147], v[68:71], v[16:31]
    ds_read_b64_tr_b16 v[86:87], v117 offset:29696
    ds_read_b64_tr_b16 v[88:89], v118 offset:28672
    ds_read_b64_tr_b16 v[90:91], v118 offset:29696
    v_max_f32 v243, 0, v243
    v_mfma_f32_32x32x16_bf16 v[32:47], v[144:147], v[72:75], v[32:47]
    ds_read_b64_tr_b16 v[92:93], v119 offset:28672
    ds_read_b64_tr_b16 v[94:95], v119 offset:29696
    v_max_f32 v245, 0, v245
    v_mfma_f32_32x32x16_bf16 v[48:63], v[144:147], v[76:79], v[48:63]
    v_max_f32 v247, 0, v247
    v_add_f32 v241, 0x3727c5ac, v241
    v_add_f32 v243, 0x3727c5ac, v243
    v_add_f32 v245, 0x3727c5ac, v245
    s_waitcnt vmcnt(16) lgkmcnt(0)
    v_mfma_f32_32x32x16_bf16 v[0:15], v[148:151], v[80:83], v[0:15]
    v_add_u32 v116, 0x8000, v116
    v_add_u32 v117, 0x8000, v117
    v_add_u32 v118, 0x8000, v118
    v_add_u32 v119, 0x8000, v119
    v_add_f32 v247, 0x3727c5ac, v247
    v_mfma_f32_32x32x16_bf16 v[16:31], v[148:151], v[84:87], v[16:31]
    ds_read_b64_tr_b16 v[64:65], v116 offset:0
    ds_read_b64_tr_b16 v[66:67], v116 offset:1024
    ds_read_b64_tr_b16 v[68:69], v116 offset:4096
    ds_read_b64_tr_b16 v[70:71], v116 offset:5120
    v_rsq_f32 v241, v241
    v_mfma_f32_32x32x16_bf16 v[32:47], v[148:151], v[88:91], v[32:47]
    ds_read_b64_tr_b16 v[72:73], v116 offset:8192
    ds_read_b64_tr_b16 v[74:75], v116 offset:9216
    ds_read_b64_tr_b16 v[76:77], v116 offset:12288
    ds_read_b64_tr_b16 v[78:79], v116 offset:13312
    v_rsq_f32 v243, v243
    v_mfma_f32_32x32x16_bf16 v[48:63], v[148:151], v[92:95], v[48:63]
    v_rsq_f32 v245, v245
    v_rsq_f32 v247, v247
    s_waitcnt vmcnt(12) lgkmcnt(0)
    v_mfma_f32_32x32x16_bf16 v[0:15], v[152:155], v[64:67], v[0:15]
    ds_read_b64_tr_b16 v[80:81], v116 offset:16384
    ds_read_b64_tr_b16 v[82:83], v116 offset:17408
    ds_read_b64_tr_b16 v[84:85], v116 offset:20480
    v_mfma_f32_32x32x16_bf16 v[0:15], v[156:159], v[68:71], v[0:15]
    ds_read_b64_tr_b16 v[86:87], v116 offset:21504
    ds_read_b64_tr_b16 v[88:89], v116 offset:24576
    ds_read_b64_tr_b16 v[90:91], v116 offset:25600
    v_mfma_f32_32x32x16_bf16 v[0:15], v[160:163], v[72:75], v[0:15]
    ds_read_b64_tr_b16 v[92:93], v116 offset:28672
    ds_read_b64_tr_b16 v[94:95], v116 offset:29696
    v_mfma_f32_32x32x16_bf16 v[0:15], v[164:167], v[76:79], v[0:15]
    s_waitcnt vmcnt(8) lgkmcnt(0)
    v_mfma_f32_32x32x16_bf16 v[0:15], v[168:171], v[80:83], v[0:15]
    ds_read_b64_tr_b16 v[64:65], v116 offset:32768
    ds_read_b64_tr_b16 v[66:67], v116 offset:33792
    ds_read_b64_tr_b16 v[68:69], v116 offset:36864
    v_mfma_f32_32x32x16_bf16 v[0:15], v[172:175], v[84:87], v[0:15]
    ds_read_b64_tr_b16 v[70:71], v116 offset:37888
    ds_read_b64_tr_b16 v[72:73], v116 offset:40960
    ds_read_b64_tr_b16 v[74:75], v116 offset:41984
    v_mfma_f32_32x32x16_bf16 v[0:15], v[176:179], v[88:91], v[0:15]
    ds_read_b64_tr_b16 v[76:77], v116 offset:45056
    ds_read_b64_tr_b16 v[78:79], v116 offset:46080
    v_mfma_f32_32x32x16_bf16 v[0:15], v[180:183], v[92:95], v[0:15]
    s_waitcnt vmcnt(4) lgkmcnt(0)
    v_mfma_f32_32x32x16_bf16 v[0:15], v[184:187], v[64:67], v[0:15]
    ds_read_b64_tr_b16 v[80:81], v116 offset:49152
    ds_read_b64_tr_b16 v[82:83], v116 offset:50176
    ds_read_b64_tr_b16 v[84:85], v116 offset:53248
    v_mfma_f32_32x32x16_bf16 v[0:15], v[188:191], v[68:71], v[0:15]
    ds_read_b64_tr_b16 v[86:87], v116 offset:54272
    ds_read_b64_tr_b16 v[88:89], v116 offset:57344
    ds_read_b64_tr_b16 v[90:91], v116 offset:58368
    v_mfma_f32_32x32x16_bf16 v[0:15], v[192:195], v[72:75], v[0:15]
    ds_read_b64_tr_b16 v[92:93], v116 offset:61440
    ds_read_b64_tr_b16 v[94:95], v116 offset:62464
    v_mfma_f32_32x32x16_bf16 v[0:15], v[196:199], v[76:79], v[0:15]
    s_waitcnt vmcnt(0) lgkmcnt(0)
    v_mfma_f32_32x32x16_bf16 v[0:15], v[200:203], v[80:83], v[0:15]
    ds_read_b64_tr_b16 v[64:65], v117 offset:0
    ds_read_b64_tr_b16 v[66:67], v117 offset:1024
    ds_read_b64_tr_b16 v[68:69], v117 offset:4096
    v_mfma_f32_32x32x16_bf16 v[0:15], v[204:207], v[84:87], v[0:15]
    ds_read_b64_tr_b16 v[70:71], v117 offset:5120
    ds_read_b64_tr_b16 v[72:73], v117 offset:8192
    ds_read_b64_tr_b16 v[74:75], v117 offset:9216
    v_mfma_f32_32x32x16_bf16 v[0:15], v[208:211], v[88:91], v[0:15]
    ds_read_b64_tr_b16 v[76:77], v117 offset:12288
    ds_read_b64_tr_b16 v[78:79], v117 offset:13312
    v_mfma_f32_32x32x16_bf16 v[0:15], v[212:215], v[92:95], v[0:15]
    s_waitcnt vmcnt(12) lgkmcnt(0)
    v_mfma_f32_32x32x16_bf16 v[16:31], v[152:155], v[64:67], v[16:31]
    ds_read_b64_tr_b16 v[80:81], v117 offset:16384
    ds_read_b64_tr_b16 v[82:83], v117 offset:17408
    ds_read_b64_tr_b16 v[84:85], v117 offset:20480
    v_mfma_f32_32x32x16_bf16 v[16:31], v[156:159], v[68:71], v[16:31]
    ds_read_b64_tr_b16 v[86:87], v117 offset:21504
    ds_read_b64_tr_b16 v[88:89], v117 offset:24576
    ds_read_b64_tr_b16 v[90:91], v117 offset:25600
    v_mfma_f32_32x32x16_bf16 v[16:31], v[160:163], v[72:75], v[16:31]
    ds_read_b64_tr_b16 v[92:93], v117 offset:28672
    ds_read_b64_tr_b16 v[94:95], v117 offset:29696
    v_mfma_f32_32x32x16_bf16 v[16:31], v[164:167], v[76:79], v[16:31]
    v_fmac_f32 v0, v216, v100
    v_fmac_f32 v1, v218, v100
    v_fmac_f32 v2, v220, v100
    v_fmac_f32 v3, v222, v100
    v_fmac_f32 v4, v224, v100
    v_fmac_f32 v5, v226, v100
    s_waitcnt vmcnt(8) lgkmcnt(0)
    v_mfma_f32_32x32x16_bf16 v[16:31], v[168:171], v[80:83], v[16:31]
    ds_read_b64_tr_b16 v[64:65], v117 offset:32768
    ds_read_b64_tr_b16 v[66:67], v117 offset:33792
    ds_read_b64_tr_b16 v[68:69], v117 offset:36864
    v_fmac_f32 v6, v228, v100
    v_fmac_f32 v7, v230, v100
    v_mul_f32 v0, v0, v217
    v_mfma_f32_32x32x16_bf16 v[16:31], v[172:175], v[84:87], v[16:31]
    ds_read_b64_tr_b16 v[70:71], v117 offset:37888
    ds_read_b64_tr_b16 v[72:73], v117 offset:40960
    ds_read_b64_tr_b16 v[74:75], v117 offset:41984
    v_mul_f32 v1, v1, v219
    v_mul_f32 v2, v2, v221
    v_mul_f32 v3, v3, v223
    v_mfma_f32_32x32x16_bf16 v[16:31], v[176:179], v[88:91], v[16:31]
    ds_read_b64_tr_b16 v[76:77], v117 offset:45056
    ds_read_b64_tr_b16 v[78:79], v117 offset:46080
    v_mul_f32 v4, v4, v225
    v_mul_f32 v5, v5, v227
    v_mul_f32 v6, v6, v229
    v_mfma_f32_32x32x16_bf16 v[16:31], v[180:183], v[92:95], v[16:31]
    v_mul_f32 v7, v7, v231
    v_cvt_pk_bf16_f32 v0, v0, v1
    v_cvt_pk_bf16_f32 v1, v2, v3
    v_cvt_pk_bf16_f32 v2, v4, v5
    v_cvt_pk_bf16_f32 v3, v6, v7
    buffer_store_dwordx4 v[0:3], v96, s[20:23], s37 offen offset:0 sc1
    s_waitcnt vmcnt(5) lgkmcnt(0)
    v_mfma_f32_32x32x16_bf16 v[16:31], v[184:187], v[64:67], v[16:31]
    ds_read_b64_tr_b16 v[80:81], v117 offset:49152
    ds_read_b64_tr_b16 v[82:83], v117 offset:50176
    ds_read_b64_tr_b16 v[84:85], v117 offset:53248
    v_fmac_f32 v8, v232, v100
    v_fmac_f32 v9, v234, v100
    v_fmac_f32 v10, v236, v100
    v_mfma_f32_32x32x16_bf16 v[16:31], v[188:191], v[68:71], v[16:31]
    ds_read_b64_tr_b16 v[86:87], v117 offset:54272
    ds_read_b64_tr_b16 v[88:89], v117 offset:57344
    ds_read_b64_tr_b16 v[90:91], v117 offset:58368
    v_fmac_f32 v11, v238, v100
    v_fmac_f32 v12, v240, v100
    v_fmac_f32 v13, v242, v100
    v_mfma_f32_32x32x16_bf16 v[16:31], v[192:195], v[72:75], v[16:31]
    ds_read_b64_tr_b16 v[92:93], v117 offset:61440
    ds_read_b64_tr_b16 v[94:95], v117 offset:62464
    v_fmac_f32 v14, v244, v100
    v_fmac_f32 v15, v246, v100
    v_mul_f32 v8, v8, v233
    v_mfma_f32_32x32x16_bf16 v[16:31], v[196:199], v[76:79], v[16:31]
    v_mul_f32 v9, v9, v235
    v_mul_f32 v10, v10, v237
    v_mul_f32 v11, v11, v239
    v_mul_f32 v12, v12, v241
    v_mul_f32 v13, v13, v243
    v_mul_f32 v14, v14, v245
    s_waitcnt vmcnt(1) lgkmcnt(0)
    v_mfma_f32_32x32x16_bf16 v[16:31], v[200:203], v[80:83], v[16:31]
    ds_read_b64_tr_b16 v[64:65], v118 offset:0
    ds_read_b64_tr_b16 v[66:67], v118 offset:1024
    ds_read_b64_tr_b16 v[68:69], v118 offset:4096
    v_mul_f32 v15, v15, v247
    v_cvt_pk_bf16_f32 v8, v8, v9
    v_cvt_pk_bf16_f32 v9, v10, v11
    v_mfma_f32_32x32x16_bf16 v[16:31], v[204:207], v[84:87], v[16:31]
    ds_read_b64_tr_b16 v[70:71], v118 offset:5120
    ds_read_b64_tr_b16 v[72:73], v118 offset:8192
    ds_read_b64_tr_b16 v[74:75], v118 offset:9216
    v_cvt_pk_bf16_f32 v10, v12, v13
    v_cvt_pk_bf16_f32 v11, v14, v15
    buffer_store_dwordx4 v[8:11], v96, s[20:23], s37 offen offset:640 sc1
    v_mfma_f32_32x32x16_bf16 v[16:31], v[208:211], v[88:91], v[16:31]
    ds_read_b64_tr_b16 v[76:77], v118 offset:12288
    ds_read_b64_tr_b16 v[78:79], v118 offset:13312
    v_mfma_f32_32x32x16_bf16 v[16:31], v[212:215], v[92:95], v[16:31]
    s_waitcnt vmcnt(14) lgkmcnt(0)
    v_mfma_f32_32x32x16_bf16 v[32:47], v[152:155], v[64:67], v[32:47]
    ds_read_b64_tr_b16 v[80:81], v118 offset:16384
    ds_read_b64_tr_b16 v[82:83], v118 offset:17408
    ds_read_b64_tr_b16 v[84:85], v118 offset:20480
    v_mfma_f32_32x32x16_bf16 v[32:47], v[156:159], v[68:71], v[32:47]
    ds_read_b64_tr_b16 v[86:87], v118 offset:21504
    ds_read_b64_tr_b16 v[88:89], v118 offset:24576
    ds_read_b64_tr_b16 v[90:91], v118 offset:25600
    v_mfma_f32_32x32x16_bf16 v[32:47], v[160:163], v[72:75], v[32:47]
    ds_read_b64_tr_b16 v[92:93], v118 offset:28672
    ds_read_b64_tr_b16 v[94:95], v118 offset:29696
    v_mfma_f32_32x32x16_bf16 v[32:47], v[164:167], v[76:79], v[32:47]
    v_fmac_f32 v16, v216, v101
    v_fmac_f32 v17, v218, v101
    v_fmac_f32 v18, v220, v101
    v_fmac_f32 v19, v222, v101
    v_fmac_f32 v20, v224, v101
    v_fmac_f32 v21, v226, v101
    s_waitcnt vmcnt(10) lgkmcnt(0)
    v_mfma_f32_32x32x16_bf16 v[32:47], v[168:171], v[80:83], v[32:47]
    ds_read_b64_tr_b16 v[64:65], v118 offset:32768
    ds_read_b64_tr_b16 v[66:67], v118 offset:33792
    ds_read_b64_tr_b16 v[68:69], v118 offset:36864
    v_fmac_f32 v22, v228, v101
    v_fmac_f32 v23, v230, v101
    v_mul_f32 v16, v16, v217
    v_mfma_f32_32x32x16_bf16 v[32:47], v[172:175], v[84:87], v[32:47]
    ds_read_b64_tr_b16 v[70:71], v118 offset:37888
    ds_read_b64_tr_b16 v[72:73], v118 offset:40960
    ds_read_b64_tr_b16 v[74:75], v118 offset:41984
    v_mul_f32 v17, v17, v219
    v_mul_f32 v18, v18, v221
    v_mul_f32 v19, v19, v223
    v_mfma_f32_32x32x16_bf16 v[32:47], v[176:179], v[88:91], v[32:47]
    ds_read_b64_tr_b16 v[76:77], v118 offset:45056
    ds_read_b64_tr_b16 v[78:79], v118 offset:46080
    v_mul_f32 v20, v20, v225
    v_mul_f32 v21, v21, v227
    v_mul_f32 v22, v22, v229
    v_mfma_f32_32x32x16_bf16 v[32:47], v[180:183], v[92:95], v[32:47]
    v_mul_f32 v23, v23, v231
    v_cvt_pk_bf16_f32 v16, v16, v17
    v_cvt_pk_bf16_f32 v17, v18, v19
    v_cvt_pk_bf16_f32 v18, v20, v21
    v_cvt_pk_bf16_f32 v19, v22, v23
    buffer_store_dwordx4 v[16:19], v97, s[20:23], s37 offen offset:0 sc1
    s_waitcnt vmcnt(7) lgkmcnt(0)
    v_mfma_f32_32x32x16_bf16 v[32:47], v[184:187], v[64:67], v[32:47]
    ds_read_b64_tr_b16 v[80:81], v118 offset:49152
    ds_read_b64_tr_b16 v[82:83], v118 offset:50176
    ds_read_b64_tr_b16 v[84:85], v118 offset:53248
    v_fmac_f32 v24, v232, v101
    v_fmac_f32 v25, v234, v101
    v_fmac_f32 v26, v236, v101
    v_mfma_f32_32x32x16_bf16 v[32:47], v[188:191], v[68:71], v[32:47]
    ds_read_b64_tr_b16 v[86:87], v118 offset:54272
    ds_read_b64_tr_b16 v[88:89], v118 offset:57344
    ds_read_b64_tr_b16 v[90:91], v118 offset:58368
    v_fmac_f32 v27, v238, v101
    v_fmac_f32 v28, v240, v101
    v_fmac_f32 v29, v242, v101
    v_mfma_f32_32x32x16_bf16 v[32:47], v[192:195], v[72:75], v[32:47]
    ds_read_b64_tr_b16 v[92:93], v118 offset:61440
    ds_read_b64_tr_b16 v[94:95], v118 offset:62464
    v_fmac_f32 v30, v244, v101
    v_fmac_f32 v31, v246, v101
    v_mul_f32 v24, v24, v233
    v_mfma_f32_32x32x16_bf16 v[32:47], v[196:199], v[76:79], v[32:47]
    v_mul_f32 v25, v25, v235
    v_mul_f32 v26, v26, v237
    v_mul_f32 v27, v27, v239
    v_mul_f32 v28, v28, v241
    v_mul_f32 v29, v29, v243
    v_mul_f32 v30, v30, v245
    s_waitcnt vmcnt(3) lgkmcnt(0)
    v_mfma_f32_32x32x16_bf16 v[32:47], v[200:203], v[80:83], v[32:47]
    ds_read_b64_tr_b16 v[64:65], v119 offset:0
    ds_read_b64_tr_b16 v[66:67], v119 offset:1024
    ds_read_b64_tr_b16 v[68:69], v119 offset:4096
    v_mul_f32 v31, v31, v247
    v_cvt_pk_bf16_f32 v24, v24, v25
    v_cvt_pk_bf16_f32 v25, v26, v27
    v_mfma_f32_32x32x16_bf16 v[32:47], v[204:207], v[84:87], v[32:47]
    ds_read_b64_tr_b16 v[70:71], v119 offset:5120
    ds_read_b64_tr_b16 v[72:73], v119 offset:8192
    ds_read_b64_tr_b16 v[74:75], v119 offset:9216
    v_cvt_pk_bf16_f32 v26, v28, v29
    v_cvt_pk_bf16_f32 v27, v30, v31
    buffer_store_dwordx4 v[24:27], v97, s[20:23], s37 offen offset:640 sc1
    v_mfma_f32_32x32x16_bf16 v[32:47], v[208:211], v[88:91], v[32:47]
    ds_read_b64_tr_b16 v[76:77], v119 offset:12288
    ds_read_b64_tr_b16 v[78:79], v119 offset:13312
    v_mfma_f32_32x32x16_bf16 v[32:47], v[212:215], v[92:95], v[32:47]
    s_waitcnt vmcnt(16) lgkmcnt(0)
    v_mfma_f32_32x32x16_bf16 v[48:63], v[152:155], v[64:67], v[48:63]
    ds_read_b64_tr_b16 v[80:81], v119 offset:16384
    ds_read_b64_tr_b16 v[82:83], v119 offset:17408
    ds_read_b64_tr_b16 v[84:85], v119 offset:20480
    v_mfma_f32_32x32x16_bf16 v[48:63], v[156:159], v[68:71], v[48:63]
    ds_read_b64_tr_b16 v[86:87], v119 offset:21504
    ds_read_b64_tr_b16 v[88:89], v119 offset:24576
    ds_read_b64_tr_b16 v[90:91], v119 offset:25600
    v_mfma_f32_32x32x16_bf16 v[48:63], v[160:163], v[72:75], v[48:63]
    ds_read_b64_tr_b16 v[92:93], v119 offset:28672
    ds_read_b64_tr_b16 v[94:95], v119 offset:29696
    v_mfma_f32_32x32x16_bf16 v[48:63], v[164:167], v[76:79], v[48:63]
    v_fmac_f32 v32, v216, v102
    v_fmac_f32 v33, v218, v102
    v_fmac_f32 v34, v220, v102
    v_fmac_f32 v35, v222, v102
    v_fmac_f32 v36, v224, v102
    v_fmac_f32 v37, v226, v102
    s_waitcnt vmcnt(12) lgkmcnt(0)
    v_mfma_f32_32x32x16_bf16 v[48:63], v[168:171], v[80:83], v[48:63]
    ds_read_b64_tr_b16 v[64:65], v119 offset:32768
    ds_read_b64_tr_b16 v[66:67], v119 offset:33792
    ds_read_b64_tr_b16 v[68:69], v119 offset:36864
    v_fmac_f32 v38, v228, v102
    v_fmac_f32 v39, v230, v102
    v_mul_f32 v32, v32, v217
    v_mfma_f32_32x32x16_bf16 v[48:63], v[172:175], v[84:87], v[48:63]
    ds_read_b64_tr_b16 v[70:71], v119 offset:37888
    ds_read_b64_tr_b16 v[72:73], v119 offset:40960
    ds_read_b64_tr_b16 v[74:75], v119 offset:41984
    v_mul_f32 v33, v33, v219
    v_mul_f32 v34, v34, v221
    v_mul_f32 v35, v35, v223
    v_mfma_f32_32x32x16_bf16 v[48:63], v[176:179], v[88:91], v[48:63]
    ds_read_b64_tr_b16 v[76:77], v119 offset:45056
    ds_read_b64_tr_b16 v[78:79], v119 offset:46080
    v_mul_f32 v36, v36, v225
    v_mul_f32 v37, v37, v227
    v_mul_f32 v38, v38, v229
    v_mfma_f32_32x32x16_bf16 v[48:63], v[180:183], v[92:95], v[48:63]
    v_mul_f32 v39, v39, v231
    v_cvt_pk_bf16_f32 v32, v32, v33
    v_cvt_pk_bf16_f32 v33, v34, v35
    v_cvt_pk_bf16_f32 v34, v36, v37
    v_cvt_pk_bf16_f32 v35, v38, v39
    buffer_store_dwordx4 v[32:35], v98, s[20:23], s37 offen offset:0 sc1
    s_waitcnt vmcnt(9) lgkmcnt(0)
    v_mfma_f32_32x32x16_bf16 v[48:63], v[184:187], v[64:67], v[48:63]
    ds_read_b64_tr_b16 v[80:81], v119 offset:49152
    ds_read_b64_tr_b16 v[82:83], v119 offset:50176
    ds_read_b64_tr_b16 v[84:85], v119 offset:53248
    v_fmac_f32 v40, v232, v102
    v_fmac_f32 v41, v234, v102
    v_fmac_f32 v42, v236, v102
    v_mfma_f32_32x32x16_bf16 v[48:63], v[188:191], v[68:71], v[48:63]
    ds_read_b64_tr_b16 v[86:87], v119 offset:54272
    ds_read_b64_tr_b16 v[88:89], v119 offset:57344
    ds_read_b64_tr_b16 v[90:91], v119 offset:58368
    v_fmac_f32 v43, v238, v102
    v_fmac_f32 v44, v240, v102
    v_fmac_f32 v45, v242, v102
    v_mfma_f32_32x32x16_bf16 v[48:63], v[192:195], v[72:75], v[48:63]
    ds_read_b64_tr_b16 v[92:93], v119 offset:61440
    ds_read_b64_tr_b16 v[94:95], v119 offset:62464
    v_fmac_f32 v46, v244, v102
    v_fmac_f32 v47, v246, v102
    v_mul_f32 v40, v40, v233
    v_mfma_f32_32x32x16_bf16 v[48:63], v[196:199], v[76:79], v[48:63]
    v_mul_f32 v41, v41, v235
    v_mul_f32 v42, v42, v237
    v_mul_f32 v43, v43, v239
    v_mul_f32 v44, v44, v241
    v_mul_f32 v45, v45, v243
    v_mul_f32 v46, v46, v245
    s_waitcnt vmcnt(5) lgkmcnt(0)
    v_mfma_f32_32x32x16_bf16 v[48:63], v[200:203], v[80:83], v[48:63]
    v_mul_f32 v47, v47, v247
    v_cvt_pk_bf16_f32 v40, v40, v41
    v_cvt_pk_bf16_f32 v41, v42, v43
    v_cvt_pk_bf16_f32 v42, v44, v45
    v_cvt_pk_bf16_f32 v43, v46, v47
    buffer_store_dwordx4 v[40:43], v98, s[20:23], s37 offen offset:640 sc1
    v_mfma_f32_32x32x16_bf16 v[48:63], v[204:207], v[84:87], v[48:63]
    v_mfma_f32_32x32x16_bf16 v[48:63], v[208:211], v[88:91], v[48:63]
    v_mfma_f32_32x32x16_bf16 v[48:63], v[212:215], v[92:95], v[48:63]
    s_nop 7
    s_nop 3
    v_fmac_f32 v48, v216, v103
    v_fmac_f32 v49, v218, v103
    v_fmac_f32 v50, v220, v103
    v_fmac_f32 v51, v222, v103
    v_fmac_f32 v52, v224, v103
    v_fmac_f32 v53, v226, v103
    v_fmac_f32 v54, v228, v103
    v_fmac_f32 v55, v230, v103
    v_mul_f32 v48, v48, v217
    v_mul_f32 v49, v49, v219
    v_mul_f32 v50, v50, v221
    v_mul_f32 v51, v51, v223
    v_mul_f32 v52, v52, v225
    v_mul_f32 v53, v53, v227
    v_mul_f32 v54, v54, v229
    v_mul_f32 v55, v55, v231
    v_cvt_pk_bf16_f32 v48, v48, v49
    v_cvt_pk_bf16_f32 v49, v50, v51
    v_cvt_pk_bf16_f32 v50, v52, v53
    v_cvt_pk_bf16_f32 v51, v54, v55
    buffer_store_dwordx4 v[48:51], v99, s[20:23], s37 offen offset:0 sc1
    v_fmac_f32 v56, v232, v103
    v_fmac_f32 v57, v234, v103
    v_fmac_f32 v58, v236, v103
    v_fmac_f32 v59, v238, v103
    v_fmac_f32 v60, v240, v103
    v_fmac_f32 v61, v242, v103
    v_fmac_f32 v62, v244, v103
    v_fmac_f32 v63, v246, v103
    v_mul_f32 v56, v56, v233
    v_mul_f32 v57, v57, v235
    v_mul_f32 v58, v58, v237
    v_mul_f32 v59, v59, v239
    v_mul_f32 v60, v60, v241
    v_mul_f32 v61, v61, v243
    v_mul_f32 v62, v62, v245
    v_mul_f32 v63, v63, v247
    v_cvt_pk_bf16_f32 v56, v56, v57
    v_cvt_pk_bf16_f32 v57, v58, v59
    v_cvt_pk_bf16_f32 v58, v60, v61
    v_cvt_pk_bf16_f32 v59, v62, v63
    buffer_store_dwordx4 v[56:59], v99, s[20:23], s37 offen offset:640 sc1
L_q_sig:
    s_lshl_b32 s97, s34, 7
    s_add_u32 s97, s97, s96
    s_add_u32 s97, s97, 0
    v_lshlrev_b32 v155, 4, v252
    s_and_b32 s30, s2, 7
    s_lshl_b32 s30, s30, 2
    s_bfe_u32 s31, s2, 0x20003
    s_add_u32 s27, s30, s31
    s_lshr_b32 s28, s2, 5
    s_and_b32 s25, s24, 3
    s_lshr_b32 s26, s24, 2
    s_cmp_lt_u32 s24, 3
    s_cselect_b32 s55, 1, 0
    s_andn2_b32 s56, s55, s91
    s_lshl_b32 s30, s28, 3
    s_lshl_b32 s31, s25, 1
    s_add_u32 s30, s30, s31
    s_add_u32 s33, s30, s26
    s_lshl_b32 s31, s27, 6
    s_add_u32 s30, s30, s31
    s_mul_i32 s36, s30, 1280
    s_mul_i32 s31, s26, 1280
    s_add_u32 s35, s36, s31
    s_sub_u32 s34, s36, s31
    s_add_u32 s34, s34, 1280
    v_and_b32 v160, 31, v252
    v_lshrrev_b32 v161, 5, v252
    v_xor_b32 v158, s26, v161
    v_mul_u32_u24 v158, 1280, v158
    v_lshl_add_u32 v173, v160, 3, v158
    v_mov_b32 v159, 0x80000000
    v_cmp_gt_u32 vcc, 32, v252
    s_mul_i32 s37, s26, 81920
    s_lshl_b32 s31, s25, 10
    s_add_u32 s30, s37, s31
    s_mov_b32 m0, s30
    s_mul_i32 s29, s27, 163840
    s_add_u32 s29, s29, 0x300000
    s_add_u32 s39, s29, s30
    s_mov_b32 s53, s30
    s_lshl_b32 s31, s25, 12
    s_add_u32 s38, s37, s31
    s_add_u32 s43, s29, s38
    s_add_u32 s57, s31, 69632
    s_mov_b32 s66, s55
    s_mov_b32 s12, s76
    s_mov_b32 s13, s77
    s_mov_b32 s14, 0x600000
    s_mov_b32 s15, 0x20000
    s_mov_b32 s16, s80
    s_mov_b32 s17, s81
    s_mov_b32 s18, 0x600000
    s_mov_b32 s19, 0x20000
    v_lshl_add_u32 v153, v160, 3, s37
    v_mad_u32_u24 v162, v161, 20, v160
    v_lshl_add_u32 v154, v162, 4, s37
    v_add_u32 v152, s37, v155
    s_mul_i32 s31, s25, 3328
    s_add_u32 s30, s31, s37
    v_add_u32 v166, s30, v155
    v_lshl_add_u32 v168, v252, 2, s30
    s_xor_b32 s30, s26, 1
    s_mul_i32 s30, s30, 81920
    s_add_u32 s30, s30, s31
    v_add_u32 v167, s30, v155
    v_lshl_add_u32 v169, v252, 2, s30
    v_cmp_eq_u32 s[54:55], 20, v160
    v_mov_b32 v162, 0x3f803f80
    v_mov_b32 v174, 0x71800000
    v_cndmask_b32 v16, 0, v162, s[54:55]
    v_cndmask_b32 v17, 0, v162, s[54:55]
    v_cndmask_b32 v18, 0, v162, s[54:55]
    v_cndmask_b32 v19, 0, v162, s[54:55]
    v_cndmask_b32 v20, 0, v162, s[54:55]
    v_cndmask_b32 v21, 0, v162, s[54:55]
    v_cndmask_b32 v22, 0, v162, s[54:55]
    v_cndmask_b32 v23, 0, v162, s[54:55]
    v_and_b32 v160, 15, v252
    v_bfe_u32 v162, v252, 4, 1
    v_mul_u32_u24 v162, 20480, v162
    v_lshl_add_u32 v163, v160, 4, v162
    v_lshl_add_u32 v163, v161, 8, v163
    s_lshl_b32 s31, s27, 9
    v_add_u32 v164, s31, v163
    v_lshl_add_u32 v163, v160, 3, v162
    s_lshl_b32 s31, s27, 7
    s_add_u32 s31, s31, 16384
    v_add_u32 v163, s31, v163
    v_cndmask_b32 v165, v159, v163, vcc
    s_xor_b32 s47, s33, 1
    s_mul_i32 s47, s47, 40960
    s_add_u32 s47, s47, 0x800000
    s_lshl_b32 s42, s28, 5
    s_add_u32 s42, s42, s27
    v_cmp_gt_u32 s[54:55], 16, v252
    v_lshlrev_b32 v163, 2, v252
    s_lshl_b32 s48, s42, 6
    s_add_u32 s49, s48, 0x60000
    v_cndmask_b32 v172, v159, v163, s[54:55]
    s_mul_i32 s30, s27, 20
    s_add_u32 s31, s30, 19
    s_lshr_b32 s30, s30, 7
    s_lshr_b32 s31, s31, 7
    v_mov_b32 v162, s30
    v_mov_b32 v163, s31
    v_and_b32 v158, 16, v252
    v_cmp_eq_u32 s[54:55], 0, v158
    s_mov_b32 s40, 0x000fffff
    s_mov_b32 s41, 0x000fffff
    v_cndmask_b32 v162, v163, v162, s[54:55]
    v_mad_u32_u24 v170, v161, 5, v162
    v_add_u32 v170, 5, v170
    v_lshl_add_u32 v170, v170, 4, v160
    v_lshlrev_b32 v170, 7, v170
    v_and_b32 v163, 1, v252
    s_lshl_b32 s30, s28, 1
    v_add_u32 v163, s30, v163
    v_lshl_add_u32 v163, v162, 4, v163
    v_add_u32 v160, 240, v160
    v_cndmask_b32 v163, v160, v163, vcc
    v_lshlrev_b32 v171, 7, v163
    v_lshrrev_b32 v210, 3, v252
    v_and_b32 v211, 7, v252
    v_lshlrev_b32 v211, 4, v211
    v_mul_u32_u24 v208, 3072, v210
    v_add_u32 v208, v208, v211
    v_lshl_add_u32 v209, v210, 12, v211
    v_bfe_u32 v211, v252, 2, 2
    v_lshrrev_b32 v212, 5, v252
    v_lshl_add_u32 v212, v212, 3, v211
    v_lshl_add_u32 v212, v212, 7, s57
    v_and_b32 v213, 1, v252
    v_lshl_add_u32 v212, v213, 4, v212
    v_and_b32 v213, 2, v252
    v_lshl_add_u32 v212, v213, 2, v212
    v_and_b32 v213, 16, v252
    v_lshl_add_u32 v212, v213, 1, v212
    v_lshrrev_b32 v213, 4, v252
    v_lshl_add_u32 v213, v213, 3, v211
    v_lshl_add_u32 v213, v213, 7, s57
    v_and_b32 v210, 3, v252
    v_lshl_add_u32 v213, v210, 3, v213
    s_mov_b32 s50, 0
    s_lshl_b32 s50, s50, 7
    s_add_u32 s50, s50, s96
    s_waitcnt vmcnt(0)
    v_readfirstlane_b32 s90, v253
    s_nop 0
    s_mul_i32 s90, s90, 0x9e3779b1
    s_add_u32 s90, s90, 0x7f4a7c15
    v_mov_b32 v250, s90
    v_lshlrev_b32 v251, 15, v252
    s_waitcnt vmcnt(0) lgkmcnt(0)
    s_barrier
    s_cmp_lg_u32 s24, 3
    s_cbranch_scc1 L_sig8
    s_mov_b64 exec, 1
    buffer_store_dword v250, v251, s[4:7], s97 offen sc1
    s_mov_b64 exec, -1
L_sig8:
    s_lshl_b32 s97, s42, 7
    s_add_u32 s97, s97, s96
    s_add_u32 s97, s97, 262144
    s_cmp_lg_u32 s24, 1
    s_cbranch_scc1 L_attn_nz
    s_cmp_lg_u32 s91, 0
    s_cbranch_scc1 L_attn_nz
    buffer_store_dword v255, v172, s[4:7], s49 offen sc1
L_attn_nz:
    s_cmp_lg_u32 s24, 0
    s_cbranch_scc1 L_np9
    s_mov_b32 s61, 0x40000
L_poll10:
    buffer_load_dword v250, v170, s[4:7], s50 offen sc1
    buffer_load_dword v251, v171, s[4:7], s50 offen sc1
    s_sub_u32 s61, s61, 1
    s_waitcnt vmcnt(0)
    s_cbranch_scc1 L_pollx11
    v_xor_b32 v250, s90, v250
    v_xor_b32 v251, s90, v251
    v_or_b32 v250, v250, v251
    v_cmp_ne_u32 vcc, 0, v250
    s_cbranch_vccz L_pollx11
    s_mov_b64 exec, vcc
    s_sleep 1
    s_branch L_poll10
L_pollx11:
    s_mov_b64 exec, -1
L_np9:
    s_barrier
    buffer_load_dwordx4 v155, s[20:23], s39 offen sc1 lds
    buffer_load_dwordx4 v[0:3], v155, s[20:23], s35 offen sc1
    buffer_load_dwordx4 v[4:7], v155, s[20:23], s34 offen sc1
    buffer_load_dwordx2 v[8:9], v173, s[20:23], s36 offen offset:1024 sc1
    s_cmp_lg_u32 s26, 0
    s_cbranch_scc1 L_attn_f
    s_setprio 2
    s_waitcnt vmcnt(0)
    s_barrier
    s_branch L_attn_g
L_attn_f:
    s_setprio 1
    s_mul_i32 s30, s25, 3072
    s_add_u32 m0, s30, 4096
    s_add_u32 s54, m0, s29
    buffer_load_dwordx4 v155, s[20:23], s54 offen offset:0 sc1 lds
    buffer_load_dwordx4 v155, s[20:23], s54 offen offset:1024 sc1 lds
    buffer_load_dwordx4 v155, s[20:23], s54 offen offset:2048 sc1 lds
    s_barrier
    s_mul_i32 s30, s25, 3072
    s_add_u32 m0, s30, 86016
    s_add_u32 s54, m0, s29
    buffer_load_dwordx4 v155, s[20:23], s54 offen offset:0 sc1 lds
    buffer_load_dwordx4 v155, s[20:23], s54 offen offset:1024 sc1 lds
    buffer_load_dwordx4 v155, s[20:23], s54 offen offset:2048 sc1 lds
    s_mul_i32 s30, s25, 4096
    s_add_u32 m0, s30, 16384
    s_add_u32 s54, m0, s29
    buffer_load_dwordx4 v155, s[20:23], s54 offen offset:0 sc1 lds
    buffer_load_dwordx4 v155, s[20:23], s54 offen offset:1024 sc1 lds
    buffer_load_dwordx4 v155, s[20:23], s54 offen offset:2048 sc1 lds
    buffer_load_dwordx4 v155, s[20:23], s54 offen offset:3072 sc1 lds
    s_waitcnt vmcnt(7)
    s_barrier
    s_mul_i32 s30, s25, 9216
    s_add_u32 m0, s30, 32768
    s_add_u32 s54, m0, s29
    buffer_load_dwordx4 v155, s[20:23], s54 offen offset:0 sc1 lds
    buffer_load_dwordx4 v155, s[20:23], s54 offen offset:1024 sc1 lds
    buffer_load_dwordx4 v155, s[20:23], s54 offen offset:2048 sc1 lds
    buffer_load_dwordx4 v155, s[20:23], s54 offen offset:3072 sc1 lds
    s_add_u32 m0, s30, 36864
    s_add_u32 s54, m0, s29
    buffer_load_dwordx4 v155, s[20:23], s54 offen offset:0 sc1 lds
    buffer_load_dwordx4 v155, s[20:23], s54 offen offset:1024 sc1 lds
    buffer_load_dwordx4 v155, s[20:23], s54 offen offset:2048 sc1 lds
    buffer_load_dwordx4 v155, s[20:23], s54 offen offset:3072 sc1 lds
    s_add_u32 m0, s30, 40960
    s_add_u32 s54, m0, s29
    buffer_load_dwordx4 v155, s[20:23], s54 offen offset:0 sc1 lds
L_attn_g:
    ds_read_b128 v[12:15], v152 offset:0
    ds_read_b64 v[10:11], v153 offset:1024
    s_mov_b64 exec, s[40:41]
    ds_read_b128 v[16:19], v154 offset:1280
    ds_read_b128 v[20:23], v154 offset:1920
    s_mov_b64 exec, -1
    s_waitcnt lgkmcnt(2)
    v_mfma_f32_32x32x16_bf16 v[88:103], v[12:15], v[0:3], 0
    v_mfma_f32_32x32x16_bf16 v[104:119], v[12:15], v[4:7], 0
    s_nop 7
    s_nop 1
    v_mfma_f32_32x32x4_2b_bf16 v[88:119], v[10:11], v[8:9], v[88:119]
    ds_read_b128 v[12:15], v152 offset:2560
    ds_read_b64 v[10:11], v153 offset:3584
    s_nop 7
    s_nop 7
    s_nop 1
    v_max_f32 v156, v88, v89
    v_max3_f32 v156, v156, v90, v91
    v_max3_f32 v156, v156, v92, v93
    v_max3_f32 v156, v156, v94, v95
    v_max3_f32 v156, v156, v96, v97
    v_max3_f32 v156, v156, v98, v99
    v_max3_f32 v156, v156, v100, v101
    v_max3_f32 v156, v156, v102, v103
    v_max3_f32 v156, v156, v104, v105
    v_max3_f32 v156, v156, v106, v107
    v_max3_f32 v156, v156, v108, v109
    v_max3_f32 v156, v156, v110, v111
    v_max3_f32 v156, v156, v112, v113
    v_max3_f32 v156, v156, v114, v115
    v_max3_f32 v156, v156, v116, v117
    v_max3_f32 v156, v156, v118, v119
    v_mov_b32 v158, v156
    s_nop 1
    v_permlane32_swap_b32 v156, v158
    v_max_f32 v156, v156, v158
    v_mov_b32 v157, v156
    v_sub_f32 v72, 0, v156
    v_sub_f32 v73, 0, v156
    v_sub_f32 v74, 0, v156
    v_sub_f32 v75, 0, v156
    v_sub_f32 v76, 0, v156
    v_sub_f32 v77, 0, v156
    v_sub_f32 v78, 0, v156
    v_sub_f32 v79, 0, v156
    v_sub_f32 v80, 0, v156
    v_sub_f32 v81, 0, v156
    v_sub_f32 v82, 0, v156
    v_sub_f32 v83, 0, v156
    v_sub_f32 v84, 0, v156
    v_sub_f32 v85, 0, v156
    v_sub_f32 v86, 0, v156
    v_sub_f32 v87, 0, v156
    v_sub_f32 v88, v88, v156
    v_sub_f32 v89, v89, v156
    v_sub_f32 v90, v90, v156
    v_sub_f32 v91, v91, v156
    v_sub_f32 v92, v92, v156
    v_sub_f32 v93, v93, v156
    v_sub_f32 v94, v94, v156
    v_sub_f32 v95, v95, v156
    v_sub_f32 v96, v96, v156
    v_sub_f32 v97, v97, v156
    v_sub_f32 v98, v98, v156
    v_sub_f32 v99, v99, v156
    v_sub_f32 v100, v100, v156
    v_sub_f32 v101, v101, v156
    v_sub_f32 v102, v102, v156
    v_sub_f32 v103, v103, v156
    v_sub_f32 v104, v104, v156
    v_sub_f32 v105, v105, v156
    v_sub_f32 v106, v106, v156
    v_sub_f32 v107, v107, v156
    v_sub_f32 v108, v108, v156
    v_sub_f32 v109, v109, v156
    v_sub_f32 v110, v110, v156
    v_sub_f32 v111, v111, v156
    v_sub_f32 v112, v112, v156
    v_sub_f32 v113, v113, v156
    v_sub_f32 v114, v114, v156
    v_sub_f32 v115, v115, v156
    v_sub_f32 v116, v116, v156
    v_sub_f32 v117, v117, v156
    v_sub_f32 v118, v118, v156
    v_sub_f32 v119, v119, v156
    s_cmp_eq_u32 s26, 0
    s_cbranch_scc1 L_attn_i
    s_waitcnt vmcnt(9)
    s_barrier
    s_mul_i32 s30, s25, 13312
    s_add_u32 m0, s30, 98304
    s_add_u32 s54, m0, s29
    buffer_load_dwordx4 v155, s[20:23], s54 offen offset:0 sc1 lds
    buffer_load_dwordx4 v155, s[20:23], s54 offen offset:1024 sc1 lds
    buffer_load_dwordx4 v155, s[20:23], s54 offen offset:2048 sc1 lds
    buffer_load_dwordx4 v155, s[20:23], s54 offen offset:3072 sc1 lds
    s_add_u32 m0, s30, 102400
    s_add_u32 s54, m0, s29
    buffer_load_dwordx4 v155, s[20:23], s54 offen offset:0 sc1 lds
    buffer_load_dwordx4 v155, s[20:23], s54 offen offset:1024 sc1 lds
    buffer_load_dwordx4 v155, s[20:23], s54 offen offset:2048 sc1 lds
    buffer_load_dwordx4 v155, s[20:23], s54 offen offset:3072 sc1 lds
    s_add_u32 m0, s30, 106496
    s_add_u32 s54, m0, s29
    buffer_load_dwordx4 v155, s[20:23], s54 offen offset:0 sc1 lds
    buffer_load_dwordx4 v155, s[20:23], s54 offen offset:1024 sc1 lds
    buffer_load_dwordx4 v155, s[20:23], s54 offen offset:2048 sc1 lds
    buffer_load_dwordx4 v155, s[20:23], s54 offen offset:3072 sc1 lds
    s_add_u32 m0, s30, 110592
    s_add_u32 s54, m0, s29
    buffer_load_dwordx4 v155, s[20:23], s54 offen offset:0 sc1 lds
L_attn_i:
    s_waitcnt lgkmcnt(0)
    v_mfma_f32_32x32x16_bf16 v[120:135], v[12:15], v[0:3], v[72:87]
    v_exp_f32 v88, v88
    v_exp_f32 v89, v89
    v_exp_f32 v90, v90
    v_exp_f32 v91, v91
    v_exp_f32 v92, v92
    v_exp_f32 v93, v93
    v_mfma_f32_32x32x16_bf16 v[136:151], v[12:15], v[4:7], v[72:87]
    v_exp_f32 v94, v94
    v_exp_f32 v95, v95
    v_exp_f32 v96, v96
    v_exp_f32 v97, v97
    v_cvt_pk_bf16_f32 v24, v88, v89
    v_cvt_pk_bf16_f32 v25, v90, v91
    v_exp_f32 v98, v98
    v_exp_f32 v99, v99
    v_exp_f32 v100, v100
    v_exp_f32 v101, v101
    v_cvt_pk_bf16_f32 v26, v92, v93
    v_cvt_pk_bf16_f32 v27, v94, v95
    v_exp_f32 v102, v102
    v_exp_f32 v103, v103
    v_cvt_pk_bf16_f32 v28, v96, v97
    v_cvt_pk_bf16_f32 v29, v98, v99
    v_cvt_pk_bf16_f32 v30, v100, v101
    v_cvt_pk_bf16_f32 v31, v102, v103
    v_mfma_f32_32x32x4_2b_bf16 v[120:151], v[10:11], v[8:9], v[120:151]
    v_exp_f32 v104, v104
    v_exp_f32 v105, v105
    v_exp_f32 v106, v106
    v_exp_f32 v107, v107
    v_exp_f32 v108, v108
    v_exp_f32 v109, v109
    v_exp_f32 v110, v110
    v_exp_f32 v111, v111
    s_waitcnt lgkmcnt(0)
    v_mfma_f32_32x32x16_bf16 v[40:55], v[16:19], v[24:27], 0
    v_exp_f32 v112, v112
    v_exp_f32 v113, v113
    v_exp_f32 v114, v114
    v_exp_f32 v115, v115
    v_exp_f32 v116, v116
    v_exp_f32 v117, v117
    v_cvt_pk_bf16_f32 v32, v104, v105
    v_cvt_pk_bf16_f32 v33, v106, v107
    v_mfma_f32_32x32x16_bf16 v[40:55], v[20:23], v[28:31], v[40:55]
    s_cmp_lg_u32 s26, 0
    s_cbranch_scc1 L_lb12
    s_barrier
L_lb12:
    ds_read_b128 v[12:15], v152 offset:5120
    ds_read_b64 v[10:11], v153 offset:6144
    v_exp_f32 v118, v118
    v_exp_f32 v119, v119
    v_cvt_pk_bf16_f32 v34, v108, v109
    v_cvt_pk_bf16_f32 v35, v110, v111
    v_cvt_pk_bf16_f32 v36, v112, v113
    v_cvt_pk_bf16_f32 v37, v114, v115
    v_cvt_pk_bf16_f32 v38, v116, v117
    v_cvt_pk_bf16_f32 v39, v118, v119
    s_waitcnt lgkmcnt(0)
    v_mfma_f32_32x32x16_bf16 v[88:103], v[12:15], v[0:3], v[72:87]
    v_exp_f32 v120, v120
    v_exp_f32 v121, v121
    v_exp_f32 v122, v122
    v_exp_f32 v123, v123
    v_exp_f32 v124, v124
    v_exp_f32 v125, v125
    v_mfma_f32_32x32x16_bf16 v[104:119], v[12:15], v[4:7], v[72:87]
    s_cmp_eq_u32 s26, 0
    s_cbranch_scc1 L_attn_h
    s_waitcnt vmcnt(0)
    s_barrier
L_attn_h:
    v_exp_f32 v126, v126
    v_exp_f32 v127, v127
    v_exp_f32 v128, v128
    v_exp_f32 v129, v129
    v_cvt_pk_bf16_f32 v24, v120, v121
    v_cvt_pk_bf16_f32 v25, v122, v123
    v_mfma_f32_32x32x16_bf16 v[56:71], v[16:19], v[32:35], 0
    v_exp_f32 v130, v130
    v_exp_f32 v131, v131
    v_exp_f32 v132, v132
    v_exp_f32 v133, v133
    v_cvt_pk_bf16_f32 v26, v124, v125
    v_cvt_pk_bf16_f32 v27, v126, v127
    v_mfma_f32_32x32x16_bf16 v[56:71], v[20:23], v[36:39], v[56:71]
    s_mov_b64 exec, s[40:41]
    ds_read_b128 v[16:19], v154 offset:3840
    ds_read_b128 v[20:23], v154 offset:4480
    s_mov_b64 exec, -1
    v_exp_f32 v134, v134
    v_exp_f32 v135, v135
    v_cvt_pk_bf16_f32 v28, v128, v129
    v_cvt_pk_bf16_f32 v29, v130, v131
    v_cvt_pk_bf16_f32 v30, v132, v133
    v_cvt_pk_bf16_f32 v31, v134, v135
    v_mfma_f32_32x32x4_2b_bf16 v[88:119], v[10:11], v[8:9], v[88:119]
    ds_read_b128 v[12:15], v152 offset:7680
    ds_read_b64 v[10:11], v153 offset:8704
    v_exp_f32 v136, v136
    v_exp_f32 v137, v137
    v_exp_f32 v138, v138
    v_exp_f32 v139, v139
    v_exp_f32 v140, v140
    v_exp_f32 v141, v141
    v_exp_f32 v142, v142
    v_exp_f32 v143, v143
    s_waitcnt lgkmcnt(2)
    v_mfma_f32_32x32x16_bf16 v[40:55], v[16:19], v[24:27], v[40:55]
    v_exp_f32 v144, v144
    v_exp_f32 v145, v145
    v_exp_f32 v146, v146
    v_exp_f32 v147, v147
    v_exp_f32 v148, v148
    v_exp_f32 v149, v149
    v_cvt_pk_bf16_f32 v32, v136, v137
    v_cvt_pk_bf16_f32 v33, v138, v139
    v_mfma_f32_32x32x16_bf16 v[40:55], v[20:23], v[28:31], v[40:55]
    v_exp_f32 v150, v150
    v_exp_f32 v151, v151
    v_cvt_pk_bf16_f32 v34, v140, v141
    v_cvt_pk_bf16_f32 v35, v142, v143
    v_cvt_pk_bf16_f32 v36, v144, v145
    v_cvt_pk_bf16_f32 v37, v146, v147
    v_cvt_pk_bf16_f32 v38, v148, v149
    v_cvt_pk_bf16_f32 v39, v150, v151
    s_waitcnt lgkmcnt(0)
    v_mfma_f32_32x32x16_bf16 v[120:135], v[12:15], v[0:3], v[72:87]
    v_exp_f32 v88, v88
    v_exp_f32 v89, v89
    v_exp_f32 v90, v90
    v_exp_f32 v91, v91
    v_exp_f32 v92, v92
    v_exp_f32 v93, v93
    v_mfma_f32_32x32x16_bf16 v[136:151], v[12:15], v[4:7], v[72:87]
    v_exp_f32 v94, v94
    v_exp_f32 v95, v95
    v_exp_f32 v96, v96
    v_exp_f32 v97, v97
    v_cvt_pk_bf16_f32 v24, v88, v89
    v_cvt_pk_bf16_f32 v25, v90, v91
    v_mfma_f32_32x32x16_bf16 v[56:71], v[16:19], v[32:35], v[56:71]
    v_exp_f32 v98, v98
    v_exp_f32 v99, v99
    v_exp_f32 v100, v100
    v_exp_f32 v101, v101
    v_cvt_pk_bf16_f32 v26, v92, v93
    v_cvt_pk_bf16_f32 v27, v94, v95
    v_mfma_f32_32x32x16_bf16 v[56:71], v[20:23], v[36:39], v[56:71]
    s_mov_b64 exec, s[40:41]
    ds_read_b128 v[16:19], v154 offset:6400
    ds_read_b128 v[20:23], v154 offset:7040
    s_mov_b64 exec, -1
    v_exp_f32 v102, v102
    v_exp_f32 v103, v103
    v_cvt_pk_bf16_f32 v28, v96, v97
    v_cvt_pk_bf16_f32 v29, v98, v99
    v_cvt_pk_bf16_f32 v30, v100, v101
    v_cvt_pk_bf16_f32 v31, v102, v103
    v_mfma_f32_32x32x4_2b_bf16 v[120:151], v[10:11], v[8:9], v[120:151]
    ds_read_b128 v[12:15], v152 offset:10240
    ds_read_b64 v[10:11], v153 offset:11264
    v_exp_f32 v104, v104
    v_exp_f32 v105, v105
    v_exp_f32 v106, v106
    v_exp_f32 v107, v107
    v_exp_f32 v108, v108
    v_exp_f32 v109, v109
    v_exp_f32 v110, v110
    v_exp_f32 v111, v111
    s_waitcnt lgkmcnt(2)
    v_mfma_f32_32x32x16_bf16 v[40:55], v[16:19], v[24:27], v[40:55]
    v_exp_f32 v112, v112
    v_exp_f32 v113, v113
    v_exp_f32 v114, v114
    v_exp_f32 v115, v115
    v_exp_f32 v116, v116
    v_exp_f32 v117, v117
    v_cvt_pk_bf16_f32 v32, v104, v105
    v_cvt_pk_bf16_f32 v33, v106, v107
    v_mfma_f32_32x32x16_bf16 v[40:55], v[20:23], v[28:31], v[40:55]
    v_exp_f32 v118, v118
    v_exp_f32 v119, v119
    v_cvt_pk_bf16_f32 v34, v108, v109
    v_cvt_pk_bf16_f32 v35, v110, v111
    v_cvt_pk_bf16_f32 v36, v112, v113
    v_cvt_pk_bf16_f32 v37, v114, v115
    v_cvt_pk_bf16_f32 v38, v116, v117
    v_cvt_pk_bf16_f32 v39, v118, v119
    s_waitcnt lgkmcnt(0)
    v_mfma_f32_32x32x16_bf16 v[88:103], v[12:15], v[0:3], v[72:87]
    v_exp_f32 v120, v120
    v_exp_f32 v121, v121
    v_exp_f32 v122, v122
    v_exp_f32 v123, v123
    v_exp_f32 v124, v124
    v_exp_f32 v125, v125
    v_mfma_f32_32x32x16_bf16 v[104:119], v[12:15], v[4:7], v[72:87]
    s_cmp_lg_u32 s26, 0
    s_cbranch_scc1 L_lb13
    s_barrier
L_lb13:
    v_exp_f32 v126, v126
    v_exp_f32 v127, v127
    v_exp_f32 v128, v128
    v_exp_f32 v129, v129
    v_cvt_pk_bf16_f32 v24, v120, v121
    v_cvt_pk_bf16_f32 v25, v122, v123
    v_mfma_f32_32x32x16_bf16 v[56:71], v[16:19], v[32:35], v[56:71]
    v_exp_f32 v130, v130
    v_exp_f32 v131, v131
    v_exp_f32 v132, v132
    v_exp_f32 v133, v133
    v_cvt_pk_bf16_f32 v26, v124, v125
    v_cvt_pk_bf16_f32 v27, v126, v127
    v_mfma_f32_32x32x16_bf16 v[56:71], v[20:23], v[36:39], v[56:71]
    s_mov_b64 exec, s[40:41]
    ds_read_b128 v[16:19], v154 offset:8960
    ds_read_b128 v[20:23], v154 offset:9600
    s_mov_b64 exec, -1
    v_exp_f32 v134, v134
    v_exp_f32 v135, v135
    v_cvt_pk_bf16_f32 v28, v128, v129
    v_cvt_pk_bf16_f32 v29, v130, v131
    v_cvt_pk_bf16_f32 v30, v132, v133
    v_cvt_pk_bf16_f32 v31, v134, v135
    v_mfma_f32_32x32x4_2b_bf16 v[88:119], v[10:11], v[8:9], v[88:119]
    ds_read_b128 v[12:15], v152 offset:12800
    ds_read_b64 v[10:11], v153 offset:13824
    v_exp_f32 v136, v136
    v_exp_f32 v137, v137
    v_exp_f32 v138, v138
    v_exp_f32 v139, v139
    v_exp_f32 v140, v140
    v_exp_f32 v141, v141
    v_exp_f32 v142, v142
    v_exp_f32 v143, v143
    s_waitcnt lgkmcnt(2)
    v_mfma_f32_32x32x16_bf16 v[40:55], v[16:19], v[24:27], v[40:55]
    v_exp_f32 v144, v144
    v_exp_f32 v145, v145
    v_exp_f32 v146, v146
    v_exp_f32 v147, v147
    v_exp_f32 v148, v148
    v_exp_f32 v149, v149
    v_cvt_pk_bf16_f32 v32, v136, v137
    v_cvt_pk_bf16_f32 v33, v138, v139
    v_mfma_f32_32x32x16_bf16 v[40:55], v[20:23], v[28:31], v[40:55]
    v_exp_f32 v150, v150
    v_exp_f32 v151, v151
    v_cvt_pk_bf16_f32 v34, v140, v141
    v_cvt_pk_bf16_f32 v35, v142, v143
    v_cvt_pk_bf16_f32 v36, v144, v145
    v_cvt_pk_bf16_f32 v37, v146, v147
    v_cvt_pk_bf16_f32 v38, v148, v149
    v_cvt_pk_bf16_f32 v39, v150, v151
    s_waitcnt lgkmcnt(0)
    v_mfma_f32_32x32x16_bf16 v[120:135], v[12:15], v[0:3], v[72:87]
    v_exp_f32 v88, v88
    v_exp_f32 v89, v89
    v_exp_f32 v90, v90
    v_exp_f32 v91, v91
    v_exp_f32 v92, v92
    v_exp_f32 v93, v93
    v_mfma_f32_32x32x16_bf16 v[136:151], v[12:15], v[4:7], v[72:87]
    v_exp_f32 v94, v94
    v_exp_f32 v95, v95
    v_exp_f32 v96, v96
    v_exp_f32 v97, v97
    v_cvt_pk_bf16_f32 v24, v88, v89
    v_cvt_pk_bf16_f32 v25, v90, v91
    v_mfma_f32_32x32x16_bf16 v[56:71], v[16:19], v[32:35], v[56:71]
    v_exp_f32 v98, v98
    v_exp_f32 v99, v99
    v_exp_f32 v100, v100
    v_exp_f32 v101, v101
    v_cvt_pk_bf16_f32 v26, v92, v93
    v_cvt_pk_bf16_f32 v27, v94, v95
    v_mfma_f32_32x32x16_bf16 v[56:71], v[20:23], v[36:39], v[56:71]
    s_mov_b64 exec, s[40:41]
    ds_read_b128 v[16:19], v154 offset:11520
    ds_read_b128 v[20:23], v154 offset:12160
    s_mov_b64 exec, -1
    v_exp_f32 v102, v102
    v_exp_f32 v103, v103
    v_cvt_pk_bf16_f32 v28, v96, v97
    v_cvt_pk_bf16_f32 v29, v98, v99
    v_cvt_pk_bf16_f32 v30, v100, v101
    v_cvt_pk_bf16_f32 v31, v102, v103
    v_mfma_f32_32x32x4_2b_bf16 v[120:151], v[10:11], v[8:9], v[120:151]
    ds_read_b128 v[12:15], v152 offset:15360
    ds_read_b64 v[10:11], v153 offset:16384
    v_exp_f32 v104, v104
    v_exp_f32 v105, v105
    v_exp_f32 v106, v106
    v_exp_f32 v107, v107
    v_exp_f32 v108, v108
    v_exp_f32 v109, v109
    v_exp_f32 v110, v110
    v_exp_f32 v111, v111
    s_waitcnt lgkmcnt(2)
    v_mfma_f32_32x32x16_bf16 v[40:55], v[16:19], v[24:27], v[40:55]
    v_exp_f32 v112, v112
    v_exp_f32 v113, v113
    v_exp_f32 v114, v114
    v_exp_f32 v115, v115
    v_exp_f32 v116, v116
    v_exp_f32 v117, v117
    v_cvt_pk_bf16_f32 v32, v104, v105
    v_cvt_pk_bf16_f32 v33, v106, v107
    v_mfma_f32_32x32x16_bf16 v[40:55], v[20:23], v[28:31], v[40:55]
    v_exp_f32 v118, v118
    v_exp_f32 v119, v119
    v_cvt_pk_bf16_f32 v34, v108, v109
    v_cvt_pk_bf16_f32 v35, v110, v111
    v_cvt_pk_bf16_f32 v36, v112, v113
    v_cvt_pk_bf16_f32 v37, v114, v115
    v_cvt_pk_bf16_f32 v38, v116, v117
    v_cvt_pk_bf16_f32 v39, v118, v119
    s_waitcnt lgkmcnt(0)
    v_mfma_f32_32x32x16_bf16 v[88:103], v[12:15], v[0:3], v[72:87]
    v_exp_f32 v120, v120
    v_exp_f32 v121, v121
    v_exp_f32 v122, v122
    v_exp_f32 v123, v123
    v_exp_f32 v124, v124
    v_exp_f32 v125, v125
    v_mfma_f32_32x32x16_bf16 v[104:119], v[12:15], v[4:7], v[72:87]
    v_exp_f32 v126, v126
    v_exp_f32 v127, v127
    v_exp_f32 v128, v128
    v_exp_f32 v129, v129
    v_cvt_pk_bf16_f32 v24, v120, v121
    v_cvt_pk_bf16_f32 v25, v122, v123
    v_mfma_f32_32x32x16_bf16 v[56:71], v[16:19], v[32:35], v[56:71]
    v_exp_f32 v130, v130
    v_exp_f32 v131, v131
    v_exp_f32 v132, v132
    v_exp_f32 v133, v133
    v_cvt_pk_bf16_f32 v26, v124, v125
    v_cvt_pk_bf16_f32 v27, v126, v127
    v_mfma_f32_32x32x16_bf16 v[56:71], v[20:23], v[36:39], v[56:71]
    s_mov_b64 exec, s[40:41]
    ds_read_b128 v[16:19], v154 offset:14080
    ds_read_b128 v[20:23], v154 offset:14720
    s_mov_b64 exec, -1
    v_exp_f32 v134, v134
    v_exp_f32 v135, v135
    v_cvt_pk_bf16_f32 v28, v128, v129
    v_cvt_pk_bf16_f32 v29, v130, v131
    v_cvt_pk_bf16_f32 v30, v132, v133
    v_cvt_pk_bf16_f32 v31, v134, v135
    v_mfma_f32_32x32x4_2b_bf16 v[88:119], v[10:11], v[8:9], v[88:119]
    ds_read_b128 v[12:15], v152 offset:17920
    ds_read_b64 v[10:11], v153 offset:18944
    v_exp_f32 v136, v136
    v_exp_f32 v137, v137
    v_exp_f32 v138, v138
    v_exp_f32 v139, v139
    v_exp_f32 v140, v140
    v_exp_f32 v141, v141
    v_exp_f32 v142, v142
    v_exp_f32 v143, v143
    s_waitcnt lgkmcnt(2)
    v_mfma_f32_32x32x16_bf16 v[40:55], v[16:19], v[24:27], v[40:55]
    s_cmp_eq_u32 s56, 0
    s_cbranch_scc1 L_rp14
    s_lshr_b32 s48, s2, 3
    s_bfe_u32 s49, s2, 0x20001
    s_and_b32 s50, s2, 1
    s_lshl_b32 s55, s25, 1
    s_mul_i32 s51, s49, 6
    s_add_u32 s51, s51, s55
    s_lshl_b32 s52, s50, 5
    s_add_u32 s52, s52, s48
    s_mul_i32 s30, s52, 98304
    s_lshl_b32 s58, s51, 6
    s_add_u32 s58, s58, s52
    s_lshl_b32 s54, s51, 7
    s_add_u32 s30, s30, s54
    s_add_u32 m0, s57, 0
    s_add_u32 s54, s30, 0
    buffer_load_dwordx4 v208, s[12:15], s54 offen offset:0 lds
    s_add_u32 s54, s30, 23552
    buffer_load_dwordx4 v208, s[12:15], s54 offen offset:1024 lds
    s_add_u32 s54, s30, 47104
    buffer_load_dwordx4 v208, s[12:15], s54 offen offset:2048 lds
    s_add_u32 s54, s30, 70656
    buffer_load_dwordx4 v208, s[12:15], s54 offen offset:3072 lds
    s_add_u32 m0, s57, 81920
    s_add_u32 s54, s30, 128
    buffer_load_dwordx4 v208, s[12:15], s54 offen offset:0 lds
    s_add_u32 s54, s30, 23680
    buffer_load_dwordx4 v208, s[12:15], s54 offen offset:1024 lds
    s_add_u32 s54, s30, 47232
    buffer_load_dwordx4 v208, s[12:15], s54 offen offset:2048 lds
    s_add_u32 s54, s30, 70784
    buffer_load_dwordx4 v208, s[12:15], s54 offen offset:3072 lds
L_rp14:
    v_exp_f32 v144, v144
    v_exp_f32 v145, v145
    v_exp_f32 v146, v146
    v_exp_f32 v147, v147
    v_exp_f32 v148, v148
    v_exp_f32 v149, v149
    v_cvt_pk_bf16_f32 v32, v136, v137
    v_cvt_pk_bf16_f32 v33, v138, v139
    v_mfma_f32_32x32x16_bf16 v[40:55], v[20:23], v[28:31], v[40:55]
    v_exp_f32 v150, v150
    v_exp_f32 v151, v151
    v_cvt_pk_bf16_f32 v34, v140, v141
    v_cvt_pk_bf16_f32 v35, v142, v143
    v_cvt_pk_bf16_f32 v36, v144, v145
    v_cvt_pk_bf16_f32 v37, v146, v147
    v_cvt_pk_bf16_f32 v38, v148, v149
    v_cvt_pk_bf16_f32 v39, v150, v151
    s_waitcnt lgkmcnt(0)
    v_mfma_f32_32x32x16_bf16 v[120:135], v[12:15], v[0:3], v[72:87]
    v_exp_f32 v88, v88
    v_exp_f32 v89, v89
    v_exp_f32 v90, v90
    v_exp_f32 v91, v91
    v_exp_f32 v92, v92
    v_exp_f32 v93, v93
    v_mfma_f32_32x32x16_bf16 v[136:151], v[12:15], v[4:7], v[72:87]
    v_exp_f32 v94, v94
    v_exp_f32 v95, v95
    v_exp_f32 v96, v96
    v_exp_f32 v97, v97
    v_cvt_pk_bf16_f32 v24, v88, v89
    v_cvt_pk_bf16_f32 v25, v90, v91
    v_mfma_f32_32x32x16_bf16 v[56:71], v[16:19], v[32:35], v[56:71]
    v_exp_f32 v98, v98
    v_exp_f32 v99, v99
    v_exp_f32 v100, v100
    v_exp_f32 v101, v101
    v_cvt_pk_bf16_f32 v26, v92, v93
    v_cvt_pk_bf16_f32 v27, v94, v95
    v_mfma_f32_32x32x16_bf16 v[56:71], v[20:23], v[36:39], v[56:71]
    s_mov_b64 exec, s[40:41]
    ds_read_b128 v[16:19], v154 offset:16640
    ds_read_b128 v[20:23], v154 offset:17280
    s_mov_b64 exec, -1
    v_exp_f32 v102, v102
    v_exp_f32 v103, v103
    v_cvt_pk_bf16_f32 v28, v96, v97
    v_cvt_pk_bf16_f32 v29, v98, v99
    v_cvt_pk_bf16_f32 v30, v100, v101
    v_cvt_pk_bf16_f32 v31, v102, v103
    v_mfma_f32_32x32x4_2b_bf16 v[120:151], v[10:11], v[8:9], v[120:151]
    ds_read_b128 v[12:15], v152 offset:20480
    ds_read_b64 v[10:11], v153 offset:21504
    v_exp_f32 v104, v104
    v_exp_f32 v105, v105
    v_exp_f32 v106, v106
    v_exp_f32 v107, v107
    v_exp_f32 v108, v108
    v_exp_f32 v109, v109
    v_exp_f32 v110, v110
    v_exp_f32 v111, v111
    s_waitcnt lgkmcnt(2)
    v_mfma_f32_32x32x16_bf16 v[40:55], v[16:19], v[24:27], v[40:55]
    v_exp_f32 v112, v112
    v_exp_f32 v113, v113
    v_exp_f32 v114, v114
    v_exp_f32 v115, v115
    v_exp_f32 v116, v116
    v_exp_f32 v117, v117
    v_cvt_pk_bf16_f32 v32, v104, v105
    v_cvt_pk_bf16_f32 v33, v106, v107
    v_mfma_f32_32x32x16_bf16 v[40:55], v[20:23], v[28:31], v[40:55]
    v_exp_f32 v118, v118
    v_exp_f32 v119, v119
    v_cvt_pk_bf16_f32 v34, v108, v109
    v_cvt_pk_bf16_f32 v35, v110, v111
    v_cvt_pk_bf16_f32 v36, v112, v113
    v_cvt_pk_bf16_f32 v37, v114, v115
    v_cvt_pk_bf16_f32 v38, v116, v117
    v_cvt_pk_bf16_f32 v39, v118, v119
    s_waitcnt lgkmcnt(0)
    v_mfma_f32_32x32x16_bf16 v[88:103], v[12:15], v[0:3], v[72:87]
    v_exp_f32 v120, v120
    v_exp_f32 v121, v121
    v_exp_f32 v122, v122
    v_exp_f32 v123, v123
    v_exp_f32 v124, v124
    v_exp_f32 v125, v125
    v_mfma_f32_32x32x16_bf16 v[104:119], v[12:15], v[4:7], v[72:87]
    v_exp_f32 v126, v126
    v_exp_f32 v127, v127
    v_exp_f32 v128, v128
    v_exp_f32 v129, v129
    v_cvt_pk_bf16_f32 v24, v120, v121
    v_cvt_pk_bf16_f32 v25, v122, v123
    v_mfma_f32_32x32x16_bf16 v[56:71], v[16:19], v[32:35], v[56:71]
    v_exp_f32 v130, v130
    v_exp_f32 v131, v131
    v_exp_f32 v132, v132
    v_exp_f32 v133, v133
    v_cvt_pk_bf16_f32 v26, v124, v125
    v_cvt_pk_bf16_f32 v27, v126, v127
    v_mfma_f32_32x32x16_bf16 v[56:71], v[20:23], v[36:39], v[56:71]
    s_mov_b64 exec, s[40:41]
    ds_read_b128 v[16:19], v154 offset:19200
    ds_read_b128 v[20:23], v154 offset:19840
    s_mov_b64 exec, -1
    v_exp_f32 v134, v134
    v_exp_f32 v135, v135
    v_cvt_pk_bf16_f32 v28, v128, v129
    v_cvt_pk_bf16_f32 v29, v130, v131
    v_cvt_pk_bf16_f32 v30, v132, v133
    v_cvt_pk_bf16_f32 v31, v134, v135
    v_mfma_f32_32x32x4_2b_bf16 v[88:119], v[10:11], v[8:9], v[88:119]
    ds_read_b128 v[12:15], v152 offset:23040
    ds_read_b64 v[10:11], v153 offset:24064
    v_exp_f32 v136, v136
    v_exp_f32 v137, v137
    v_exp_f32 v138, v138
    v_exp_f32 v139, v139
    v_exp_f32 v140, v140
    v_exp_f32 v141, v141
    v_exp_f32 v142, v142
    v_exp_f32 v143, v143
    s_waitcnt lgkmcnt(2)
    v_mfma_f32_32x32x16_bf16 v[40:55], v[16:19], v[24:27], v[40:55]
    v_exp_f32 v144, v144
    v_exp_f32 v145, v145
    v_exp_f32 v146, v146
    v_exp_f32 v147, v147
    v_exp_f32 v148, v148
    v_exp_f32 v149, v149
    v_cvt_pk_bf16_f32 v32, v136, v137
    v_cvt_pk_bf16_f32 v33, v138, v139
    v_mfma_f32_32x32x16_bf16 v[40:55], v[20:23], v[28:31], v[40:55]
    v_exp_f32 v150, v150
    v_exp_f32 v151, v151
    v_cvt_pk_bf16_f32 v34, v140, v141
    v_cvt_pk_bf16_f32 v35, v142, v143
    v_cvt_pk_bf16_f32 v36, v144, v145
    v_cvt_pk_bf16_f32 v37, v146, v147
    v_cvt_pk_bf16_f32 v38, v148, v149
    v_cvt_pk_bf16_f32 v39, v150, v151
    s_waitcnt lgkmcnt(0)
    v_mfma_f32_32x32x16_bf16 v[120:135], v[12:15], v[0:3], v[72:87]
    v_exp_f32 v88, v88
    v_exp_f32 v89, v89
    v_exp_f32 v90, v90
    v_exp_f32 v91, v91
    v_exp_f32 v92, v92
    v_exp_f32 v93, v93
    v_mfma_f32_32x32x16_bf16 v[136:151], v[12:15], v[4:7], v[72:87]
    s_cmp_lg_u32 s26, 0
    s_cbranch_scc1 L_lb15
    s_barrier
L_lb15:
    v_exp_f32 v94, v94
    v_exp_f32 v95, v95
    v_exp_f32 v96, v96
    v_exp_f32 v97, v97
    v_cvt_pk_bf16_f32 v24, v88, v89
    v_cvt_pk_bf16_f32 v25, v90, v91
    v_mfma_f32_32x32x16_bf16 v[56:71], v[16:19], v[32:35], v[56:71]
    v_exp_f32 v98, v98
    v_exp_f32 v99, v99
    v_exp_f32 v100, v100
    v_exp_f32 v101, v101
    v_cvt_pk_bf16_f32 v26, v92, v93
    v_cvt_pk_bf16_f32 v27, v94, v95
    v_mfma_f32_32x32x16_bf16 v[56:71], v[20:23], v[36:39], v[56:71]
    s_mov_b64 exec, s[40:41]
    ds_read_b128 v[16:19], v154 offset:21760
    ds_read_b128 v[20:23], v154 offset:22400
    s_mov_b64 exec, -1
    v_exp_f32 v102, v102
    v_exp_f32 v103, v103
    v_cvt_pk_bf16_f32 v28, v96, v97
    v_cvt_pk_bf16_f32 v29, v98, v99
    v_cvt_pk_bf16_f32 v30, v100, v101
    v_cvt_pk_bf16_f32 v31, v102, v103
    v_mfma_f32_32x32x4_2b_bf16 v[120:151], v[10:11], v[8:9], v[120:151]
    ds_read_b128 v[12:15], v152 offset:25600
    ds_read_b64 v[10:11], v153 offset:26624
    v_exp_f32 v104, v104
    v_exp_f32 v105, v105
    v_exp_f32 v106, v106
    v_exp_f32 v107, v107
    v_exp_f32 v108, v108
    v_exp_f32 v109, v109
    v_exp_f32 v110, v110
    v_exp_f32 v111, v111
    s_waitcnt lgkmcnt(2)
    v_mfma_f32_32x32x16_bf16 v[40:55], v[16:19], v[24:27], v[40:55]
    v_exp_f32 v112, v112
    v_exp_f32 v113, v113
    v_exp_f32 v114, v114
    v_exp_f32 v115, v115
    v_exp_f32 v116, v116
    v_exp_f32 v117, v117
    v_cvt_pk_bf16_f32 v32, v104, v105
    v_cvt_pk_bf16_f32 v33, v106, v107
    v_mfma_f32_32x32x16_bf16 v[40:55], v[20:23], v[28:31], v[40:55]
    v_exp_f32 v118, v118
    v_exp_f32 v119, v119
    v_cvt_pk_bf16_f32 v34, v108, v109
    v_cvt_pk_bf16_f32 v35, v110, v111
    v_cvt_pk_bf16_f32 v36, v112, v113
    v_cvt_pk_bf16_f32 v37, v114, v115
    v_cvt_pk_bf16_f32 v38, v116, v117
    v_cvt_pk_bf16_f32 v39, v118, v119
    s_waitcnt lgkmcnt(0)
    v_mfma_f32_32x32x16_bf16 v[88:103], v[12:15], v[0:3], v[72:87]
    v_exp_f32 v120, v120
    v_exp_f32 v121, v121
    v_exp_f32 v122, v122
    v_exp_f32 v123, v123
    v_exp_f32 v124, v124
    v_exp_f32 v125, v125
    v_mfma_f32_32x32x16_bf16 v[104:119], v[12:15], v[4:7], v[72:87]
    v_exp_f32 v126, v126
    v_exp_f32 v127, v127
    v_exp_f32 v128, v128
    v_exp_f32 v129, v129
    v_cvt_pk_bf16_f32 v24, v120, v121
    v_cvt_pk_bf16_f32 v25, v122, v123
    v_mfma_f32_32x32x16_bf16 v[56:71], v[16:19], v[32:35], v[56:71]
    v_exp_f32 v130, v130
    v_exp_f32 v131, v131
    v_exp_f32 v132, v132
    v_exp_f32 v133, v133
    v_cvt_pk_bf16_f32 v26, v124, v125
    v_cvt_pk_bf16_f32 v27, v126, v127
    v_mfma_f32_32x32x16_bf16 v[56:71], v[20:23], v[36:39], v[56:71]
    s_mov_b64 exec, s[40:41]
    ds_read_b128 v[16:19], v154 offset:24320
    ds_read_b128 v[20:23], v154 offset:24960
    s_mov_b64 exec, -1
    v_exp_f32 v134, v134
    v_exp_f32 v135, v135
    v_cvt_pk_bf16_f32 v28, v128, v129
    v_cvt_pk_bf16_f32 v29, v130, v131
    v_cvt_pk_bf16_f32 v30, v132, v133
    v_cvt_pk_bf16_f32 v31, v134, v135
    v_mfma_f32_32x32x4_2b_bf16 v[88:119], v[10:11], v[8:9], v[88:119]
    ds_read_b128 v[12:15], v152 offset:28160
    ds_read_b64 v[10:11], v153 offset:29184
    v_exp_f32 v136, v136
    v_exp_f32 v137, v137
    v_exp_f32 v138, v138
    v_exp_f32 v139, v139
    v_exp_f32 v140, v140
    v_exp_f32 v141, v141
    v_exp_f32 v142, v142
    v_exp_f32 v143, v143
    s_waitcnt lgkmcnt(2)
    v_mfma_f32_32x32x16_bf16 v[40:55], v[16:19], v[24:27], v[40:55]
    s_cmp_eq_u32 s56, 0
    s_cbranch_scc1 L_rp16
    v_add_u32 v210, 81920, v212
    s_waitcnt vmcnt(0)
    ds_read_b64_tr_b16 v[176:177], v212 offset:0
    ds_read_b64_tr_b16 v[178:179], v212 offset:512
    ds_read_b64_tr_b16 v[180:181], v212 offset:64
    ds_read_b64_tr_b16 v[182:183], v212 offset:576
    ds_read_b64_tr_b16 v[184:185], v212 offset:2048
    ds_read_b64_tr_b16 v[186:187], v212 offset:2560
    ds_read_b64_tr_b16 v[188:189], v212 offset:2112
    ds_read_b64_tr_b16 v[190:191], v212 offset:2624
    ds_read_b64_tr_b16 v[192:193], v210 offset:0
    ds_read_b64_tr_b16 v[194:195], v210 offset:512
    ds_read_b64_tr_b16 v[196:197], v210 offset:64
    ds_read_b64_tr_b16 v[198:199], v210 offset:576
    ds_read_b64_tr_b16 v[200:201], v210 offset:2048
    ds_read_b64_tr_b16 v[202:203], v210 offset:2560
    ds_read_b64_tr_b16 v[204:205], v210 offset:2112
    ds_read_b64_tr_b16 v[206:207], v210 offset:2624
L_rp16:
    v_exp_f32 v144, v144
    v_exp_f32 v145, v145
    v_exp_f32 v146, v146
    v_exp_f32 v147, v147
    v_exp_f32 v148, v148
    v_exp_f32 v149, v149
    v_cvt_pk_bf16_f32 v32, v136, v137
    v_cvt_pk_bf16_f32 v33, v138, v139
    v_mfma_f32_32x32x16_bf16 v[40:55], v[20:23], v[28:31], v[40:55]
    v_exp_f32 v150, v150
    v_exp_f32 v151, v151
    v_cvt_pk_bf16_f32 v34, v140, v141
    v_cvt_pk_bf16_f32 v35, v142, v143
    v_cvt_pk_bf16_f32 v36, v144, v145
    v_cvt_pk_bf16_f32 v37, v146, v147
    v_cvt_pk_bf16_f32 v38, v148, v149
    v_cvt_pk_bf16_f32 v39, v150, v151
    s_waitcnt lgkmcnt(0)
    v_mfma_f32_32x32x16_bf16 v[120:135], v[12:15], v[0:3], v[72:87]
    v_exp_f32 v88, v88
    v_exp_f32 v89, v89
    v_exp_f32 v90, v90
    v_exp_f32 v91, v91
    v_exp_f32 v92, v92
    v_exp_f32 v93, v93
    v_mfma_f32_32x32x16_bf16 v[136:151], v[12:15], v[4:7], v[72:87]
    v_exp_f32 v94, v94
    v_exp_f32 v95, v95
    v_exp_f32 v96, v96
    v_exp_f32 v97, v97
    v_cvt_pk_bf16_f32 v24, v88, v89
    v_cvt_pk_bf16_f32 v25, v90, v91
    v_mfma_f32_32x32x16_bf16 v[56:71], v[16:19], v[32:35], v[56:71]
    v_exp_f32 v98, v98
    v_exp_f32 v99, v99
    v_exp_f32 v100, v100
    v_exp_f32 v101, v101
    v_cvt_pk_bf16_f32 v26, v92, v93
    v_cvt_pk_bf16_f32 v27, v94, v95
    v_mfma_f32_32x32x16_bf16 v[56:71], v[20:23], v[36:39], v[56:71]
    s_mov_b64 exec, s[40:41]
    ds_read_b128 v[16:19], v154 offset:26880
    ds_read_b128 v[20:23], v154 offset:27520
    s_mov_b64 exec, -1
    v_exp_f32 v102, v102
    v_exp_f32 v103, v103
    v_cvt_pk_bf16_f32 v28, v96, v97
    v_cvt_pk_bf16_f32 v29, v98, v99
    v_cvt_pk_bf16_f32 v30, v100, v101
    v_cvt_pk_bf16_f32 v31, v102, v103
    v_mfma_f32_32x32x4_2b_bf16 v[120:151], v[10:11], v[8:9], v[120:151]
    ds_read_b128 v[12:15], v152 offset:30720
    ds_read_b64 v[10:11], v153 offset:31744
    v_exp_f32 v104, v104
    v_exp_f32 v105, v105
    v_exp_f32 v106, v106
    v_exp_f32 v107, v107
    v_exp_f32 v108, v108
    v_exp_f32 v109, v109
    v_exp_f32 v110, v110
    v_exp_f32 v111, v111
    s_waitcnt lgkmcnt(2)
    v_mfma_f32_32x32x16_bf16 v[40:55], v[16:19], v[24:27], v[40:55]
    s_cmp_eq_u32 s56, 0
    s_cbranch_scc1 L_rp17
    s_lshl_b32 s30, s58, 12
    s_add_u32 s30, s30, 0x500000
    s_add_u32 s54, s30, 262144
    buffer_store_dwordx4 v[176:179], v155, s[4:7], s30 offen offset:0 sc1
    buffer_store_dwordx4 v[180:183], v155, s[4:7], s30 offen offset:1024 sc1
    buffer_store_dwordx4 v[184:187], v155, s[4:7], s30 offen offset:2048 sc1
    buffer_store_dwordx4 v[188:191], v155, s[4:7], s30 offen offset:3072 sc1
    buffer_store_dwordx4 v[192:195], v155, s[4:7], s54 offen offset:0 sc1
    buffer_store_dwordx4 v[196:199], v155, s[4:7], s54 offen offset:1024 sc1
    buffer_store_dwordx4 v[200:203], v155, s[4:7], s54 offen offset:2048 sc1
    buffer_store_dwordx4 v[204:207], v155, s[4:7], s54 offen offset:3072 sc1
    s_lshr_b32 s48, s2, 3
    s_bfe_u32 s49, s2, 0x20001
    s_and_b32 s50, s2, 1
    s_lshl_b32 s55, s25, 1
    s_mul_i32 s51, s48, 6
    s_add_u32 s51, s51, s55
    s_mul_i32 s52, s50, 24
    s_lshr_b32 s30, s51, 3
    s_add_u32 s52, s52, s30
    s_and_b32 s51, s51, 7
    s_lshl_b32 s30, s49, 3
    s_add_u32 s51, s51, s30
    s_lshl_b32 s30, s52, 17
    s_mul_i32 s59, s51, 48
    s_add_u32 s59, s59, s52
    s_lshl_b32 s54, s51, 7
    s_add_u32 s30, s30, s54
    s_add_u32 m0, s57, 0
    s_add_u32 s54, s30, 0
    buffer_load_dwordx4 v209, s[16:19], s54 offen offset:0 lds
    s_add_u32 s54, s30, 31744
    buffer_load_dwordx4 v209, s[16:19], s54 offen offset:1024 lds
    s_add_u32 s54, s30, 63488
    buffer_load_dwordx4 v209, s[16:19], s54 offen offset:2048 lds
    s_add_u32 s54, s30, 95232
    buffer_load_dwordx4 v209, s[16:19], s54 offen offset:3072 lds
    s_add_u32 m0, s57, 81920
    s_add_u32 s54, s30, 128
    buffer_load_dwordx4 v209, s[16:19], s54 offen offset:0 lds
    s_add_u32 s54, s30, 31872
    buffer_load_dwordx4 v209, s[16:19], s54 offen offset:1024 lds
    s_add_u32 s54, s30, 63616
    buffer_load_dwordx4 v209, s[16:19], s54 offen offset:2048 lds
    s_add_u32 s54, s30, 95360
    buffer_load_dwordx4 v209, s[16:19], s54 offen offset:3072 lds
L_rp17:
    v_exp_f32 v112, v112
    v_exp_f32 v113, v113
    v_exp_f32 v114, v114
    v_exp_f32 v115, v115
    v_exp_f32 v116, v116
    v_exp_f32 v117, v117
    v_cvt_pk_bf16_f32 v32, v104, v105
    v_cvt_pk_bf16_f32 v33, v106, v107
    v_mfma_f32_32x32x16_bf16 v[40:55], v[20:23], v[28:31], v[40:55]
    v_exp_f32 v118, v118
    v_exp_f32 v119, v119
    v_cvt_pk_bf16_f32 v34, v108, v109
    v_cvt_pk_bf16_f32 v35, v110, v111
    v_cvt_pk_bf16_f32 v36, v112, v113
    v_cvt_pk_bf16_f32 v37, v114, v115
    v_cvt_pk_bf16_f32 v38, v116, v117
    v_cvt_pk_bf16_f32 v39, v118, v119
    s_waitcnt lgkmcnt(0)
    v_mfma_f32_32x32x16_bf16 v[88:103], v[12:15], v[0:3], v[72:87]
    v_exp_f32 v120, v120
    v_exp_f32 v121, v121
    v_exp_f32 v122, v122
    v_exp_f32 v123, v123
    v_exp_f32 v124, v124
    v_exp_f32 v125, v125
    v_mfma_f32_32x32x16_bf16 v[104:119], v[12:15], v[4:7], v[72:87]
    v_exp_f32 v126, v126
    v_exp_f32 v127, v127
    v_exp_f32 v128, v128
    v_exp_f32 v129, v129
    v_cvt_pk_bf16_f32 v24, v120, v121
    v_cvt_pk_bf16_f32 v25, v122, v123
    v_mfma_f32_32x32x16_bf16 v[56:71], v[16:19], v[32:35], v[56:71]
    v_exp_f32 v130, v130
    v_exp_f32 v131, v131
    v_exp_f32 v132, v132
    v_exp_f32 v133, v133
    v_cvt_pk_bf16_f32 v26, v124, v125
    v_cvt_pk_bf16_f32 v27, v126, v127
    v_mfma_f32_32x32x16_bf16 v[56:71], v[20:23], v[36:39], v[56:71]
    s_mov_b64 exec, s[40:41]
    ds_read_b128 v[16:19], v154 offset:29440
    ds_read_b128 v[20:23], v154 offset:30080
    s_mov_b64 exec, -1
    v_exp_f32 v134, v134
    v_exp_f32 v135, v135
    v_cvt_pk_bf16_f32 v28, v128, v129
    v_cvt_pk_bf16_f32 v29, v130, v131
    v_cvt_pk_bf16_f32 v30, v132, v133
    v_cvt_pk_bf16_f32 v31, v134, v135
    v_mfma_f32_32x32x4_2b_bf16 v[88:119], v[10:11], v[8:9], v[88:119]
    ds_read_b128 v[12:15], v152 offset:33280
    ds_read_b64 v[10:11], v153 offset:34304
    v_exp_f32 v136, v136
    v_exp_f32 v137, v137
    v_exp_f32 v138, v138
    v_exp_f32 v139, v139
    v_exp_f32 v140, v140
    v_exp_f32 v141, v141
    v_exp_f32 v142, v142
    v_exp_f32 v143, v143
    s_waitcnt lgkmcnt(2)
    v_mfma_f32_32x32x16_bf16 v[40:55], v[16:19], v[24:27], v[40:55]
    v_exp_f32 v144, v144
    v_exp_f32 v145, v145
    v_exp_f32 v146, v146
    v_exp_f32 v147, v147
    v_exp_f32 v148, v148
    v_exp_f32 v149, v149
    v_cvt_pk_bf16_f32 v32, v136, v137
    v_cvt_pk_bf16_f32 v33, v138, v139
    v_mfma_f32_32x32x16_bf16 v[40:55], v[20:23], v[28:31], v[40:55]
    v_exp_f32 v150, v150
    v_exp_f32 v151, v151
    v_cvt_pk_bf16_f32 v34, v140, v141
    v_cvt_pk_bf16_f32 v35, v142, v143
    v_cvt_pk_bf16_f32 v36, v144, v145
    v_cvt_pk_bf16_f32 v37, v146, v147
    v_cvt_pk_bf16_f32 v38, v148, v149
    v_cvt_pk_bf16_f32 v39, v150, v151
    s_waitcnt lgkmcnt(0)
    v_mfma_f32_32x32x16_bf16 v[120:135], v[12:15], v[0:3], v[72:87]
    v_exp_f32 v88, v88
    v_exp_f32 v89, v89
    v_exp_f32 v90, v90
    v_exp_f32 v91, v91
    v_exp_f32 v92, v92
    v_exp_f32 v93, v93
    v_mfma_f32_32x32x16_bf16 v[136:151], v[12:15], v[4:7], v[72:87]
    v_exp_f32 v94, v94
    v_exp_f32 v95, v95
    v_exp_f32 v96, v96
    v_exp_f32 v97, v97
    v_cvt_pk_bf16_f32 v24, v88, v89
    v_cvt_pk_bf16_f32 v25, v90, v91
    v_mfma_f32_32x32x16_bf16 v[56:71], v[16:19], v[32:35], v[56:71]
    v_exp_f32 v98, v98
    v_exp_f32 v99, v99
    v_exp_f32 v100, v100
    v_exp_f32 v101, v101
    v_cvt_pk_bf16_f32 v26, v92, v93
    v_cvt_pk_bf16_f32 v27, v94, v95
    v_mfma_f32_32x32x16_bf16 v[56:71], v[20:23], v[36:39], v[56:71]
    s_mov_b64 exec, s[40:41]
    ds_read_b128 v[16:19], v154 offset:32000
    ds_read_b128 v[20:23], v154 offset:32640
    s_mov_b64 exec, -1
    v_exp_f32 v102, v102
    v_exp_f32 v103, v103
    v_cvt_pk_bf16_f32 v28, v96, v97
    v_cvt_pk_bf16_f32 v29, v98, v99
    v_cvt_pk_bf16_f32 v30, v100, v101
    v_cvt_pk_bf16_f32 v31, v102, v103
    v_mfma_f32_32x32x4_2b_bf16 v[120:151], v[10:11], v[8:9], v[120:151]
    ds_read_b128 v[12:15], v152 offset:35840
    ds_read_b64 v[10:11], v153 offset:36864
    v_exp_f32 v104, v104
    v_exp_f32 v105, v105
    v_exp_f32 v106, v106
    v_exp_f32 v107, v107
    v_exp_f32 v108, v108
    v_exp_f32 v109, v109
    v_exp_f32 v110, v110
    v_exp_f32 v111, v111
    s_waitcnt lgkmcnt(2)
    v_mfma_f32_32x32x16_bf16 v[40:55], v[16:19], v[24:27], v[40:55]
    s_cmp_eq_u32 s56, 0
    s_cbranch_scc1 L_rp18
    s_waitcnt vmcnt(8)
    s_lshl_b32 s60, s58, 6
    s_add_u32 s60, s60, 0x1480000
    v_mov_b32 v214, s90
    v_mul_u32_u24 v215, 4096, v252
    s_mov_b64 exec, 3
    buffer_store_dword v214, v215, s[4:7], s60 offen sc1
    s_mov_b64 exec, -1
L_rp18:
    v_exp_f32 v112, v112
    v_exp_f32 v113, v113
    v_exp_f32 v114, v114
    v_exp_f32 v115, v115
    v_exp_f32 v116, v116
    v_exp_f32 v117, v117
    v_cvt_pk_bf16_f32 v32, v104, v105
    v_cvt_pk_bf16_f32 v33, v106, v107
    v_mfma_f32_32x32x16_bf16 v[40:55], v[20:23], v[28:31], v[40:55]
    v_exp_f32 v118, v118
    v_exp_f32 v119, v119
    v_cvt_pk_bf16_f32 v34, v108, v109
    v_cvt_pk_bf16_f32 v35, v110, v111
    v_cvt_pk_bf16_f32 v36, v112, v113
    v_cvt_pk_bf16_f32 v37, v114, v115
    v_cvt_pk_bf16_f32 v38, v116, v117
    v_cvt_pk_bf16_f32 v39, v118, v119
    s_waitcnt lgkmcnt(0)
    v_mfma_f32_32x32x16_bf16 v[88:103], v[12:15], v[0:3], v[72:87]
    v_exp_f32 v120, v120
    v_exp_f32 v121, v121
    v_exp_f32 v122, v122
    v_exp_f32 v123, v123
    v_exp_f32 v124, v124
    v_exp_f32 v125, v125
    v_mfma_f32_32x32x16_bf16 v[104:119], v[12:15], v[4:7], v[72:87]
    v_exp_f32 v126, v126
    v_exp_f32 v127, v127
    v_exp_f32 v128, v128
    v_exp_f32 v129, v129
    v_cvt_pk_bf16_f32 v24, v120, v121
    v_cvt_pk_bf16_f32 v25, v122, v123
    v_mfma_f32_32x32x16_bf16 v[56:71], v[16:19], v[32:35], v[56:71]
    v_exp_f32 v130, v130
    v_exp_f32 v131, v131
    v_exp_f32 v132, v132
    v_exp_f32 v133, v133
    v_cvt_pk_bf16_f32 v26, v124, v125
    v_cvt_pk_bf16_f32 v27, v126, v127
    v_mfma_f32_32x32x16_bf16 v[56:71], v[20:23], v[36:39], v[56:71]
    s_mov_b64 exec, s[40:41]
    ds_read_b128 v[16:19], v154 offset:34560
    ds_read_b128 v[20:23], v154 offset:35200
    s_mov_b64 exec, -1
    v_exp_f32 v134, v134
    v_exp_f32 v135, v135
    v_cvt_pk_bf16_f32 v28, v128, v129
    v_cvt_pk_bf16_f32 v29, v130, v131
    v_cvt_pk_bf16_f32 v30, v132, v133
    v_cvt_pk_bf16_f32 v31, v134, v135
    v_mfma_f32_32x32x4_2b_bf16 v[88:119], v[10:11], v[8:9], v[88:119]
    ds_read_b128 v[12:15], v152 offset:38400
    ds_read_b64 v[10:11], v153 offset:39424
    v_exp_f32 v136, v136
    v_exp_f32 v137, v137
    v_exp_f32 v138, v138
    v_exp_f32 v139, v139
    v_exp_f32 v140, v140
    v_exp_f32 v141, v141
    v_exp_f32 v142, v142
    v_exp_f32 v143, v143
    s_waitcnt lgkmcnt(2)
    v_mfma_f32_32x32x16_bf16 v[40:55], v[16:19], v[24:27], v[40:55]
    s_cmp_lt_u32 s24, 4
    s_cbranch_scc1 L_rl19
    s_lshr_b32 s51, s2, 3
    s_lshl_b32 s51, s51, 2
    s_add_u32 s51, s51, s25
    s_mul_i32 s51, s51, 3
    s_bfe_u32 s52, s2, 0x20001
    s_mul_i32 s52, s52, 384
    s_add_u32 s51, s51, s52
    s_cmp_lg_u32 s91, 0
    s_cbranch_scc1 L_attn_z2
    v_min_u32 v161, 2, v252
    v_lshlrev_b32 v161, 6, v161
    s_lshl_b32 s53, s51, 6
    s_add_u32 s53, s53, 0x1480000
    buffer_load_dword v162, v161, s[4:7], s53 offen sc1
L_attn_z2:
L_rl19:
    v_exp_f32 v144, v144
    v_exp_f32 v145, v145
    v_exp_f32 v146, v146
    v_exp_f32 v147, v147
    v_exp_f32 v148, v148
    v_exp_f32 v149, v149
    v_cvt_pk_bf16_f32 v32, v136, v137
    v_cvt_pk_bf16_f32 v33, v138, v139
    v_mfma_f32_32x32x16_bf16 v[40:55], v[20:23], v[28:31], v[40:55]
    v_exp_f32 v150, v150
    v_exp_f32 v151, v151
    v_cvt_pk_bf16_f32 v34, v140, v141
    v_cvt_pk_bf16_f32 v35, v142, v143
    v_cvt_pk_bf16_f32 v36, v144, v145
    v_cvt_pk_bf16_f32 v37, v146, v147
    v_cvt_pk_bf16_f32 v38, v148, v149
    v_cvt_pk_bf16_f32 v39, v150, v151
    s_waitcnt lgkmcnt(0)
    v_mfma_f32_32x32x16_bf16 v[120:135], v[12:15], v[0:3], v[72:87]
    v_exp_f32 v88, v88
    v_exp_f32 v89, v89
    v_exp_f32 v90, v90
    v_exp_f32 v91, v91
    v_exp_f32 v92, v92
    v_exp_f32 v93, v93
    v_mfma_f32_32x32x16_bf16 v[136:151], v[12:15], v[4:7], v[72:87]
    v_exp_f32 v94, v94
    v_exp_f32 v95, v95
    v_exp_f32 v96, v96
    v_exp_f32 v97, v97
    v_cvt_pk_bf16_f32 v24, v88, v89
    v_cvt_pk_bf16_f32 v25, v90, v91
    v_mfma_f32_32x32x16_bf16 v[56:71], v[16:19], v[32:35], v[56:71]
    v_exp_f32 v98, v98
    v_exp_f32 v99, v99
    v_exp_f32 v100, v100
    v_exp_f32 v101, v101
    v_cvt_pk_bf16_f32 v26, v92, v93
    v_cvt_pk_bf16_f32 v27, v94, v95
    v_mfma_f32_32x32x16_bf16 v[56:71], v[20:23], v[36:39], v[56:71]
    s_mov_b64 exec, s[40:41]
    ds_read_b128 v[16:19], v154 offset:37120
    ds_read_b128 v[20:23], v154 offset:37760
    s_mov_b64 exec, -1
    v_exp_f32 v102, v102
    v_exp_f32 v103, v103
    v_cvt_pk_bf16_f32 v28, v96, v97
    v_cvt_pk_bf16_f32 v29, v98, v99
    v_cvt_pk_bf16_f32 v30, v100, v101
    v_cvt_pk_bf16_f32 v31, v102, v103
    v_mfma_f32_32x32x4_2b_bf16 v[120:151], v[10:11], v[8:9], v[120:151]
    v_add_u32 v152, 40960, v152
    v_add_u32 v153, 40960, v153
    ds_read_b128 v[12:15], v152 offset:0
    ds_read_b64 v[10:11], v153 offset:1024
    v_exp_f32 v104, v104
    v_exp_f32 v105, v105
    v_exp_f32 v106, v106
    v_exp_f32 v107, v107
    v_exp_f32 v108, v108
    v_exp_f32 v109, v109
    v_exp_f32 v110, v110
    v_exp_f32 v111, v111
    s_waitcnt lgkmcnt(2)
    v_mfma_f32_32x32x16_bf16 v[40:55], v[16:19], v[24:27], v[40:55]
    s_cmp_eq_u32 s56, 0
    s_cbranch_scc1 L_rp20
    v_add_u32 v210, 81920, v213
    s_waitcnt vmcnt(0)
    ds_read_b64_tr_b16 v[176:177], v213 offset:0
    ds_read_b64_tr_b16 v[178:179], v213 offset:512
    ds_read_b64_tr_b16 v[180:181], v213 offset:32
    ds_read_b64_tr_b16 v[182:183], v213 offset:544
    ds_read_b64_tr_b16 v[184:185], v213 offset:64
    ds_read_b64_tr_b16 v[186:187], v213 offset:576
    ds_read_b64_tr_b16 v[188:189], v213 offset:96
    ds_read_b64_tr_b16 v[190:191], v213 offset:608
    ds_read_b64_tr_b16 v[192:193], v210 offset:0
    ds_read_b64_tr_b16 v[194:195], v210 offset:512
    ds_read_b64_tr_b16 v[196:197], v210 offset:32
    ds_read_b64_tr_b16 v[198:199], v210 offset:544
    ds_read_b64_tr_b16 v[200:201], v210 offset:64
    ds_read_b64_tr_b16 v[202:203], v210 offset:576
    ds_read_b64_tr_b16 v[204:205], v210 offset:96
    ds_read_b64_tr_b16 v[206:207], v210 offset:608
L_rp20:
    v_exp_f32 v112, v112
    v_exp_f32 v113, v113
    v_exp_f32 v114, v114
    v_exp_f32 v115, v115
    v_exp_f32 v116, v116
    v_exp_f32 v117, v117
    v_cvt_pk_bf16_f32 v32, v104, v105
    v_cvt_pk_bf16_f32 v33, v106, v107
    v_mfma_f32_32x32x16_bf16 v[40:55], v[20:23], v[28:31], v[40:55]
    v_exp_f32 v118, v118
    v_exp_f32 v119, v119
    v_cvt_pk_bf16_f32 v34, v108, v109
    v_cvt_pk_bf16_f32 v35, v110, v111
    v_cvt_pk_bf16_f32 v36, v112, v113
    v_cvt_pk_bf16_f32 v37, v114, v115
    v_cvt_pk_bf16_f32 v38, v116, v117
    v_cvt_pk_bf16_f32 v39, v118, v119
    s_waitcnt lgkmcnt(0)
    v_mfma_f32_32x32x16_bf16 v[88:103], v[12:15], v[0:3], v[72:87]
    v_exp_f32 v120, v120
    v_exp_f32 v121, v121
    v_exp_f32 v122, v122
    v_exp_f32 v123, v123
    v_exp_f32 v124, v124
    v_exp_f32 v125, v125
    v_mfma_f32_32x32x16_bf16 v[104:119], v[12:15], v[4:7], v[72:87]
    v_exp_f32 v126, v126
    v_exp_f32 v127, v127
    v_exp_f32 v128, v128
    v_exp_f32 v129, v129
    v_cvt_pk_bf16_f32 v24, v120, v121
    v_cvt_pk_bf16_f32 v25, v122, v123
    v_mfma_f32_32x32x16_bf16 v[56:71], v[16:19], v[32:35], v[56:71]
    v_exp_f32 v130, v130
    v_exp_f32 v131, v131
    v_exp_f32 v132, v132
    v_exp_f32 v133, v133
    v_cvt_pk_bf16_f32 v26, v124, v125
    v_cvt_pk_bf16_f32 v27, v126, v127
    v_mfma_f32_32x32x16_bf16 v[56:71], v[20:23], v[36:39], v[56:71]
    s_mov_b64 exec, s[40:41]
    ds_read_b128 v[16:19], v154 offset:39680
    ds_read_b128 v[20:23], v154 offset:40320
    s_mov_b64 exec, -1
    v_exp_f32 v134, v134
    v_exp_f32 v135, v135
    v_cvt_pk_bf16_f32 v28, v128, v129
    v_cvt_pk_bf16_f32 v29, v130, v131
    v_cvt_pk_bf16_f32 v30, v132, v133
    v_cvt_pk_bf16_f32 v31, v134, v135
    v_mfma_f32_32x32x4_2b_bf16 v[88:119], v[10:11], v[8:9], v[88:119]
    ds_read_b128 v[12:15], v152 offset:2560
    ds_read_b64 v[10:11], v153 offset:3584
    v_exp_f32 v136, v136
    v_exp_f32 v137, v137
    v_exp_f32 v138, v138
    v_exp_f32 v139, v139
    v_exp_f32 v140, v140
    v_exp_f32 v141, v141
    v_exp_f32 v142, v142
    v_exp_f32 v143, v143
    s_waitcnt lgkmcnt(2)
    v_mfma_f32_32x32x16_bf16 v[40:55], v[16:19], v[24:27], v[40:55]
    s_cmp_eq_u32 s56, 0
    s_cbranch_scc1 L_rp21
    s_lshl_b32 s30, s59, 12
    s_add_u32 s30, s30, 0xb00000
    s_add_u32 s54, s30, 196608
    buffer_store_dwordx4 v[176:179], v155, s[4:7], s30 offen offset:0 sc1
    buffer_store_dwordx4 v[180:183], v155, s[4:7], s30 offen offset:1024 sc1
    buffer_store_dwordx4 v[184:187], v155, s[4:7], s30 offen offset:2048 sc1
    buffer_store_dwordx4 v[188:191], v155, s[4:7], s30 offen offset:3072 sc1
    buffer_store_dwordx4 v[192:195], v155, s[4:7], s54 offen offset:0 sc1
    buffer_store_dwordx4 v[196:199], v155, s[4:7], s54 offen offset:1024 sc1
    buffer_store_dwordx4 v[200:203], v155, s[4:7], s54 offen offset:2048 sc1
    buffer_store_dwordx4 v[204:207], v155, s[4:7], s54 offen offset:3072 sc1
L_rp21:
    s_cmp_eq_u32 s66, 0
    s_cbranch_scc1 L_attn_x6
    s_add_u32 m0, s38, 69632
    s_add_u32 s54, s43, 69632
    buffer_load_dwordx4 v155, s[20:23], s54 offen offset:0 sc1 lds
    buffer_load_dwordx4 v155, s[20:23], s54 offen offset:1024 sc1 lds
    buffer_load_dwordx4 v155, s[20:23], s54 offen offset:2048 sc1 lds
    buffer_load_dwordx4 v155, s[20:23], s54 offen offset:3072 sc1 lds
    s_add_u32 m0, s38, 151552
    s_add_u32 s54, s43, 151552
    buffer_load_dwordx4 v155, s[20:23], s54 offen offset:0 sc1 lds
    buffer_load_dwordx4 v155, s[20:23], s54 offen offset:1024 sc1 lds
    buffer_load_dwordx4 v155, s[20:23], s54 offen offset:2048 sc1 lds
    buffer_load_dwordx4 v155, s[20:23], s54 offen offset:3072 sc1 lds
L_attn_x6:
    s_cmp_lt_u32 s24, 4
    s_cbranch_scc1 L_rl22
    s_cmp_lg_u32 s91, 0
    s_cbranch_scc1 L_attn_y2
    s_waitcnt vmcnt(0)
    v_cmp_ne_u32 vcc, s90, v162
    s_cbranch_vccz L_attn_y2
    s_mov_b32 s61, 0x40000
L_poll23:
    buffer_load_dword v250, v161, s[4:7], s53 offen sc1
    s_sub_u32 s61, s61, 1
    s_waitcnt vmcnt(0)
    s_cbranch_scc1 L_pollx24
    v_cmp_ne_u32 vcc, s90, v250
    s_cbranch_vccz L_pollx24
    s_mov_b64 exec, vcc
    s_sleep 1
    s_branch L_poll23
L_pollx24:
    s_mov_b64 exec, -1
L_attn_y2:
    s_lshl_b32 s51, s51, 12
    s_add_u32 s51, s51, 0x500000
    s_add_u32 s52, s51, 4096
    v_lshlrev_b32 v158, 7, v252
    buffer_load_dword v159, v158, s[4:7], s51 offen sc1
    buffer_load_dword v160, v158, s[4:7], s52 offen sc1
L_rl22:
    v_exp_f32 v144, v144
    v_exp_f32 v145, v145
    v_exp_f32 v146, v146
    v_exp_f32 v147, v147
    v_exp_f32 v148, v148
    v_exp_f32 v149, v149
    v_cvt_pk_bf16_f32 v32, v136, v137
    v_cvt_pk_bf16_f32 v33, v138, v139
    v_mfma_f32_32x32x16_bf16 v[40:55], v[20:23], v[28:31], v[40:55]
    v_exp_f32 v150, v150
    v_exp_f32 v151, v151
    v_cvt_pk_bf16_f32 v34, v140, v141
    v_cvt_pk_bf16_f32 v35, v142, v143
    v_cvt_pk_bf16_f32 v36, v144, v145
    v_cvt_pk_bf16_f32 v37, v146, v147
    v_cvt_pk_bf16_f32 v38, v148, v149
    v_cvt_pk_bf16_f32 v39, v150, v151
    s_waitcnt lgkmcnt(0)
    v_mfma_f32_32x32x16_bf16 v[120:135], v[12:15], v[0:3], v[72:87]
    v_exp_f32 v88, v88
    v_exp_f32 v89, v89
    v_exp_f32 v90, v90
    v_exp_f32 v91, v91
    v_exp_f32 v92, v92
    v_exp_f32 v93, v93
    v_mfma_f32_32x32x16_bf16 v[136:151], v[12:15], v[4:7], v[72:87]
    v_exp_f32 v94, v94
    v_exp_f32 v95, v95
    v_exp_f32 v96, v96
    v_exp_f32 v97, v97
    v_cvt_pk_bf16_f32 v24, v88, v89
    v_cvt_pk_bf16_f32 v25, v90, v91
    v_mfma_f32_32x32x16_bf16 v[56:71], v[16:19], v[32:35], v[56:71]
    v_exp_f32 v98, v98
    v_exp_f32 v99, v99
    v_exp_f32 v100, v100
    v_exp_f32 v101, v101
    v_cvt_pk_bf16_f32 v26, v92, v93
    v_cvt_pk_bf16_f32 v27, v94, v95
    v_mfma_f32_32x32x16_bf16 v[56:71], v[20:23], v[36:39], v[56:71]
    v_add_u32 v154, 40960, v154
    s_mov_b64 exec, s[40:41]
    ds_read_b128 v[16:19], v154 offset:1280
    ds_read_b128 v[20:23], v154 offset:1920
    s_mov_b64 exec, -1
    v_exp_f32 v102, v102
    v_exp_f32 v103, v103
    v_cvt_pk_bf16_f32 v28, v96, v97
    v_cvt_pk_bf16_f32 v29, v98, v99
    v_cvt_pk_bf16_f32 v30, v100, v101
    v_cvt_pk_bf16_f32 v31, v102, v103
    v_mfma_f32_32x32x4_2b_bf16 v[120:151], v[10:11], v[8:9], v[120:151]
    ds_read_b128 v[12:15], v152 offset:5120
    ds_read_b64 v[10:11], v153 offset:6144
    v_exp_f32 v104, v104
    v_exp_f32 v105, v105
    v_exp_f32 v106, v106
    v_exp_f32 v107, v107
    v_exp_f32 v108, v108
    v_exp_f32 v109, v109
    v_exp_f32 v110, v110
    v_exp_f32 v111, v111
    s_waitcnt lgkmcnt(2)
    v_mfma_f32_32x32x16_bf16 v[40:55], v[16:19], v[24:27], v[40:55]
    v_exp_f32 v112, v112
    v_exp_f32 v113, v113
    v_exp_f32 v114, v114
    v_exp_f32 v115, v115
    v_exp_f32 v116, v116
    v_exp_f32 v117, v117
    v_cvt_pk_bf16_f32 v32, v104, v105
    v_cvt_pk_bf16_f32 v33, v106, v107
    v_mfma_f32_32x32x16_bf16 v[40:55], v[20:23], v[28:31], v[40:55]
    v_exp_f32 v118, v118
    v_exp_f32 v119, v119
    v_cvt_pk_bf16_f32 v34, v108, v109
    v_cvt_pk_bf16_f32 v35, v110, v111
    v_cvt_pk_bf16_f32 v36, v112, v113
    v_cvt_pk_bf16_f32 v37, v114, v115
    v_cvt_pk_bf16_f32 v38, v116, v117
    v_cvt_pk_bf16_f32 v39, v118, v119
    s_waitcnt lgkmcnt(0)
    v_mfma_f32_32x32x16_bf16 v[88:103], v[12:15], v[0:3], v[72:87]
    v_exp_f32 v120, v120
    v_exp_f32 v121, v121
    v_exp_f32 v122, v122
    v_exp_f32 v123, v123
    v_exp_f32 v124, v124
    v_exp_f32 v125, v125
    v_mfma_f32_32x32x16_bf16 v[104:119], v[12:15], v[4:7], v[72:87]
    v_exp_f32 v126, v126
    v_exp_f32 v127, v127
    v_exp_f32 v128, v128
    v_exp_f32 v129, v129
    v_cvt_pk_bf16_f32 v24, v120, v121
    v_cvt_pk_bf16_f32 v25, v122, v123
    v_mfma_f32_32x32x16_bf16 v[56:71], v[16:19], v[32:35], v[56:71]
    v_exp_f32 v130, v130
    v_exp_f32 v131, v131
    v_exp_f32 v132, v132
    v_exp_f32 v133, v133
    v_cvt_pk_bf16_f32 v26, v124, v125
    v_cvt_pk_bf16_f32 v27, v126, v127
    v_mfma_f32_32x32x16_bf16 v[56:71], v[20:23], v[36:39], v[56:71]
    s_mov_b64 exec, s[40:41]
    ds_read_b128 v[16:19], v154 offset:3840
    ds_read_b128 v[20:23], v154 offset:4480
    s_mov_b64 exec, -1
    v_exp_f32 v134, v134
    v_exp_f32 v135, v135
    v_cvt_pk_bf16_f32 v28, v128, v129
    v_cvt_pk_bf16_f32 v29, v130, v131
    v_cvt_pk_bf16_f32 v30, v132, v133
    v_cvt_pk_bf16_f32 v31, v134, v135
    v_mfma_f32_32x32x4_2b_bf16 v[88:119], v[10:11], v[8:9], v[88:119]
    ds_read_b128 v[12:15], v152 offset:7680
    ds_read_b64 v[10:11], v153 offset:8704
    v_exp_f32 v136, v136
    v_exp_f32 v137, v137
    v_exp_f32 v138, v138
    v_exp_f32 v139, v139
    v_exp_f32 v140, v140
    v_exp_f32 v141, v141
    v_exp_f32 v142, v142
    v_exp_f32 v143, v143
    s_waitcnt lgkmcnt(2)
    v_mfma_f32_32x32x16_bf16 v[40:55], v[16:19], v[24:27], v[40:55]
    s_cmp_eq_u32 s56, 0
    s_cbranch_scc1 L_rp25
    s_waitcnt vmcnt(8)
    s_lshl_b32 s60, s59, 6
    s_add_u32 s60, s60, 0x1498000
    v_mov_b32 v214, s90
    v_mul_u32_u24 v215, 3072, v252
    s_mov_b64 exec, 3
    buffer_store_dword v214, v215, s[4:7], s60 offen sc1
    s_mov_b64 exec, -1
L_rp25:
    v_exp_f32 v144, v144
    v_exp_f32 v145, v145
    v_exp_f32 v146, v146
    v_exp_f32 v147, v147
    v_exp_f32 v148, v148
    v_exp_f32 v149, v149
    v_cvt_pk_bf16_f32 v32, v136, v137
    v_cvt_pk_bf16_f32 v33, v138, v139
    v_mfma_f32_32x32x16_bf16 v[40:55], v[20:23], v[28:31], v[40:55]
    v_exp_f32 v150, v150
    v_exp_f32 v151, v151
    v_cvt_pk_bf16_f32 v34, v140, v141
    v_cvt_pk_bf16_f32 v35, v142, v143
    v_cvt_pk_bf16_f32 v36, v144, v145
    v_cvt_pk_bf16_f32 v37, v146, v147
    v_cvt_pk_bf16_f32 v38, v148, v149
    v_cvt_pk_bf16_f32 v39, v150, v151
    s_waitcnt lgkmcnt(0)
    v_mfma_f32_32x32x16_bf16 v[120:135], v[12:15], v[0:3], v[72:87]
    v_exp_f32 v88, v88
    v_exp_f32 v89, v89
    v_exp_f32 v90, v90
    v_exp_f32 v91, v91
    v_exp_f32 v92, v92
    v_exp_f32 v93, v93
    v_mfma_f32_32x32x16_bf16 v[136:151], v[12:15], v[4:7], v[72:87]
    v_exp_f32 v94, v94
    v_exp_f32 v95, v95
    v_exp_f32 v96, v96
    v_exp_f32 v97, v97
    v_cvt_pk_bf16_f32 v24, v88, v89
    v_cvt_pk_bf16_f32 v25, v90, v91
    v_mfma_f32_32x32x16_bf16 v[56:71], v[16:19], v[32:35], v[56:71]
    v_exp_f32 v98, v98
    v_exp_f32 v99, v99
    v_exp_f32 v100, v100
    v_exp_f32 v101, v101
    v_cvt_pk_bf16_f32 v26, v92, v93
    v_cvt_pk_bf16_f32 v27, v94, v95
    v_mfma_f32_32x32x16_bf16 v[56:71], v[20:23], v[36:39], v[56:71]
    s_mov_b64 exec, s[40:41]
    ds_read_b128 v[16:19], v154 offset:6400
    ds_read_b128 v[20:23], v154 offset:7040
    s_mov_b64 exec, -1
    v_exp_f32 v102, v102
    v_exp_f32 v103, v103
    v_cvt_pk_bf16_f32 v28, v96, v97
    v_cvt_pk_bf16_f32 v29, v98, v99
    v_cvt_pk_bf16_f32 v30, v100, v101
    v_cvt_pk_bf16_f32 v31, v102, v103
    v_mfma_f32_32x32x4_2b_bf16 v[120:151], v[10:11], v[8:9], v[120:151]
    ds_read_b128 v[12:15], v152 offset:10240
    ds_read_b64 v[10:11], v153 offset:11264
    v_exp_f32 v104, v104
    v_exp_f32 v105, v105
    v_exp_f32 v106, v106
    v_exp_f32 v107, v107
    v_exp_f32 v108, v108
    v_exp_f32 v109, v109
    v_exp_f32 v110, v110
    v_exp_f32 v111, v111
    s_waitcnt lgkmcnt(2)
    v_mfma_f32_32x32x16_bf16 v[40:55], v[16:19], v[24:27], v[40:55]
    s_cmp_lt_u32 s24, 4
    s_cbranch_scc1 L_rl26
    s_bfe_u32 s52, s2, 0x20001
    s_lshl_b32 s52, s52, 3
    s_lshr_b32 s51, s2, 5
    s_add_u32 s52, s52, s51
    s_mul_i32 s52, s52, 48
    s_mul_i32 s51, s25, 12
    s_add_u32 s52, s52, s51
    s_add_u32 s52, s52, 6
    s_cmp_lg_u32 s91, 0
    s_cbranch_scc1 L_attn_z1
    v_min_u32 v161, 3, v252
    v_lshlrev_b32 v161, 6, v161
    s_lshl_b32 s53, s52, 6
    s_add_u32 s53, s53, 0x1498000
    buffer_load_dword v162, v161, s[4:7], s53 offen sc1
L_attn_z1:
    s_lshl_b32 s52, s52, 12
    s_add_u32 s52, s52, 0xb00000
L_rl26:
    v_exp_f32 v112, v112
    v_exp_f32 v113, v113
    v_exp_f32 v114, v114
    v_exp_f32 v115, v115
    v_exp_f32 v116, v116
    v_exp_f32 v117, v117
    v_cvt_pk_bf16_f32 v32, v104, v105
    v_cvt_pk_bf16_f32 v33, v106, v107
    v_mfma_f32_32x32x16_bf16 v[40:55], v[20:23], v[28:31], v[40:55]
    v_exp_f32 v118, v118
    v_exp_f32 v119, v119
    v_cvt_pk_bf16_f32 v34, v108, v109
    v_cvt_pk_bf16_f32 v35, v110, v111
    v_cvt_pk_bf16_f32 v36, v112, v113
    v_cvt_pk_bf16_f32 v37, v114, v115
    v_cvt_pk_bf16_f32 v38, v116, v117
    v_cvt_pk_bf16_f32 v39, v118, v119
    s_waitcnt lgkmcnt(0)
    v_mfma_f32_32x32x16_bf16 v[88:103], v[12:15], v[0:3], v[72:87]
    v_exp_f32 v120, v120
    v_exp_f32 v121, v121
    v_exp_f32 v122, v122
    v_exp_f32 v123, v123
    v_exp_f32 v124, v124
    v_exp_f32 v125, v125
    v_mfma_f32_32x32x16_bf16 v[104:119], v[12:15], v[4:7], v[72:87]
    v_exp_f32 v126, v126
    v_exp_f32 v127, v127
    v_exp_f32 v128, v128
    v_exp_f32 v129, v129
    v_cvt_pk_bf16_f32 v24, v120, v121
    v_cvt_pk_bf16_f32 v25, v122, v123
    v_mfma_f32_32x32x16_bf16 v[56:71], v[16:19], v[32:35], v[56:71]
    v_exp_f32 v130, v130
    v_exp_f32 v131, v131
    v_exp_f32 v132, v132
    v_exp_f32 v133, v133
    v_cvt_pk_bf16_f32 v26, v124, v125
    v_cvt_pk_bf16_f32 v27, v126, v127
    v_mfma_f32_32x32x16_bf16 v[56:71], v[20:23], v[36:39], v[56:71]
    s_mov_b64 exec, s[40:41]
    ds_read_b128 v[16:19], v154 offset:8960
    ds_read_b128 v[20:23], v154 offset:9600
    s_mov_b64 exec, -1
    v_exp_f32 v134, v134
    v_exp_f32 v135, v135
    v_cvt_pk_bf16_f32 v28, v128, v129
    v_cvt_pk_bf16_f32 v29, v130, v131
    v_cvt_pk_bf16_f32 v30, v132, v133
    v_cvt_pk_bf16_f32 v31, v134, v135
    v_mfma_f32_32x32x4_2b_bf16 v[88:119], v[10:11], v[8:9], v[88:119]
    ds_read_b128 v[12:15], v152 offset:12800
    ds_read_b64 v[10:11], v153 offset:13824
    v_exp_f32 v136, v136
    v_exp_f32 v137, v137
    v_exp_f32 v138, v138
    v_exp_f32 v139, v139
    v_exp_f32 v140, v140
    v_exp_f32 v141, v141
    v_exp_f32 v142, v142
    v_exp_f32 v143, v143
    s_waitcnt lgkmcnt(2)
    v_mfma_f32_32x32x16_bf16 v[40:55], v[16:19], v[24:27], v[40:55]
    s_cmp_ge_u32 s24, 4
    s_cbranch_scc1 L_rl27
    s_lshr_b32 s30, s2, 3
    s_min_u32 s30, s30, 29
    s_mul_i32 s30, s30, 52
    s_lshr_b32 s30, s30, 8
    s_bfe_u32 s52, s2, 0x20001
    s_mul_i32 s52, s52, 6
    s_add_u32 s52, s52, s30
    s_lshl_b32 s52, s52, 6
    s_lshl_b32 s30, s24, 4
    s_add_u32 s52, s52, s30
    s_add_u32 s52, s52, 12
    s_cmp_lg_u32 s91, 0
    s_cbranch_scc1 L_attn_z4
    v_min_u32 v161, 3, v252
    v_lshlrev_b32 v161, 6, v161
    s_lshl_b32 s53, s52, 6
    s_add_u32 s53, s53, 0x1480000
    buffer_load_dword v162, v161, s[4:7], s53 offen sc1
L_attn_z4:
    s_lshl_b32 s52, s52, 12
    s_add_u32 s52, s52, 0x500000
    s_lshl_b32 s30, s24, 9
    s_and_b32 s30, s30, 0x400
    v_add_u32 v170, s30, v155
    v_xor_b32 v171, 0x400, v170
L_rl27:
    v_exp_f32 v144, v144
    v_exp_f32 v145, v145
    v_exp_f32 v146, v146
    v_exp_f32 v147, v147
    v_exp_f32 v148, v148
    v_exp_f32 v149, v149
    v_cvt_pk_bf16_f32 v32, v136, v137
    v_cvt_pk_bf16_f32 v33, v138, v139
    v_mfma_f32_32x32x16_bf16 v[40:55], v[20:23], v[28:31], v[40:55]
    v_exp_f32 v150, v150
    v_exp_f32 v151, v151
    v_cvt_pk_bf16_f32 v34, v140, v141
    v_cvt_pk_bf16_f32 v35, v142, v143
    v_cvt_pk_bf16_f32 v36, v144, v145
    v_cvt_pk_bf16_f32 v37, v146, v147
    v_cvt_pk_bf16_f32 v38, v148, v149
    v_cvt_pk_bf16_f32 v39, v150, v151
    s_waitcnt lgkmcnt(0)
    v_mfma_f32_32x32x16_bf16 v[120:135], v[12:15], v[0:3], v[72:87]
    v_exp_f32 v88, v88
    v_exp_f32 v89, v89
    v_exp_f32 v90, v90
    v_exp_f32 v91, v91
    v_exp_f32 v92, v92
    v_exp_f32 v93, v93
    v_mfma_f32_32x32x16_bf16 v[136:151], v[12:15], v[4:7], v[72:87]
    v_exp_f32 v94, v94
    v_exp_f32 v95, v95
    v_exp_f32 v96, v96
    v_exp_f32 v97, v97
    v_cvt_pk_bf16_f32 v24, v88, v89
    v_cvt_pk_bf16_f32 v25, v90, v91
    v_mfma_f32_32x32x16_bf16 v[56:71], v[16:19], v[32:35], v[56:71]
    v_exp_f32 v98, v98
    v_exp_f32 v99, v99
    v_exp_f32 v100, v100
    v_exp_f32 v101, v101
    v_cvt_pk_bf16_f32 v26, v92, v93
    v_cvt_pk_bf16_f32 v27, v94, v95
    v_mfma_f32_32x32x16_bf16 v[56:71], v[20:23], v[36:39], v[56:71]
    s_mov_b64 exec, s[40:41]
    ds_read_b128 v[16:19], v154 offset:11520
    ds_read_b128 v[20:23], v154 offset:12160
    s_mov_b64 exec, -1
    v_exp_f32 v102, v102
    v_exp_f32 v103, v103
    v_cvt_pk_bf16_f32 v28, v96, v97
    v_cvt_pk_bf16_f32 v29, v98, v99
    v_cvt_pk_bf16_f32 v30, v100, v101
    v_cvt_pk_bf16_f32 v31, v102, v103
    v_mfma_f32_32x32x4_2b_bf16 v[120:151], v[10:11], v[8:9], v[120:151]
    ds_read_b128 v[12:15], v152 offset:15360
    ds_read_b64 v[10:11], v153 offset:16384
    v_exp_f32 v104, v104
    v_exp_f32 v105, v105
    v_exp_f32 v106, v106
    v_exp_f32 v107, v107
    v_exp_f32 v108, v108
    v_exp_f32 v109, v109
    v_exp_f32 v110, v110
    v_exp_f32 v111, v111
    s_waitcnt lgkmcnt(2)
    v_mfma_f32_32x32x16_bf16 v[40:55], v[16:19], v[24:27], v[40:55]
    s_cmp_lt_u32 s24, 4
    s_cbranch_scc1 L_rl28
    s_cmp_lg_u32 s91, 0
    s_cbranch_scc1 L_attn_y1
    s_waitcnt vmcnt(0)
    v_cmp_ne_u32 vcc, s90, v162
    s_cbranch_vccz L_attn_y1
    s_mov_b32 s61, 0x40000
L_poll29:
    buffer_load_dword v250, v161, s[4:7], s53 offen sc1
    s_sub_u32 s61, s61, 1
    s_waitcnt vmcnt(0)
    s_cbranch_scc1 L_pollx30
    v_cmp_ne_u32 vcc, s90, v250
    s_cbranch_vccz L_pollx30
    s_mov_b64 exec, vcc
    s_sleep 1
    s_branch L_poll29
L_pollx30:
    s_mov_b64 exec, -1
L_attn_y1:
    buffer_load_dwordx4 v[176:179], v155, s[4:7], s52 offen offset:0 sc1
    buffer_load_dwordx4 v[180:183], v155, s[4:7], s52 offen offset:1024 sc1
    buffer_load_dwordx4 v[184:187], v155, s[4:7], s52 offen offset:2048 sc1
    buffer_load_dwordx4 v[188:191], v155, s[4:7], s52 offen offset:3072 sc1
    s_add_u32 s52, s52, 4096
L_rl28:
    v_exp_f32 v112, v112
    v_exp_f32 v113, v113
    v_exp_f32 v114, v114
    v_exp_f32 v115, v115
    v_exp_f32 v116, v116
    v_exp_f32 v117, v117
    v_cvt_pk_bf16_f32 v32, v104, v105
    v_cvt_pk_bf16_f32 v33, v106, v107
    v_mfma_f32_32x32x16_bf16 v[40:55], v[20:23], v[28:31], v[40:55]
    v_exp_f32 v118, v118
    v_exp_f32 v119, v119
    v_cvt_pk_bf16_f32 v34, v108, v109
    v_cvt_pk_bf16_f32 v35, v110, v111
    v_cvt_pk_bf16_f32 v36, v112, v113
    v_cvt_pk_bf16_f32 v37, v114, v115
    v_cvt_pk_bf16_f32 v38, v116, v117
    v_cvt_pk_bf16_f32 v39, v118, v119
    s_cmp_ge_u32 s24, 4
    s_cbranch_scc1 L_pr31
    s_setprio 0
L_pr31:
    s_waitcnt lgkmcnt(0)
    v_mfma_f32_32x32x16_bf16 v[88:103], v[12:15], v[0:3], v[72:87]
    v_exp_f32 v120, v120
    v_exp_f32 v121, v121
    v_exp_f32 v122, v122
    v_exp_f32 v123, v123
    v_exp_f32 v124, v124
    v_exp_f32 v125, v125
    v_mfma_f32_32x32x16_bf16 v[104:119], v[12:15], v[4:7], v[72:87]
    v_exp_f32 v126, v126
    v_exp_f32 v127, v127
    v_exp_f32 v128, v128
    v_exp_f32 v129, v129
    v_cvt_pk_bf16_f32 v24, v120, v121
    v_cvt_pk_bf16_f32 v25, v122, v123
    v_mfma_f32_32x32x16_bf16 v[56:71], v[16:19], v[32:35], v[56:71]
    v_exp_f32 v130, v130
    v_exp_f32 v131, v131
    v_exp_f32 v132, v132
    v_exp_f32 v133, v133
    v_cvt_pk_bf16_f32 v26, v124, v125
    v_cvt_pk_bf16_f32 v27, v126, v127
    v_mfma_f32_32x32x16_bf16 v[56:71], v[20:23], v[36:39], v[56:71]
    s_mov_b64 exec, s[40:41]
    ds_read_b128 v[16:19], v154 offset:14080
    ds_read_b128 v[20:23], v154 offset:14720
    s_mov_b64 exec, -1
    v_exp_f32 v134, v134
    v_exp_f32 v135, v135
    v_cvt_pk_bf16_f32 v28, v128, v129
    v_cvt_pk_bf16_f32 v29, v130, v131
    v_cvt_pk_bf16_f32 v30, v132, v133
    v_cvt_pk_bf16_f32 v31, v134, v135
    v_mfma_f32_32x32x4_2b_bf16 v[88:119], v[10:11], v[8:9], v[88:119]
    ds_read_b128 v[12:15], v152 offset:17920
    ds_read_b64 v[10:11], v153 offset:18944
    v_exp_f32 v136, v136
    v_exp_f32 v137, v137
    v_exp_f32 v138, v138
    v_exp_f32 v139, v139
    v_exp_f32 v140, v140
    v_exp_f32 v141, v141
    v_exp_f32 v142, v142
    v_exp_f32 v143, v143
    s_waitcnt lgkmcnt(2)
    v_mfma_f32_32x32x16_bf16 v[40:55], v[16:19], v[24:27], v[40:55]
    s_cmp_lt_u32 s24, 4
    s_cbranch_scc1 L_rl32
    buffer_load_dwordx4 v[192:195], v155, s[4:7], s52 offen offset:0 sc1
    buffer_load_dwordx4 v[196:199], v155, s[4:7], s52 offen offset:1024 sc1
    buffer_load_dwordx4 v[200:203], v155, s[4:7], s52 offen offset:2048 sc1
    buffer_load_dwordx4 v[204:207], v155, s[4:7], s52 offen offset:3072 sc1
    s_add_u32 s52, s52, 4096
L_rl32:
    s_cmp_ge_u32 s24, 4
    s_cbranch_scc1 L_rl33
    s_cmp_lg_u32 s91, 0
    s_cbranch_scc1 L_attn_y4
    s_waitcnt vmcnt(0)
    v_cmp_ne_u32 vcc, s90, v162
    s_cbranch_vccz L_attn_y4
    s_mov_b32 s61, 0x40000
L_poll34:
    buffer_load_dword v250, v161, s[4:7], s53 offen sc1
    s_sub_u32 s61, s61, 1
    s_waitcnt vmcnt(0)
    s_cbranch_scc1 L_pollx35
    v_cmp_ne_u32 vcc, s90, v250
    s_cbranch_vccz L_pollx35
    s_mov_b64 exec, vcc
    s_sleep 1
    s_branch L_poll34
L_pollx35:
    s_mov_b64 exec, -1
L_attn_y4:
    buffer_load_dwordx4 v[176:179], v170, s[4:7], s52 offen offset:0 sc1
    buffer_load_dwordx4 v[180:183], v171, s[4:7], s52 offen offset:0 sc1
    buffer_load_dwordx4 v[184:187], v170, s[4:7], s52 offen offset:2048 sc1
    buffer_load_dwordx4 v[188:191], v171, s[4:7], s52 offen offset:2048 sc1
    s_add_u32 s52, s52, 4096
L_rl33:
    v_exp_f32 v144, v144
    v_exp_f32 v145, v145
    v_exp_f32 v146, v146
    v_exp_f32 v147, v147
    v_exp_f32 v148, v148
    v_exp_f32 v149, v149
    v_cvt_pk_bf16_f32 v32, v136, v137
    v_cvt_pk_bf16_f32 v33, v138, v139
    v_mfma_f32_32x32x16_bf16 v[40:55], v[20:23], v[28:31], v[40:55]
    v_exp_f32 v150, v150
    v_exp_f32 v151, v151
    v_cvt_pk_bf16_f32 v34, v140, v141
    v_cvt_pk_bf16_f32 v35, v142, v143
    v_cvt_pk_bf16_f32 v36, v144, v145
    v_cvt_pk_bf16_f32 v37, v146, v147
    v_cvt_pk_bf16_f32 v38, v148, v149
    v_cvt_pk_bf16_f32 v39, v150, v151
    s_waitcnt lgkmcnt(0)
    v_mfma_f32_32x32x16_bf16 v[120:135], v[12:15], v[0:3], v[72:87]
    v_exp_f32 v88, v88
    v_exp_f32 v89, v89
    v_exp_f32 v90, v90
    v_exp_f32 v91, v91
    v_exp_f32 v92, v92
    v_exp_f32 v93, v93
    v_mfma_f32_32x32x16_bf16 v[136:151], v[12:15], v[4:7], v[72:87]
    v_exp_f32 v94, v94
    v_exp_f32 v95, v95
    v_exp_f32 v96, v96
    v_exp_f32 v97, v97
    v_cvt_pk_bf16_f32 v24, v88, v89
    v_cvt_pk_bf16_f32 v25, v90, v91
    v_mfma_f32_32x32x16_bf16 v[56:71], v[16:19], v[32:35], v[56:71]
    v_exp_f32 v98, v98
    v_exp_f32 v99, v99
    v_exp_f32 v100, v100
    v_exp_f32 v101, v101
    v_cvt_pk_bf16_f32 v26, v92, v93
    v_cvt_pk_bf16_f32 v27, v94, v95
    v_mfma_f32_32x32x16_bf16 v[56:71], v[20:23], v[36:39], v[56:71]
    s_mov_b64 exec, s[40:41]
    ds_read_b128 v[16:19], v154 offset:16640
    ds_read_b128 v[20:23], v154 offset:17280
    s_mov_b64 exec, -1
    v_exp_f32 v102, v102
    v_exp_f32 v103, v103
    v_cvt_pk_bf16_f32 v28, v96, v97
    v_cvt_pk_bf16_f32 v29, v98, v99
    v_cvt_pk_bf16_f32 v30, v100, v101
    v_cvt_pk_bf16_f32 v31, v102, v103
    v_mfma_f32_32x32x4_2b_bf16 v[120:151], v[10:11], v[8:9], v[120:151]
    ds_read_b128 v[12:15], v152 offset:20480
    ds_read_b64 v[10:11], v153 offset:21504
    v_exp_f32 v104, v104
    v_exp_f32 v105, v105
    v_exp_f32 v106, v106
    v_exp_f32 v107, v107
    v_exp_f32 v108, v108
    v_exp_f32 v109, v109
    v_exp_f32 v110, v110
    v_exp_f32 v111, v111
    s_waitcnt lgkmcnt(2)
    v_mfma_f32_32x32x16_bf16 v[40:55], v[16:19], v[24:27], v[40:55]
    s_cmp_lt_u32 s24, 4
    s_cbranch_scc1 L_rl36
    buffer_load_dwordx4 v[208:211], v155, s[4:7], s52 offen offset:0 sc1
    buffer_load_dwordx4 v[212:215], v155, s[4:7], s52 offen offset:1024 sc1
    buffer_load_dwordx4 v[216:219], v155, s[4:7], s52 offen offset:2048 sc1
    buffer_load_dwordx4 v[220:223], v155, s[4:7], s52 offen offset:3072 sc1
    s_add_u32 s52, s52, 4096
L_rl36:
    s_cmp_ge_u32 s24, 4
    s_cbranch_scc1 L_rl37
    buffer_load_dwordx4 v[192:195], v170, s[4:7], s52 offen offset:0 sc1
    buffer_load_dwordx4 v[196:199], v171, s[4:7], s52 offen offset:0 sc1
    buffer_load_dwordx4 v[200:203], v170, s[4:7], s52 offen offset:2048 sc1
    buffer_load_dwordx4 v[204:207], v171, s[4:7], s52 offen offset:2048 sc1
    s_add_u32 s52, s52, 4096
L_rl37:
    v_exp_f32 v112, v112
    v_exp_f32 v113, v113
    v_exp_f32 v114, v114
    v_exp_f32 v115, v115
    v_exp_f32 v116, v116
    v_exp_f32 v117, v117
    v_cvt_pk_bf16_f32 v32, v104, v105
    v_cvt_pk_bf16_f32 v33, v106, v107
    v_mfma_f32_32x32x16_bf16 v[40:55], v[20:23], v[28:31], v[40:55]
    v_exp_f32 v118, v118
    v_exp_f32 v119, v119
    v_cvt_pk_bf16_f32 v34, v108, v109
    v_cvt_pk_bf16_f32 v35, v110, v111
    v_cvt_pk_bf16_f32 v36, v112, v113
    v_cvt_pk_bf16_f32 v37, v114, v115
    v_cvt_pk_bf16_f32 v38, v116, v117
    v_cvt_pk_bf16_f32 v39, v118, v119
    s_waitcnt lgkmcnt(0)
    v_mfma_f32_32x32x16_bf16 v[88:103], v[12:15], v[0:3], v[72:87]
    v_exp_f32 v120, v120
    v_exp_f32 v121, v121
    v_exp_f32 v122, v122
    v_exp_f32 v123, v123
    v_exp_f32 v124, v124
    v_exp_f32 v125, v125
    v_mfma_f32_32x32x16_bf16 v[104:119], v[12:15], v[4:7], v[72:87]
    v_exp_f32 v126, v126
    v_exp_f32 v127, v127
    v_exp_f32 v128, v128
    v_exp_f32 v129, v129
    v_cvt_pk_bf16_f32 v24, v120, v121
    v_cvt_pk_bf16_f32 v25, v122, v123
    v_mfma_f32_32x32x16_bf16 v[56:71], v[16:19], v[32:35], v[56:71]
    v_exp_f32 v130, v130
    v_exp_f32 v131, v131
    v_exp_f32 v132, v132
    v_exp_f32 v133, v133
    v_cvt_pk_bf16_f32 v26, v124, v125
    v_cvt_pk_bf16_f32 v27, v126, v127
    v_mfma_f32_32x32x16_bf16 v[56:71], v[20:23], v[36:39], v[56:71]
    s_mov_b64 exec, s[40:41]
    ds_read_b128 v[16:19], v154 offset:19200
    ds_read_b128 v[20:23], v154 offset:19840
    s_mov_b64 exec, -1
    v_exp_f32 v134, v134
    v_exp_f32 v135, v135
    v_cvt_pk_bf16_f32 v28, v128, v129
    v_cvt_pk_bf16_f32 v29, v130, v131
    v_cvt_pk_bf16_f32 v30, v132, v133
    v_cvt_pk_bf16_f32 v31, v134, v135
    v_mfma_f32_32x32x4_2b_bf16 v[88:119], v[10:11], v[8:9], v[88:119]
    ds_read_b128 v[12:15], v152 offset:23040
    ds_read_b64 v[10:11], v153 offset:24064
    v_exp_f32 v136, v136
    v_exp_f32 v137, v137
    v_exp_f32 v138, v138
    v_exp_f32 v139, v139
    v_exp_f32 v140, v140
    v_exp_f32 v141, v141
    v_exp_f32 v142, v142
    v_exp_f32 v143, v143
    s_waitcnt lgkmcnt(2)
    v_mfma_f32_32x32x16_bf16 v[40:55], v[16:19], v[24:27], v[40:55]
    s_cmp_lt_u32 s24, 4
    s_cbranch_scc1 L_rl38
    buffer_load_dwordx4 v[224:227], v155, s[4:7], s52 offen offset:0 sc1
    buffer_load_dwordx4 v[228:231], v155, s[4:7], s52 offen offset:1024 sc1
    buffer_load_dwordx4 v[232:235], v155, s[4:7], s52 offen offset:2048 sc1
    buffer_load_dwordx4 v[236:239], v155, s[4:7], s52 offen offset:3072 sc1
    s_add_u32 s52, s52, 4096
L_rl38:
    s_cmp_ge_u32 s24, 4
    s_cbranch_scc1 L_rl39
    buffer_load_dwordx4 v[208:211], v170, s[4:7], s52 offen offset:0 sc1
    buffer_load_dwordx4 v[212:215], v171, s[4:7], s52 offen offset:0 sc1
    buffer_load_dwordx4 v[216:219], v170, s[4:7], s52 offen offset:2048 sc1
    buffer_load_dwordx4 v[220:223], v171, s[4:7], s52 offen offset:2048 sc1
    s_add_u32 s52, s52, 4096
L_rl39:
    v_exp_f32 v144, v144
    v_exp_f32 v145, v145
    v_exp_f32 v146, v146
    v_exp_f32 v147, v147
    v_exp_f32 v148, v148
    v_exp_f32 v149, v149
    v_cvt_pk_bf16_f32 v32, v136, v137
    v_cvt_pk_bf16_f32 v33, v138, v139
    v_mfma_f32_32x32x16_bf16 v[40:55], v[20:23], v[28:31], v[40:55]
    v_exp_f32 v150, v150
    v_exp_f32 v151, v151
    v_cvt_pk_bf16_f32 v34, v140, v141
    v_cvt_pk_bf16_f32 v35, v142, v143
    v_cvt_pk_bf16_f32 v36, v144, v145
    v_cvt_pk_bf16_f32 v37, v146, v147
    v_cvt_pk_bf16_f32 v38, v148, v149
    v_cvt_pk_bf16_f32 v39, v150, v151
    s_waitcnt lgkmcnt(0)
    v_mfma_f32_32x32x16_bf16 v[120:135], v[12:15], v[0:3], v[72:87]
    v_exp_f32 v88, v88
    v_exp_f32 v89, v89
    v_exp_f32 v90, v90
    v_exp_f32 v91, v91
    v_exp_f32 v92, v92
    v_exp_f32 v93, v93
    v_mfma_f32_32x32x16_bf16 v[136:151], v[12:15], v[4:7], v[72:87]
    v_exp_f32 v94, v94
    v_exp_f32 v95, v95
    v_exp_f32 v96, v96
    v_exp_f32 v97, v97
    v_cvt_pk_bf16_f32 v24, v88, v89
    v_cvt_pk_bf16_f32 v25, v90, v91
    v_mfma_f32_32x32x16_bf16 v[56:71], v[16:19], v[32:35], v[56:71]
    v_exp_f32 v98, v98
    v_exp_f32 v99, v99
    v_exp_f32 v100, v100
    v_exp_f32 v101, v101
    v_cvt_pk_bf16_f32 v26, v92, v93
    v_cvt_pk_bf16_f32 v27, v94, v95
    v_mfma_f32_32x32x16_bf16 v[56:71], v[20:23], v[36:39], v[56:71]
    s_mov_b64 exec, s[40:41]
    ds_read_b128 v[16:19], v154 offset:21760
    ds_read_b128 v[20:23], v154 offset:22400
    s_mov_b64 exec, -1
    v_exp_f32 v102, v102
    v_exp_f32 v103, v103
    v_cvt_pk_bf16_f32 v28, v96, v97
    v_cvt_pk_bf16_f32 v29, v98, v99
    v_cvt_pk_bf16_f32 v30, v100, v101
    v_cvt_pk_bf16_f32 v31, v102, v103
    v_mfma_f32_32x32x4_2b_bf16 v[120:151], v[10:11], v[8:9], v[120:151]
    ds_read_b128 v[12:15], v152 offset:25600
    ds_read_b64 v[10:11], v153 offset:26624
    v_exp_f32 v104, v104
    v_exp_f32 v105, v105
    v_exp_f32 v106, v106
    v_exp_f32 v107, v107
    v_exp_f32 v108, v108
    v_exp_f32 v109, v109
    v_exp_f32 v110, v110
    v_exp_f32 v111, v111
    s_waitcnt lgkmcnt(2)
    v_mfma_f32_32x32x16_bf16 v[40:55], v[16:19], v[24:27], v[40:55]
    s_cmp_ge_u32 s24, 4
    s_cbranch_scc1 L_rl40
    buffer_load_dwordx4 v[224:227], v170, s[4:7], s52 offen offset:0 sc1
    buffer_load_dwordx4 v[228:231], v171, s[4:7], s52 offen offset:0 sc1
    buffer_load_dwordx4 v[232:235], v170, s[4:7], s52 offen offset:2048 sc1
    buffer_load_dwordx4 v[236:239], v171, s[4:7], s52 offen offset:2048 sc1
    s_add_u32 s52, s52, 4096
L_rl40:
    v_exp_f32 v112, v112
    v_exp_f32 v113, v113
    v_exp_f32 v114, v114
    v_exp_f32 v115, v115
    v_exp_f32 v116, v116
    v_exp_f32 v117, v117
    v_cvt_pk_bf16_f32 v32, v104, v105
    v_cvt_pk_bf16_f32 v33, v106, v107
    v_mfma_f32_32x32x16_bf16 v[40:55], v[20:23], v[28:31], v[40:55]
    v_exp_f32 v118, v118
    v_exp_f32 v119, v119
    v_cvt_pk_bf16_f32 v34, v108, v109
    v_cvt_pk_bf16_f32 v35, v110, v111
    v_cvt_pk_bf16_f32 v36, v112, v113
    v_cvt_pk_bf16_f32 v37, v114, v115
    v_cvt_pk_bf16_f32 v38, v116, v117
    v_cvt_pk_bf16_f32 v39, v118, v119
    s_waitcnt lgkmcnt(0)
    v_mfma_f32_32x32x16_bf16 v[88:103], v[12:15], v[0:3], v[72:87]
    v_exp_f32 v120, v120
    v_exp_f32 v121, v121
    v_exp_f32 v122, v122
    v_exp_f32 v123, v123
    v_exp_f32 v124, v124
    v_exp_f32 v125, v125
    v_mfma_f32_32x32x16_bf16 v[104:119], v[12:15], v[4:7], v[72:87]
    v_exp_f32 v126, v126
    v_exp_f32 v127, v127
    v_exp_f32 v128, v128
    v_exp_f32 v129, v129
    v_cvt_pk_bf16_f32 v24, v120, v121
    v_cvt_pk_bf16_f32 v25, v122, v123
    v_mfma_f32_32x32x16_bf16 v[56:71], v[16:19], v[32:35], v[56:71]
    v_exp_f32 v130, v130
    v_exp_f32 v131, v131
    v_exp_f32 v132, v132
    v_exp_f32 v133, v133
    v_cvt_pk_bf16_f32 v26, v124, v125
    v_cvt_pk_bf16_f32 v27, v126, v127
    v_mfma_f32_32x32x16_bf16 v[56:71], v[20:23], v[36:39], v[56:71]
    s_mov_b64 exec, s[40:41]
    ds_read_b128 v[16:19], v154 offset:24320
    ds_read_b128 v[20:23], v154 offset:24960
    s_mov_b64 exec, -1
    v_exp_f32 v134, v134
    v_exp_f32 v135, v135
    v_cvt_pk_bf16_f32 v28, v128, v129
    v_cvt_pk_bf16_f32 v29, v130, v131
    v_cvt_pk_bf16_f32 v30, v132, v133
    v_cvt_pk_bf16_f32 v31, v134, v135
    v_mfma_f32_32x32x4_2b_bf16 v[88:119], v[10:11], v[8:9], v[88:119]
    s_waitcnt vmcnt(16) lgkmcnt(0)
    s_barrier
    ds_read_b128 v[12:15], v152 offset:28160
    ds_read_b64 v[10:11], v153 offset:29184
    v_exp_f32 v136, v136
    v_exp_f32 v137, v137
    v_exp_f32 v138, v138
    v_exp_f32 v139, v139
    v_exp_f32 v140, v140
    v_exp_f32 v141, v141
    v_exp_f32 v142, v142
    v_exp_f32 v143, v143
    s_waitcnt lgkmcnt(2)
    v_mfma_f32_32x32x16_bf16 v[40:55], v[16:19], v[24:27], v[40:55]
    s_and_b32 s48, s2, 1
    s_lshl_b32 s48, s48, 2
    s_bfe_u32 s49, s2, 0x20003
    s_add_u32 s48, s48, s49
    s_mul_i32 s48, s48, 102400
    s_mul_i32 s49, s26, 51200
    s_add_u32 s48, s48, s49
    s_add_u32 s48, s48, 0x80000
    s_and_b32 s50, s25, 1
    s_lshl_b32 s50, s50, 10
    s_add_u32 s50, s50, 49152
    s_add_u32 s51, s48, s50
    s_add_u32 s50, s50, s37
    s_mul_i32 s49, s25, 12288
    s_add_u32 s48, s48, s49
    s_add_u32 s49, s49, s37
    v_exp_f32 v144, v144
    v_exp_f32 v145, v145
    v_exp_f32 v146, v146
    v_exp_f32 v147, v147
    v_exp_f32 v148, v148
    v_exp_f32 v149, v149
    v_cvt_pk_bf16_f32 v32, v136, v137
    v_cvt_pk_bf16_f32 v33, v138, v139
    v_mfma_f32_32x32x16_bf16 v[40:55], v[20:23], v[28:31], v[40:55]
    v_exp_f32 v150, v150
    v_exp_f32 v151, v151
    v_cvt_pk_bf16_f32 v34, v140, v141
    v_cvt_pk_bf16_f32 v35, v142, v143
    v_cvt_pk_bf16_f32 v36, v144, v145
    v_cvt_pk_bf16_f32 v37, v146, v147
    v_cvt_pk_bf16_f32 v38, v148, v149
    v_cvt_pk_bf16_f32 v39, v150, v151
    s_cmp_ge_u32 s24, 4
    s_cbranch_scc1 L_pr41
    s_setprio 2
L_pr41:
    s_waitcnt lgkmcnt(0)
    v_mfma_f32_32x32x16_bf16 v[120:135], v[12:15], v[0:3], v[72:87]
    v_exp_f32 v88, v88
    v_exp_f32 v89, v89
    v_exp_f32 v90, v90
    v_exp_f32 v91, v91
    v_exp_f32 v92, v92
    v_exp_f32 v93, v93
    v_mfma_f32_32x32x16_bf16 v[136:151], v[12:15], v[4:7], v[72:87]
    v_exp_f32 v94, v94
    v_exp_f32 v95, v95
    v_exp_f32 v96, v96
    v_exp_f32 v97, v97
    v_cvt_pk_bf16_f32 v24, v88, v89
    v_cvt_pk_bf16_f32 v25, v90, v91
    v_mfma_f32_32x32x16_bf16 v[56:71], v[16:19], v[32:35], v[56:71]
    v_exp_f32 v98, v98
    v_exp_f32 v99, v99
    v_exp_f32 v100, v100
    v_exp_f32 v101, v101
    v_cvt_pk_bf16_f32 v26, v92, v93
    v_cvt_pk_bf16_f32 v27, v94, v95
    v_mfma_f32_32x32x16_bf16 v[56:71], v[20:23], v[36:39], v[56:71]
    s_mov_b64 exec, s[40:41]
    ds_read_b128 v[16:19], v154 offset:26880
    ds_read_b128 v[20:23], v154 offset:27520
    s_mov_b64 exec, -1
    v_exp_f32 v102, v102
    v_exp_f32 v103, v103
    v_cvt_pk_bf16_f32 v28, v96, v97
    v_cvt_pk_bf16_f32 v29, v98, v99
    v_cvt_pk_bf16_f32 v30, v100, v101
    v_cvt_pk_bf16_f32 v31, v102, v103
    v_mfma_f32_32x32x4_2b_bf16 v[120:151], v[10:11], v[8:9], v[120:151]
    ds_read_b128 v[12:15], v152 offset:30720
    ds_read_b64 v[10:11], v153 offset:31744
    v_exp_f32 v104, v104
    v_exp_f32 v105, v105
    v_exp_f32 v106, v106
    v_exp_f32 v107, v107
    v_exp_f32 v108, v108
    v_exp_f32 v109, v109
    v_exp_f32 v110, v110
    v_exp_f32 v111, v111
    s_waitcnt lgkmcnt(2)
    v_mfma_f32_32x32x16_bf16 v[40:55], v[16:19], v[24:27], v[40:55]
    s_add_u32 m0, s49, 13312
    s_nop 0
    buffer_load_dwordx4 v155, s[4:7], s48 offen offset:0 sc1 lds
    buffer_load_dwordx4 v155, s[4:7], s48 offen offset:1024 sc1 lds
    v_exp_f32 v112, v112
    v_exp_f32 v113, v113
    v_exp_f32 v114, v114
    v_exp_f32 v115, v115
    v_exp_f32 v116, v116
    v_exp_f32 v117, v117
    v_cvt_pk_bf16_f32 v32, v104, v105
    v_cvt_pk_bf16_f32 v33, v106, v107
    v_mfma_f32_32x32x16_bf16 v[40:55], v[20:23], v[28:31], v[40:55]
    v_exp_f32 v118, v118
    v_exp_f32 v119, v119
    v_cvt_pk_bf16_f32 v34, v108, v109
    v_cvt_pk_bf16_f32 v35, v110, v111
    v_cvt_pk_bf16_f32 v36, v112, v113
    v_cvt_pk_bf16_f32 v37, v114, v115
    v_cvt_pk_bf16_f32 v38, v116, v117
    v_cvt_pk_bf16_f32 v39, v118, v119
    s_waitcnt lgkmcnt(0)
    v_mfma_f32_32x32x16_bf16 v[88:103], v[12:15], v[0:3], v[72:87]
    v_exp_f32 v120, v120
    v_exp_f32 v121, v121
    v_exp_f32 v122, v122
    v_exp_f32 v123, v123
    v_exp_f32 v124, v124
    v_exp_f32 v125, v125
    v_mfma_f32_32x32x16_bf16 v[104:119], v[12:15], v[4:7], v[72:87]
    buffer_load_dwordx4 v155, s[4:7], s48 offen offset:2048 sc1 lds
    buffer_load_dwordx4 v155, s[4:7], s48 offen offset:3072 sc1 lds
    s_add_u32 s48, s48, 4096
    v_exp_f32 v126, v126
    v_exp_f32 v127, v127
    v_exp_f32 v128, v128
    v_exp_f32 v129, v129
    v_cvt_pk_bf16_f32 v24, v120, v121
    v_cvt_pk_bf16_f32 v25, v122, v123
    v_mfma_f32_32x32x16_bf16 v[56:71], v[16:19], v[32:35], v[56:71]
    v_exp_f32 v130, v130
    v_exp_f32 v131, v131
    v_exp_f32 v132, v132
    v_exp_f32 v133, v133
    v_cvt_pk_bf16_f32 v26, v124, v125
    v_cvt_pk_bf16_f32 v27, v126, v127
    v_mfma_f32_32x32x16_bf16 v[56:71], v[20:23], v[36:39], v[56:71]
    s_mov_b64 exec, s[40:41]
    ds_read_b128 v[16:19], v154 offset:29440
    ds_read_b128 v[20:23], v154 offset:30080
    s_mov_b64 exec, -1
    v_exp_f32 v134, v134
    v_exp_f32 v135, v135
    v_cvt_pk_bf16_f32 v28, v128, v129
    v_cvt_pk_bf16_f32 v29, v130, v131
    v_cvt_pk_bf16_f32 v30, v132, v133
    v_cvt_pk_bf16_f32 v31, v134, v135
    v_mfma_f32_32x32x4_2b_bf16 v[88:119], v[10:11], v[8:9], v[88:119]
    ds_read_b128 v[12:15], v152 offset:33280
    ds_read_b64 v[10:11], v153 offset:34304
    v_exp_f32 v136, v136
    v_exp_f32 v137, v137
    v_exp_f32 v138, v138
    v_exp_f32 v139, v139
    v_exp_f32 v140, v140
    v_exp_f32 v141, v141
    v_exp_f32 v142, v142
    v_exp_f32 v143, v143
    s_waitcnt lgkmcnt(2)
    v_mfma_f32_32x32x16_bf16 v[40:55], v[16:19], v[24:27], v[40:55]
    s_add_u32 m0, s49, 17408
    s_nop 0
    buffer_load_dwordx4 v155, s[4:7], s48 offen offset:0 sc1 lds
    buffer_load_dwordx4 v155, s[4:7], s48 offen offset:1024 sc1 lds
    v_exp_f32 v144, v144
    v_exp_f32 v145, v145
    v_exp_f32 v146, v146
    v_exp_f32 v147, v147
    v_exp_f32 v148, v148
    v_exp_f32 v149, v149
    v_cvt_pk_bf16_f32 v32, v136, v137
    v_cvt_pk_bf16_f32 v33, v138, v139
    v_mfma_f32_32x32x16_bf16 v[40:55], v[20:23], v[28:31], v[40:55]
    v_exp_f32 v150, v150
    v_exp_f32 v151, v151
    v_cvt_pk_bf16_f32 v34, v140, v141
    v_cvt_pk_bf16_f32 v35, v142, v143
    v_cvt_pk_bf16_f32 v36, v144, v145
    v_cvt_pk_bf16_f32 v37, v146, v147
    v_cvt_pk_bf16_f32 v38, v148, v149
    v_cvt_pk_bf16_f32 v39, v150, v151
    s_waitcnt lgkmcnt(0)
    v_mfma_f32_32x32x16_bf16 v[120:135], v[12:15], v[0:3], v[72:87]
    v_exp_f32 v88, v88
    v_exp_f32 v89, v89
    v_exp_f32 v90, v90
    v_exp_f32 v91, v91
    v_exp_f32 v92, v92
    v_exp_f32 v93, v93
    v_mfma_f32_32x32x16_bf16 v[136:151], v[12:15], v[4:7], v[72:87]
    buffer_load_dwordx4 v155, s[4:7], s48 offen offset:2048 sc1 lds
    buffer_load_dwordx4 v155, s[4:7], s48 offen offset:3072 sc1 lds
    s_add_u32 s48, s48, 4096
    v_exp_f32 v94, v94
    v_exp_f32 v95, v95
    v_exp_f32 v96, v96
    v_exp_f32 v97, v97
    v_cvt_pk_bf16_f32 v24, v88, v89
    v_cvt_pk_bf16_f32 v25, v90, v91
    v_mfma_f32_32x32x16_bf16 v[56:71], v[16:19], v[32:35], v[56:71]
    v_exp_f32 v98, v98
    v_exp_f32 v99, v99
    v_exp_f32 v100, v100
    v_exp_f32 v101, v101
    v_cvt_pk_bf16_f32 v26, v92, v93
    v_cvt_pk_bf16_f32 v27, v94, v95
    v_mfma_f32_32x32x16_bf16 v[56:71], v[20:23], v[36:39], v[56:71]
    s_mov_b64 exec, s[40:41]
    ds_read_b128 v[16:19], v154 offset:32000
    ds_read_b128 v[20:23], v154 offset:32640
    s_mov_b64 exec, -1
    v_exp_f32 v102, v102
    v_exp_f32 v103, v103
    v_cvt_pk_bf16_f32 v28, v96, v97
    v_cvt_pk_bf16_f32 v29, v98, v99
    v_cvt_pk_bf16_f32 v30, v100, v101
    v_cvt_pk_bf16_f32 v31, v102, v103
    v_mfma_f32_32x32x4_2b_bf16 v[120:151], v[10:11], v[8:9], v[120:151]
    ds_read_b128 v[12:15], v152 offset:35840
    ds_read_b64 v[10:11], v153 offset:36864
    v_exp_f32 v104, v104
    v_exp_f32 v105, v105
    v_exp_f32 v106, v106
    v_exp_f32 v107, v107
    v_exp_f32 v108, v108
    v_exp_f32 v109, v109
    v_exp_f32 v110, v110
    v_exp_f32 v111, v111
    s_waitcnt lgkmcnt(2)
    v_mfma_f32_32x32x16_bf16 v[40:55], v[16:19], v[24:27], v[40:55]
    s_add_u32 m0, s49, 21504
    s_nop 0
    buffer_load_dwordx4 v155, s[4:7], s48 offen offset:0 sc1 lds
    buffer_load_dwordx4 v155, s[4:7], s48 offen offset:1024 sc1 lds
    v_exp_f32 v112, v112
    v_exp_f32 v113, v113
    v_exp_f32 v114, v114
    v_exp_f32 v115, v115
    v_exp_f32 v116, v116
    v_exp_f32 v117, v117
    v_cvt_pk_bf16_f32 v32, v104, v105
    v_cvt_pk_bf16_f32 v33, v106, v107
    v_mfma_f32_32x32x16_bf16 v[40:55], v[20:23], v[28:31], v[40:55]
    v_exp_f32 v118, v118
    v_exp_f32 v119, v119
    v_cvt_pk_bf16_f32 v34, v108, v109
    v_cvt_pk_bf16_f32 v35, v110, v111
    v_cvt_pk_bf16_f32 v36, v112, v113
    v_cvt_pk_bf16_f32 v37, v114, v115
    v_cvt_pk_bf16_f32 v38, v116, v117
    v_cvt_pk_bf16_f32 v39, v118, v119
    s_waitcnt lgkmcnt(0)
    v_mfma_f32_32x32x16_bf16 v[88:103], v[12:15], v[0:3], v[72:87]
    v_exp_f32 v120, v120
    v_exp_f32 v121, v121
    v_exp_f32 v122, v122
    v_exp_f32 v123, v123
    v_exp_f32 v124, v124
    v_exp_f32 v125, v125
    v_mfma_f32_32x32x16_bf16 v[104:119], v[12:15], v[4:7], v[72:87]
    buffer_load_dwordx4 v155, s[4:7], s48 offen offset:2048 sc1 lds
    buffer_load_dwordx4 v155, s[4:7], s48 offen offset:3072 sc1 lds
    s_add_u32 s48, s48, 4096
    v_exp_f32 v126, v126
    v_exp_f32 v127, v127
    v_exp_f32 v128, v128
    v_exp_f32 v129, v129
    v_cvt_pk_bf16_f32 v24, v120, v121
    v_cvt_pk_bf16_f32 v25, v122, v123
    v_mfma_f32_32x32x16_bf16 v[56:71], v[16:19], v[32:35], v[56:71]
    v_exp_f32 v130, v130
    v_exp_f32 v131, v131
    v_exp_f32 v132, v132
    v_exp_f32 v133, v133
    v_cvt_pk_bf16_f32 v26, v124, v125
    v_cvt_pk_bf16_f32 v27, v126, v127
    v_mfma_f32_32x32x16_bf16 v[56:71], v[20:23], v[36:39], v[56:71]
    s_mov_b64 exec, s[40:41]
    ds_read_b128 v[16:19], v154 offset:34560
    ds_read_b128 v[20:23], v154 offset:35200
    s_mov_b64 exec, -1
    v_exp_f32 v134, v134
    v_exp_f32 v135, v135
    v_cvt_pk_bf16_f32 v28, v128, v129
    v_cvt_pk_bf16_f32 v29, v130, v131
    v_cvt_pk_bf16_f32 v30, v132, v133
    v_cvt_pk_bf16_f32 v31, v134, v135
    v_mfma_f32_32x32x4_2b_bf16 v[88:119], v[10:11], v[8:9], v[88:119]
    ds_read_b128 v[12:15], v152 offset:38400
    ds_read_b64 v[10:11], v153 offset:39424
    v_exp_f32 v136, v136
    v_exp_f32 v137, v137
    v_exp_f32 v138, v138
    v_exp_f32 v139, v139
    v_exp_f32 v140, v140
    v_exp_f32 v141, v141
    v_exp_f32 v142, v142
    v_exp_f32 v143, v143
    s_waitcnt lgkmcnt(2)
    v_mfma_f32_32x32x16_bf16 v[40:55], v[16:19], v[24:27], v[40:55]
    s_add_u32 m0, s50, 13312
    s_nop 0
    buffer_load_dwordx4 v155, s[4:7], s51 offen sc1 lds
    v_exp_f32 v144, v144
    v_exp_f32 v145, v145
    v_exp_f32 v146, v146
    v_exp_f32 v147, v147
    v_exp_f32 v148, v148
    v_exp_f32 v149, v149
    v_cvt_pk_bf16_f32 v32, v136, v137
    v_cvt_pk_bf16_f32 v33, v138, v139
    v_mfma_f32_32x32x16_bf16 v[40:55], v[20:23], v[28:31], v[40:55]
    v_exp_f32 v150, v150
    v_exp_f32 v151, v151
    v_cvt_pk_bf16_f32 v34, v140, v141
    v_cvt_pk_bf16_f32 v35, v142, v143
    v_cvt_pk_bf16_f32 v36, v144, v145
    v_cvt_pk_bf16_f32 v37, v146, v147
    v_cvt_pk_bf16_f32 v38, v148, v149
    v_cvt_pk_bf16_f32 v39, v150, v151
    s_waitcnt lgkmcnt(0)
    v_mfma_f32_32x32x16_bf16 v[120:135], v[12:15], v[0:3], v[72:87]
    v_exp_f32 v88, v88
    v_exp_f32 v89, v89
    v_exp_f32 v90, v90
    v_exp_f32 v91, v91
    v_exp_f32 v92, v92
    v_exp_f32 v93, v93
    v_mfma_f32_32x32x16_bf16 v[136:151], v[12:15], v[4:7], v[72:87]
    v_exp_f32 v94, v94
    v_exp_f32 v95, v95
    v_exp_f32 v96, v96
    v_exp_f32 v97, v97
    v_cvt_pk_bf16_f32 v24, v88, v89
    v_cvt_pk_bf16_f32 v25, v90, v91
    v_mfma_f32_32x32x16_bf16 v[56:71], v[16:19], v[32:35], v[56:71]
    v_exp_f32 v98, v98
    v_exp_f32 v99, v99
    v_exp_f32 v100, v100
    v_exp_f32 v101, v101
    v_cvt_pk_bf16_f32 v26, v92, v93
    v_cvt_pk_bf16_f32 v27, v94, v95
    v_mfma_f32_32x32x16_bf16 v[56:71], v[20:23], v[36:39], v[56:71]
    s_mov_b64 exec, s[40:41]
    ds_read_b128 v[16:19], v154 offset:37120
    ds_read_b128 v[20:23], v154 offset:37760
    s_mov_b64 exec, -1
    v_exp_f32 v102, v102
    v_exp_f32 v103, v103
    v_cvt_pk_bf16_f32 v28, v96, v97
    v_cvt_pk_bf16_f32 v29, v98, v99
    v_cvt_pk_bf16_f32 v30, v100, v101
    v_cvt_pk_bf16_f32 v31, v102, v103
    v_mfma_f32_32x32x4_2b_bf16 v[120:151], v[10:11], v[8:9], v[120:151]
    v_exp_f32 v104, v104
    v_exp_f32 v105, v105
    v_exp_f32 v106, v106
    v_exp_f32 v107, v107
    v_exp_f32 v108, v108
    v_exp_f32 v109, v109
    v_exp_f32 v110, v110
    v_exp_f32 v111, v111
    s_waitcnt lgkmcnt(0)
    v_mfma_f32_32x32x16_bf16 v[40:55], v[16:19], v[24:27], v[40:55]
    v_exp_f32 v112, v112
    v_exp_f32 v113, v113
    v_exp_f32 v114, v114
    v_exp_f32 v115, v115
    v_exp_f32 v116, v116
    v_exp_f32 v117, v117
    v_cvt_pk_bf16_f32 v32, v104, v105
    v_cvt_pk_bf16_f32 v33, v106, v107
    v_mfma_f32_32x32x16_bf16 v[40:55], v[20:23], v[28:31], v[40:55]
    v_exp_f32 v118, v118
    v_exp_f32 v119, v119
    v_cvt_pk_bf16_f32 v34, v108, v109
    v_cvt_pk_bf16_f32 v35, v110, v111
    v_cvt_pk_bf16_f32 v36, v112, v113
    v_cvt_pk_bf16_f32 v37, v114, v115
    v_cvt_pk_bf16_f32 v38, v116, v117
    v_cvt_pk_bf16_f32 v39, v118, v119
    s_cmp_ge_u32 s24, 4
    s_cbranch_scc1 L_pr42
    s_setprio 0
L_pr42:
    v_exp_f32 v120, v120
    v_exp_f32 v121, v121
    v_exp_f32 v122, v122
    v_exp_f32 v123, v123
    v_exp_f32 v124, v124
    v_exp_f32 v125, v125
    v_exp_f32 v126, v126
    v_exp_f32 v127, v127
    v_exp_f32 v128, v128
    v_exp_f32 v129, v129
    v_cvt_pk_bf16_f32 v24, v120, v121
    v_cvt_pk_bf16_f32 v25, v122, v123
    v_mfma_f32_32x32x16_bf16 v[56:71], v[16:19], v[32:35], v[56:71]
    v_exp_f32 v130, v130
    v_exp_f32 v131, v131
    v_exp_f32 v132, v132
    v_exp_f32 v133, v133
    v_cvt_pk_bf16_f32 v26, v124, v125
    v_cvt_pk_bf16_f32 v27, v126, v127
    v_mfma_f32_32x32x16_bf16 v[56:71], v[20:23], v[36:39], v[56:71]
    s_mov_b64 exec, s[40:41]
    ds_read_b128 v[16:19], v154 offset:39680
    ds_read_b128 v[20:23], v154 offset:40320
    s_mov_b64 exec, -1
    v_exp_f32 v134, v134
    v_exp_f32 v135, v135
    v_cvt_pk_bf16_f32 v28, v128, v129
    v_cvt_pk_bf16_f32 v29, v130, v131
    v_cvt_pk_bf16_f32 v30, v132, v133
    v_cvt_pk_bf16_f32 v31, v134, v135
    v_exp_f32 v136, v136
    v_exp_f32 v137, v137
    v_exp_f32 v138, v138
    v_exp_f32 v139, v139
    v_exp_f32 v140, v140
    v_exp_f32 v141, v141
    v_exp_f32 v142, v142
    v_exp_f32 v143, v143
    s_waitcnt lgkmcnt(0)
    v_mfma_f32_32x32x16_bf16 v[40:55], v[16:19], v[24:27], v[40:55]
    v_exp_f32 v144, v144
    v_exp_f32 v145, v145
    v_exp_f32 v146, v146
    v_exp_f32 v147, v147
    v_exp_f32 v148, v148
    v_exp_f32 v149, v149
    v_cvt_pk_bf16_f32 v32, v136, v137
    v_cvt_pk_bf16_f32 v33, v138, v139
    v_mfma_f32_32x32x16_bf16 v[40:55], v[20:23], v[28:31], v[40:55]
    v_exp_f32 v150, v150
    v_exp_f32 v151, v151
    v_cvt_pk_bf16_f32 v34, v140, v141
    v_cvt_pk_bf16_f32 v35, v142, v143
    v_cvt_pk_bf16_f32 v36, v144, v145
    v_cvt_pk_bf16_f32 v37, v146, v147
    v_cvt_pk_bf16_f32 v38, v148, v149
    v_cvt_pk_bf16_f32 v39, v150, v151
    v_mov_b32 v160, 0x1f800000
    s_nop 0
    v_mfma_f32_32x32x16_bf16 v[56:71], v[16:19], v[32:35], v[56:71]
    v_mfma_f32_32x32x16_bf16 v[56:71], v[20:23], v[36:39], v[56:71]
    ds_write_b128 v166, v[40:43] offset:0
    ds_write_b128 v166, v[44:47] offset:1024
    ds_write_b128 v166, v[48:51] offset:2048
    ds_write_b32 v168, v156 offset:3072
    v_maximum3_f32 v158, |v40|, |v41|, 0
    v_maximum3_f32 v158, |v42|, |v43|, v158
    v_maximum3_f32 v158, |v44|, |v45|, v158
    v_maximum3_f32 v158, |v46|, |v47|, v158
    v_maximum3_f32 v158, |v48|, |v49|, v158
    v_maximum3_f32 v158, |v50|, |v51|, v158
    s_nop 1
    v_maximum3_f32 v158, |v56|, |v57|, v158
    v_maximum3_f32 v158, |v58|, |v59|, v158
    v_maximum3_f32 v158, |v60|, |v61|, v158
    v_maximum3_f32 v158, |v62|, |v63|, v158
    v_maximum3_f32 v158, |v64|, |v65|, v158
    v_maximum3_f32 v158, |v66|, |v67|, v158
    v_min_f32 v159, v48, v64
    v_cmp_nlt_f32 vcc, v158, v174
    v_cmp_lt_f32 s[54:55], v159, v160
    s_setprio 0
    s_or_b32 s55, s55, vcc_hi
    s_or_b32 s55, s55, vcc_lo
    s_cbranch_scc1 L_attn_slow
L_attn_join:
    s_waitcnt lgkmcnt(0)
    s_barrier
    ds_read_b32 v156, v169 offset:3072
    ds_read_b128 v[48:51], v167 offset:2048
    ds_read_b128 v[40:43], v167 offset:0
    ds_read_b128 v[44:47], v167 offset:1024
    s_waitcnt lgkmcnt(3)
    v_max_f32 v158, v156, v157
    v_sub_f32 v162, v157, v158
    v_sub_f32 v160, v156, v158
    v_exp_f32 v162, v162
    v_exp_f32 v160, v160
    s_waitcnt lgkmcnt(2)
    v_mul_f32 v158, v64, v162
    v_fmac_f32 v158, v48, v160
    v_mov_b32 v159, v158
    s_nop 1
    v_permlane32_swap_b32 v158, v159
    v_rcp_f32 v158, v159
    s_nop 0
    v_mul_f32 v162, v162, v158
    v_mul_f32 v160, v160, v158
    v_pk_mul_f32 v[56:57], v[56:57], v[162:163] op_sel_hi:[1,0]
    v_pk_mul_f32 v[58:59], v[58:59], v[162:163] op_sel_hi:[1,0]
    v_pk_mul_f32 v[60:61], v[60:61], v[162:163] op_sel_hi:[1,0]
    v_pk_mul_f32 v[62:63], v[62:63], v[162:163] op_sel_hi:[1,0]
    v_pk_mul_f32 v[64:65], v[64:65], v[162:163] op_sel_hi:[1,0]
    v_pk_mul_f32 v[66:67], v[66:67], v[162:163] op_sel_hi:[1,0]
    s_waitcnt lgkmcnt(0)
    v_pk_fma_f32 v[56:57], v[40:41], v[160:161], v[56:57] op_sel_hi:[1,0,1]
    v_pk_fma_f32 v[58:59], v[42:43], v[160:161], v[58:59] op_sel_hi:[1,0,1]
    v_pk_fma_f32 v[60:61], v[44:45], v[160:161], v[60:61] op_sel_hi:[1,0,1]
    v_pk_fma_f32 v[62:63], v[46:47], v[160:161], v[62:63] op_sel_hi:[1,0,1]
    v_pk_fma_f32 v[64:65], v[48:49], v[160:161], v[64:65] op_sel_hi:[1,0,1]
    v_pk_fma_f32 v[66:67], v[50:51], v[160:161], v[66:67] op_sel_hi:[1,0,1]
    v_cvt_pk_bf16_f32 v24, v56, v57
    v_cvt_pk_bf16_f32 v25, v58, v59
    v_cvt_pk_bf16_f32 v26, v60, v61
    v_cvt_pk_bf16_f32 v27, v62, v63
    v_cvt_pk_bf16_f32 v28, v64, v65
    v_cvt_pk_bf16_f32 v29, v66, v67
    buffer_store_dwordx4 v[24:27], v164, s[20:23], s47 offen sc1
    buffer_store_dwordx2 v[28:29], v165, s[20:23], s47 offen sc1
    s_branch L_attn_end
L_attn_slow:
    s_waitcnt lgkmcnt(0)
    v_and_b32 v158, 31, v252
    v_lshlrev_b32 v153, 3, v158
    v_lshrrev_b32 v159, 5, v252
    v_mul_u32_u24 v159, 20, v159
    v_add_lshl_u32 v154, v159, v158, 4
    v_mov_b32 v156, 0xff800000
    v_mov_b32 v157, 0xff800000
    s_add_u32 s44, s29, s37
    s_mov_b32 s45, s44
    s_mov_b32 s46, 32
L_attn_s1:
    buffer_load_dwordx4 v[12:15], v155, s[20:23], s45 offen sc1
    buffer_load_dwordx2 v[10:11], v153, s[20:23], s45 offen offset:1024 sc1
    s_waitcnt vmcnt(0)
    v_mfma_f32_32x32x16_bf16 v[88:103], v[12:15], v[0:3], 0
    v_mfma_f32_32x32x16_bf16 v[104:119], v[12:15], v[4:7], 0
    s_nop 7
    s_nop 3
    v_mfma_f32_32x32x4_2b_bf16 v[88:119], v[10:11], v[8:9], v[88:119]
    s_nop 7
    s_nop 7
    s_nop 7
    v_max3_f32 v156, v156, v88, v89
    v_max3_f32 v156, v156, v90, v91
    v_max3_f32 v156, v156, v92, v93
    v_max3_f32 v156, v156, v94, v95
    v_max3_f32 v156, v156, v96, v97
    v_max3_f32 v156, v156, v98, v99
    v_max3_f32 v156, v156, v100, v101
    v_max3_f32 v156, v156, v102, v103
    v_max3_f32 v157, v157, v104, v105
    v_max3_f32 v157, v157, v106, v107
    v_max3_f32 v157, v157, v108, v109
    v_max3_f32 v157, v157, v110, v111
    v_max3_f32 v157, v157, v112, v113
    v_max3_f32 v157, v157, v114, v115
    v_max3_f32 v157, v157, v116, v117
    v_max3_f32 v157, v157, v118, v119
    s_add_u32 s45, s45, 2560
    s_sub_u32 s46, s46, 1
    s_cmp_lg_u32 s46, 0
    s_cbranch_scc1 L_attn_s1
    v_mov_b32 v158, v156
    v_mov_b32 v159, v157
    s_nop 1
    v_permlane32_swap_b32 v156, v158
    v_permlane32_swap_b32 v157, v159
    v_max_f32 v156, v156, v158
    v_max_f32 v157, v157, v159
    v_mov_b32 v40, 0
    v_mov_b32 v41, 0
    v_mov_b32 v42, 0
    v_mov_b32 v43, 0
    v_mov_b32 v44, 0
    v_mov_b32 v45, 0
    v_mov_b32 v46, 0
    v_mov_b32 v47, 0
    v_mov_b32 v48, 0
    v_mov_b32 v49, 0
    v_mov_b32 v50, 0
    v_mov_b32 v51, 0
    v_mov_b32 v52, 0
    v_mov_b32 v53, 0
    v_mov_b32 v54, 0
    v_mov_b32 v55, 0
    v_mov_b32 v56, 0
    v_mov_b32 v57, 0
    v_mov_b32 v58, 0
    v_mov_b32 v59, 0
    v_mov_b32 v60, 0
    v_mov_b32 v61, 0
    v_mov_b32 v62, 0
    v_mov_b32 v63, 0
    v_mov_b32 v64, 0
    v_mov_b32 v65, 0
    v_mov_b32 v66, 0
    v_mov_b32 v67, 0
    v_mov_b32 v68, 0
    v_mov_b32 v69, 0
    v_mov_b32 v70, 0
    v_mov_b32 v71, 0
    s_mov_b32 s45, s44
    s_mov_b32 s46, 32
L_attn_s2:
    buffer_load_dwordx4 v[12:15], v155, s[20:23], s45 offen sc1
    buffer_load_dwordx2 v[10:11], v153, s[20:23], s45 offen offset:1024 sc1
    s_mov_b64 exec, s[40:41]
    buffer_load_dwordx4 v[16:19], v154, s[20:23], s45 offen offset:1280 sc1
    buffer_load_dwordx4 v[20:23], v154, s[20:23], s45 offen offset:1920 sc1
    s_mov_b64 exec, -1
    s_waitcnt vmcnt(0)
    v_mfma_f32_32x32x16_bf16 v[88:103], v[12:15], v[0:3], 0
    v_mfma_f32_32x32x16_bf16 v[104:119], v[12:15], v[4:7], 0
    s_nop 7
    s_nop 3
    v_mfma_f32_32x32x4_2b_bf16 v[88:119], v[10:11], v[8:9], v[88:119]
    s_nop 7
    s_nop 7
    s_nop 7
    v_sub_f32 v88, v88, v156
    v_sub_f32 v89, v89, v156
    v_sub_f32 v90, v90, v156
    v_sub_f32 v91, v91, v156
    v_sub_f32 v92, v92, v156
    v_sub_f32 v93, v93, v156
    v_sub_f32 v94, v94, v156
    v_sub_f32 v95, v95, v156
    v_sub_f32 v96, v96, v156
    v_sub_f32 v97, v97, v156
    v_sub_f32 v98, v98, v156
    v_sub_f32 v99, v99, v156
    v_sub_f32 v100, v100, v156
    v_sub_f32 v101, v101, v156
    v_sub_f32 v102, v102, v156
    v_sub_f32 v103, v103, v156
    v_exp_f32 v88, v88
    v_exp_f32 v89, v89
    v_exp_f32 v90, v90
    v_exp_f32 v91, v91
    v_exp_f32 v92, v92
    v_exp_f32 v93, v93
    v_exp_f32 v94, v94
    v_exp_f32 v95, v95
    v_exp_f32 v96, v96
    v_exp_f32 v97, v97
    v_cvt_pk_bf16_f32 v24, v88, v89
    v_cvt_pk_bf16_f32 v25, v90, v91
    v_exp_f32 v98, v98
    v_exp_f32 v99, v99
    v_exp_f32 v100, v100
    v_exp_f32 v101, v101
    v_cvt_pk_bf16_f32 v26, v92, v93
    v_cvt_pk_bf16_f32 v27, v94, v95
    v_exp_f32 v102, v102
    v_exp_f32 v103, v103
    v_cvt_pk_bf16_f32 v28, v96, v97
    v_cvt_pk_bf16_f32 v29, v98, v99
    v_cvt_pk_bf16_f32 v30, v100, v101
    v_cvt_pk_bf16_f32 v31, v102, v103
    v_sub_f32 v104, v104, v157
    v_sub_f32 v105, v105, v157
    v_sub_f32 v106, v106, v157
    v_sub_f32 v107, v107, v157
    v_sub_f32 v108, v108, v157
    v_sub_f32 v109, v109, v157
    v_sub_f32 v110, v110, v157
    v_sub_f32 v111, v111, v157
    v_sub_f32 v112, v112, v157
    v_sub_f32 v113, v113, v157
    v_sub_f32 v114, v114, v157
    v_sub_f32 v115, v115, v157
    v_sub_f32 v116, v116, v157
    v_sub_f32 v117, v117, v157
    v_sub_f32 v118, v118, v157
    v_sub_f32 v119, v119, v157
    v_exp_f32 v104, v104
    v_exp_f32 v105, v105
    v_exp_f32 v106, v106
    v_exp_f32 v107, v107
    v_exp_f32 v108, v108
    v_exp_f32 v109, v109
    v_exp_f32 v110, v110
    v_exp_f32 v111, v111
    v_exp_f32 v112, v112
    v_exp_f32 v113, v113
    v_cvt_pk_bf16_f32 v32, v104, v105
    v_cvt_pk_bf16_f32 v33, v106, v107
    v_exp_f32 v114, v114
    v_exp_f32 v115, v115
    v_exp_f32 v116, v116
    v_exp_f32 v117, v117
    v_cvt_pk_bf16_f32 v34, v108, v109
    v_cvt_pk_bf16_f32 v35, v110, v111
    v_exp_f32 v118, v118
    v_exp_f32 v119, v119
    v_cvt_pk_bf16_f32 v36, v112, v113
    v_cvt_pk_bf16_f32 v37, v114, v115
    v_cvt_pk_bf16_f32 v38, v116, v117
    v_cvt_pk_bf16_f32 v39, v118, v119
    s_nop 1
    v_mfma_f32_32x32x16_bf16 v[40:55], v[16:19], v[24:27], v[40:55]
    v_mfma_f32_32x32x16_bf16 v[40:55], v[20:23], v[28:31], v[40:55]
    v_mfma_f32_32x32x16_bf16 v[56:71], v[16:19], v[32:35], v[56:71]
    v_mfma_f32_32x32x16_bf16 v[56:71], v[20:23], v[36:39], v[56:71]
    s_add_u32 s45, s45, 2560
    s_sub_u32 s46, s46, 1
    s_cmp_lg_u32 s46, 0
    s_cbranch_scc1 L_attn_s2
    s_nop 7
    s_nop 7
    ds_write_b128 v166, v[40:43] offset:0
    ds_write_b128 v166, v[44:47] offset:1024
    ds_write_b128 v166, v[48:51] offset:2048
    ds_write_b32 v168, v156 offset:3072
    s_branch L_attn_join
L_attn_end:
    s_and_b32 s30, s2, 1
    s_lshl_b32 s30, s30, 2
    s_bfe_u32 s31, s2, 0x20003
    s_add_u32 s26, s30, s31
    s_bfe_u32 s30, s2, 0x20001
    s_lshl_b32 s30, s30, 3
    s_lshr_b32 s31, s2, 5
    s_add_u32 s25, s30, s31
    s_lshl_b32 s29, s25, 3
    s_add_u32 s29, s29, s26
    s_cmp_lt_u32 s24, 4
    s_cbranch_scc1 L_wo_c
    v_lshlrev_b32 v0, 4, v252
    s_cmp_lg_u32 s91, 0
    s_cbranch_scc1 L_wo_h1
    s_lshr_b32 s30, s2, 3
    s_mul_i32 s31, s30, 52
    s_lshr_b32 s31, s31, 8
    s_mul_i32 s33, s31, 5
    s_sub_u32 s30, s30, s33
    s_and_b32 s33, s2, 1
    s_mul_i32 s33, s33, 5
    s_add_u32 s25, s33, s30
    s_bfe_u32 s33, s2, 0x20001
    s_mul_i32 s33, s33, 6
    s_add_u32 s26, s33, s31
    s_mul_i32 s45, s25, 24
    s_add_u32 s45, s45, s26
    s_lshl_b32 s27, s26, 18
    s_lshl_b32 s30, s3, 16
    s_add_u32 s27, s27, s30
    s_add_u32 s27, s27, 0x500000
    s_min_u32 s26, s26, 23
    s_lshl_b32 s35, s26, 6
    s_lshl_b32 s30, s3, 4
    s_add_u32 s35, s35, s30
    s_and_b32 s30, s2, 1
    s_lshl_b32 s30, s30, 2
    s_bfe_u32 s31, s2, 0x20003
    s_add_u32 s25, s30, s31
    s_bfe_u32 s30, s2, 0x20001
    s_lshl_b32 s30, s30, 3
    s_lshr_b32 s31, s2, 5
    s_add_u32 s26, s30, s31
    s_lshl_b32 s47, s26, 3
    s_add_u32 s47, s47, s25
    s_mul_i32 s27, s26, 196608
    s_mul_i32 s30, s3, 49152
    s_add_u32 s27, s27, s30
    s_add_u32 s27, s27, 0xb00000
    s_lshl_b32 s29, s3, 12
    s_mul_i32 s36, s26, 48
    s_mul_i32 s30, s3, 12
    s_add_u32 s36, s36, s30
    s_add_u32 s36, s36, 1520
    v_min_u32 v1, 27, v252
    v_mov_b32 v2, s35
    v_mov_b32 v3, s36
    v_cmp_gt_u32 vcc, 16, v1
    s_mov_b32 s35, 0x1480000
    s_nop 0
    v_cndmask_b32 v2, v3, v2, vcc
    v_add_lshl_u32 v1, v1, v2, 6
    s_mov_b32 s61, 0x40000
L_poll43:
    buffer_load_dword v250, v1, s[4:7], s35 offen sc1
    s_sub_u32 s61, s61, 1
    s_waitcnt vmcnt(0)
    s_cbranch_scc1 L_pollx44
    v_cmp_ne_u32 vcc, s90, v250
    s_cbranch_vccz L_pollx44
    s_mov_b64 exec, vcc
    s_sleep 1
    s_branch L_poll43
L_pollx44:
    s_mov_b64 exec, -1
L_wo_h1:
    s_waitcnt vmcnt(0) lgkmcnt(0)
    s_barrier
    s_and_b32 s30, s2, 1
    s_lshl_b32 s30, s30, 2
    s_bfe_u32 s31, s2, 0x20003
    s_add_u32 s25, s30, s31
    s_bfe_u32 s30, s2, 0x20001
    s_lshl_b32 s30, s30, 3
    s_lshr_b32 s31, s2, 5
    s_add_u32 s26, s30, s31
    s_lshl_b32 s47, s26, 3
    s_add_u32 s47, s47, s25
    s_mul_i32 s27, s26, 196608
    s_mul_i32 s30, s3, 49152
    s_add_u32 s27, s27, s30
    s_add_u32 s27, s27, 0xb00000
    s_lshl_b32 s29, s3, 12
    s_add_u32 s27, s27, 12288
    buffer_load_dwordx4 v[64:67], v0, s[4:7], s27 offen offset:0 sc1
    buffer_load_dwordx4 v[68:71], v0, s[4:7], s27 offen offset:1024 sc1
    buffer_load_dwordx4 v[72:75], v0, s[4:7], s27 offen offset:2048 sc1
    buffer_load_dwordx4 v[76:79], v0, s[4:7], s27 offen offset:3072 sc1
    s_add_u32 s27, s27, 4096
    buffer_load_dwordx4 v[80:83], v0, s[4:7], s27 offen offset:0 sc1
    buffer_load_dwordx4 v[84:87], v0, s[4:7], s27 offen offset:1024 sc1
    buffer_load_dwordx4 v[88:91], v0, s[4:7], s27 offen offset:2048 sc1
    buffer_load_dwordx4 v[92:95], v0, s[4:7], s27 offen offset:3072 sc1
    s_add_u32 s27, s27, 4096
    buffer_load_dwordx4 v[96:99], v0, s[4:7], s27 offen offset:0 sc1
    buffer_load_dwordx4 v[100:103], v0, s[4:7], s27 offen offset:1024 sc1
    buffer_load_dwordx4 v[104:107], v0, s[4:7], s27 offen offset:2048 sc1
    buffer_load_dwordx4 v[108:111], v0, s[4:7], s27 offen offset:3072 sc1
    s_add_u32 s27, s27, 4096
    s_lshr_b32 s30, s2, 3
    s_mul_i32 s31, s30, 52
    s_lshr_b32 s31, s31, 8
    s_mul_i32 s33, s31, 5
    s_sub_u32 s30, s30, s33
    s_and_b32 s33, s2, 1
    s_mul_i32 s33, s33, 5
    s_add_u32 s25, s33, s30
    s_bfe_u32 s33, s2, 0x20001
    s_mul_i32 s33, s33, 6
    s_add_u32 s26, s33, s31
    s_mul_i32 s45, s25, 24
    s_add_u32 s45, s45, s26
    s_lshl_b32 s27, s26, 18
    s_lshl_b32 s30, s3, 16
    s_add_u32 s27, s27, s30
    s_add_u32 s27, s27, 0x500000
    s_lshr_b32 s30, s3, 1
    s_mul_i32 s30, s30, 81920
    s_and_b32 s31, s3, 1
    s_mul_i32 s33, s31, 69632
    s_add_u32 s33, s33, s30
    s_mul_i32 s34, s31, 28672
    s_add_u32 s34, s34, s30
    s_add_u32 s34, s34, 12288
    s_barrier
    s_barrier
    s_cmp_ge_u32 s2, 240
    s_cbranch_scc1 L_wo_end
    s_mov_b32 m0, s33
    s_mov_b32 s30, 3
L_wo_dma2:
    buffer_load_dwordx4 v0, s[4:7], s27 offen offset:0 sc1 lds
    buffer_load_dwordx4 v0, s[4:7], s27 offen offset:1024 sc1 lds
    buffer_load_dwordx4 v0, s[4:7], s27 offen offset:2048 sc1 lds
    buffer_load_dwordx4 v0, s[4:7], s27 offen offset:3072 sc1 lds
    s_add_u32 m0, m0, 4096
    s_add_u32 s27, s27, 4096
    s_sub_u32 s30, s30, 1
    s_cmp_lg_u32 s30, 0
    s_cbranch_scc1 L_wo_dma2
    s_branch L_wo_end
L_wo_c:
    v_lshrrev_b32 v160, 4, v252
    v_and_b32 v161, 15, v252
    v_lshlrev_b32 v162, 4, v252
    s_lshl_b32 s30, s25, 2
    s_add_u32 s27, s30, s3
    v_cmp_gt_u32 vcc, 2, v160
    v_mov_b32 v81, 0x80000000
    s_mul_i32 s28, s27, 20480
    s_add_u32 s28, s28, 0x800000
    v_lshlrev_b32 v163, 3, v161
    v_lshl_add_u32 v163, v160, 8, v163
    v_add_u32 v173, 13312, v162
    v_lshlrev_b32 v80, 3, v160
    v_sub_u32 v80, v161, v80
    v_mov_b32 v83, 0x3f80
    v_mov_b32 v84, 0x3f800000
    v_cmp_eq_i32 vcc, 0, v80
    v_cmp_eq_i32 s[38:39], 1, v80
    s_nop 0
    v_cndmask_b32 v76, 0, v83, vcc
    v_cndmask_b32 v76, v76, v84, s[38:39]
    v_cmp_eq_i32 vcc, 2, v80
    v_cmp_eq_i32 s[38:39], 3, v80
    s_nop 0
    v_cndmask_b32 v77, 0, v83, vcc
    v_cndmask_b32 v77, v77, v84, s[38:39]
    v_cmp_eq_i32 vcc, 4, v80
    v_cmp_eq_i32 s[38:39], 5, v80
    s_nop 0
    v_cndmask_b32 v78, 0, v83, vcc
    v_cndmask_b32 v78, v78, v84, s[38:39]
    v_cmp_eq_i32 vcc, 6, v80
    v_cmp_eq_i32 s[38:39], 7, v80
    s_nop 0
    v_cndmask_b32 v79, 0, v83, vcc
    v_cndmask_b32 v79, v79, v84, s[38:39]
    v_lshlrev_b32 v80, 2, v160
    v_sub_u32 v80, v161, v80
    v_mov_b32 v83, 0x3f80
    v_mov_b32 v84, 0x3f800000
    v_cmp_eq_i32 vcc, 0, v80
    v_cmp_eq_i32 s[38:39], 1, v80
    s_nop 0
    v_cndmask_b32 v154, 0, v83, vcc
    v_cndmask_b32 v154, v154, v84, s[38:39]
    v_cmp_eq_i32 vcc, 2, v80
    v_cmp_eq_i32 s[38:39], 3, v80
    s_nop 0
    v_cndmask_b32 v155, 0, v83, vcc
    v_cndmask_b32 v155, v155, v84, s[38:39]
    v_mov_b32 v152, 0
    v_mov_b32 v153, 0
    v_mov_b32 v156, 0
    v_mov_b32 v157, 0
    s_mul_i32 s30, s26, 80
    v_lshrrev_b32 v80, 1, v160
    v_lshlrev_b32 v80, 9, v80
    v_and_b32 v85, 1, v160
    v_lshl_add_u32 v80, v85, 3, v80
    v_add_u32 v84, s30, v161
    v_add_u32 v82, 0, v84
    v_lshrrev_b32 v83, 5, v82
    v_and_b32 v82, 31, v82
    v_lshl_add_u32 v82, v82, 4, v80
    v_lshl_add_u32 v167, v83, 17, v82
    v_add_u32 v82, 16, v84
    v_lshrrev_b32 v83, 5, v82
    v_and_b32 v82, 31, v82
    v_lshl_add_u32 v82, v82, 4, v80
    v_lshl_add_u32 v168, v83, 17, v82
    v_add_u32 v82, 32, v84
    v_lshrrev_b32 v83, 5, v82
    v_and_b32 v82, 31, v82
    v_lshl_add_u32 v82, v82, 4, v80
    v_lshl_add_u32 v169, v83, 17, v82
    v_add_u32 v82, 48, v84
    v_lshrrev_b32 v83, 5, v82
    v_and_b32 v82, 31, v82
    v_lshl_add_u32 v82, v82, 4, v80
    v_lshl_add_u32 v170, v83, 17, v82
    v_add_u32 v82, 64, v84
    v_lshrrev_b32 v83, 5, v82
    v_and_b32 v82, 31, v82
    v_lshl_add_u32 v82, v82, 4, v80
    v_lshl_add_u32 v171, v83, 17, v82
    s_lshl_b32 s37, s27, 10
    s_add_u32 s40, s37, 0xe00000
    v_lshrrev_b32 v82, 2, v252
    v_lshlrev_b32 v172, 4, v82
    v_and_b32 v83, 3, v252
    v_lshl_add_u32 v165, v83, 8, v172
    s_lshl_b32 s33, s27, 11
    s_add_u32 s33, s33, 0x1300000
    s_lshl_b32 s34, s26, 8
    s_add_u32 s34, s34, s33
    s_mov_b32 s42, 0x11111111
    s_mov_b32 s43, 0x11111111
    v_mov_b32 v250, s90
    v_lshlrev_b32 v251, 15, v252
    s_waitcnt vmcnt(0) lgkmcnt(0)
    s_barrier
    s_cmp_lg_u32 s24, 3
    s_cbranch_scc1 L_sig45
    s_mov_b64 exec, 1
    buffer_store_dword v250, v251, s[4:7], s97 offen sc1
    s_mov_b64 exec, -1
L_sig45:
    s_lshl_b32 s97, s29, 7
    s_add_u32 s97, s97, s96
    s_add_u32 s97, s97, 524288
    v_cmp_gt_u32 vcc, 2, v160
    s_cmp_lg_u32 s91, 0
    s_cbranch_scc1 L_wo_x1
    s_mov_b32 s12, s68
    s_mov_b32 s13, s69
    s_mov_b32 s14, 0x280000
    s_mov_b32 s15, 0x20000
    v_mul_u32_u24 v80, 1280, v161
    v_lshl_add_u32 v164, v160, 4, v80
    s_mul_i32 s56, s26, 160
    s_mul_i32 s57, s27, 20480
    s_add_u32 s57, s57, s56
    v_cndmask_b32 v82, v81, v164, vcc
    buffer_load_dwordx4 v[140:143], v164, s[12:15], s57 offen
    buffer_load_dwordx4 v[144:147], v164, s[12:15], s57 offen offset:64
    buffer_load_dwordx4 v[148:151], v82, s[12:15], s57 offen offset:128
    s_branch L_wo_x2
L_wo_x1:
    v_and_b32 v80, 3, v161
    v_and_b32 v82, 4, v161
    v_lshl_or_b32 v80, v82, 1, v80
    v_and_b32 v82, 8, v161
    v_lshrrev_b32 v82, 1, v82
    v_or_b32 v80, v80, v82
    v_lshlrev_b32 v80, 4, v80
    v_lshl_add_u32 v164, v160, 9, v80
    s_lshr_b32 s56, s27, 1
    s_mul_i32 s56, s56, 40960
    s_and_b32 s57, s27, 1
    s_lshl_b32 s57, s57, 8
    s_add_u32 s56, s56, s57
    s_mul_i32 s57, s26, 5120
    s_add_u32 s57, s57, s56
    s_add_u32 s57, s57, 0x200000
    s_add_u32 s58, s57, 4096
    v_cndmask_b32 v82, v81, v164, vcc
    buffer_load_dwordx4 v[140:143], v164, s[4:7], s57 offen sc1
    buffer_load_dwordx4 v[144:147], v164, s[4:7], s57 offen offset:2048 sc1
    buffer_load_dwordx4 v[148:151], v82, s[4:7], s58 offen sc1
L_wo_x2:
    ds_read_b128 v[100:103], v173 offset:0
    ds_read_b128 v[104:107], v173 offset:1024
    ds_read_b128 v[108:111], v173 offset:2048
    ds_read_b128 v[112:115], v173 offset:3072
    ds_read_b128 v[116:119], v173 offset:4096
    ds_read_b128 v[120:123], v173 offset:5120
    ds_read_b128 v[124:127], v173 offset:6144
    ds_read_b128 v[128:131], v173 offset:7168
    ds_read_b128 v[132:135], v173 offset:8192
    ds_read_b128 v[136:139], v173 offset:9216
    v_and_b32 v166, 31, v252
    v_lshlrev_b32 v166, 7, v166
    s_lshr_b32 s36, s25, 2
    s_lshl_b32 s36, s36, 5
    s_lshl_b32 s36, s36, 7
    s_add_u32 s36, s36, s96
    s_add_u32 s36, s36, 262144
    s_cmp_lg_u32 s24, 0
    s_cbranch_scc1 L_np46
    s_mov_b32 s61, 0x40000
L_poll47:
    buffer_load_dword v250, v166, s[4:7], s36 offen sc1
    s_sub_u32 s61, s61, 1
    s_waitcnt vmcnt(0)
    s_cbranch_scc1 L_pollx48
    v_cmp_ne_u32 vcc, s90, v250
    s_cbranch_vccz L_pollx48
    s_mov_b64 exec, vcc
    s_sleep 1
    s_branch L_poll47
L_pollx48:
    s_mov_b64 exec, -1
L_np46:
    s_barrier
    buffer_load_dwordx4 v[0:3], v162, s[20:23], s28 offen offset:0 sc1
    buffer_load_dwordx4 v[4:7], v162, s[20:23], s28 offen offset:1024 sc1
    buffer_load_dwordx4 v[8:11], v162, s[20:23], s28 offen offset:2048 sc1
    buffer_load_dwordx4 v[12:15], v162, s[20:23], s28 offen offset:3072 sc1
    s_add_u32 s28, s28, 4096
    buffer_load_dwordx4 v[16:19], v162, s[20:23], s28 offen offset:0 sc1
    buffer_load_dwordx4 v[20:23], v162, s[20:23], s28 offen offset:1024 sc1
    buffer_load_dwordx4 v[24:27], v162, s[20:23], s28 offen offset:2048 sc1
    buffer_load_dwordx4 v[28:31], v162, s[20:23], s28 offen offset:3072 sc1
    s_add_u32 s28, s28, 4096
    buffer_load_dwordx4 v[32:35], v162, s[20:23], s28 offen offset:0 sc1
    buffer_load_dwordx4 v[36:39], v162, s[20:23], s28 offen offset:1024 sc1
    s_waitcnt vmcnt(10)
    v_mfma_f32_16x16x32_bf16 v[80:83], v[140:143], v[154:157], 0
    v_mfma_f32_16x16x32_bf16 v[84:87], v[140:143], v[152:155], 0
    v_mfma_f32_16x16x32_bf16 v[88:91], v[144:147], v[154:157], 0
    v_mfma_f32_16x16x32_bf16 v[92:95], v[144:147], v[152:155], 0
    v_mfma_f32_16x16x32_bf16 v[96:99], v[148:151], v[76:79], 0
    buffer_load_dwordx4 v[40:43], v162, s[20:23], s28 offen offset:2048 sc1
    buffer_load_dwordx4 v[44:47], v162, s[20:23], s28 offen offset:3072 sc1
    s_add_u32 s28, s28, 4096
    buffer_load_dwordx4 v[48:51], v162, s[20:23], s28 offen offset:0 sc1
    s_waitcnt vmcnt(12) lgkmcnt(5)
    v_mfma_f32_16x16x32_bf16 v[80:83], v[0:3], v[100:103], v[80:83]
    ds_read_b128 v[140:143], v173 offset:10240
    v_mfma_f32_16x16x32_bf16 v[84:87], v[0:3], v[104:107], v[84:87]
    ds_read_b128 v[144:147], v173 offset:11264
    v_mfma_f32_16x16x32_bf16 v[88:91], v[0:3], v[108:111], v[88:91]
    ds_read_b128 v[148:151], v173 offset:12288
    v_mfma_f32_16x16x32_bf16 v[92:95], v[0:3], v[112:115], v[92:95]
    ds_read_b128 v[152:155], v173 offset:13312
    v_mfma_f32_16x16x32_bf16 v[96:99], v[0:3], v[116:119], v[96:99]
    ds_read_b128 v[156:159], v173 offset:14336
    buffer_load_dwordx4 v[52:55], v162, s[20:23], s28 offen offset:1024 sc1
    buffer_load_dwordx4 v[56:59], v162, s[20:23], s28 offen offset:2048 sc1
    buffer_load_dwordx4 v[60:63], v162, s[20:23], s28 offen offset:3072 sc1
    s_add_u32 s28, s28, 4096
    s_waitcnt vmcnt(14) lgkmcnt(5)
    v_mfma_f32_16x16x32_bf16 v[80:83], v[4:7], v[120:123], v[80:83]
    ds_read_b128 v[100:103], v173 offset:15360
    v_mfma_f32_16x16x32_bf16 v[84:87], v[4:7], v[124:127], v[84:87]
    ds_read_b128 v[104:107], v173 offset:16384
    v_mfma_f32_16x16x32_bf16 v[88:91], v[4:7], v[128:131], v[88:91]
    ds_read_b128 v[108:111], v173 offset:17408
    v_mfma_f32_16x16x32_bf16 v[92:95], v[4:7], v[132:135], v[92:95]
    ds_read_b128 v[112:115], v173 offset:18432
    v_mfma_f32_16x16x32_bf16 v[96:99], v[4:7], v[136:139], v[96:99]
    ds_read_b128 v[116:119], v173 offset:19456
    buffer_load_dwordx2 v[64:65], v163, s[20:23], s28 offen offset:0 sc1
    buffer_load_dwordx2 v[66:67], v163, s[20:23], s28 offen offset:128 sc1
    buffer_load_dwordx2 v[68:69], v163, s[20:23], s28 offen offset:1024 sc1
    s_waitcnt vmcnt(16) lgkmcnt(5)
    v_mfma_f32_16x16x32_bf16 v[80:83], v[8:11], v[140:143], v[80:83]
    ds_read_b128 v[120:123], v173 offset:20480
    v_mfma_f32_16x16x32_bf16 v[84:87], v[8:11], v[144:147], v[84:87]
    ds_read_b128 v[124:127], v173 offset:21504
    v_mfma_f32_16x16x32_bf16 v[88:91], v[8:11], v[148:151], v[88:91]
    ds_read_b128 v[128:131], v173 offset:22528
    v_mfma_f32_16x16x32_bf16 v[92:95], v[8:11], v[152:155], v[92:95]
    ds_read_b128 v[132:135], v173 offset:23552
    v_mfma_f32_16x16x32_bf16 v[96:99], v[8:11], v[156:159], v[96:99]
    ds_read_b128 v[136:139], v173 offset:24576
    buffer_load_dwordx2 v[70:71], v163, s[20:23], s28 offen offset:1152 sc1
    buffer_load_dwordx2 v[72:73], v163, s[20:23], s28 offen offset:2048 sc1
    buffer_load_dwordx2 v[74:75], v163, s[20:23], s28 offen offset:2176 sc1
    s_waitcnt vmcnt(18) lgkmcnt(5)
    v_mfma_f32_16x16x32_bf16 v[80:83], v[12:15], v[100:103], v[80:83]
    ds_read_b128 v[140:143], v173 offset:25600
    v_mfma_f32_16x16x32_bf16 v[84:87], v[12:15], v[104:107], v[84:87]
    ds_read_b128 v[144:147], v173 offset:26624
    v_mfma_f32_16x16x32_bf16 v[88:91], v[12:15], v[108:111], v[88:91]
    ds_read_b128 v[148:151], v173 offset:27648
    v_mfma_f32_16x16x32_bf16 v[92:95], v[12:15], v[112:115], v[92:95]
    ds_read_b128 v[152:155], v173 offset:28672
    v_mfma_f32_16x16x32_bf16 v[96:99], v[12:15], v[116:119], v[96:99]
    ds_read_b128 v[156:159], v173 offset:29696
    buffer_load_dwordx2 v[76:77], v163, s[20:23], s28 offen offset:3072 sc1
    buffer_load_dwordx2 v[78:79], v163, s[20:23], s28 offen offset:3200 sc1
    s_waitcnt vmcnt(19) lgkmcnt(5)
    v_mfma_f32_16x16x32_bf16 v[80:83], v[16:19], v[120:123], v[80:83]
    ds_read_b128 v[100:103], v173 offset:30720
    v_mfma_f32_16x16x32_bf16 v[84:87], v[16:19], v[124:127], v[84:87]
    ds_read_b128 v[104:107], v173 offset:31744
    v_mfma_f32_16x16x32_bf16 v[88:91], v[16:19], v[128:131], v[88:91]
    ds_read_b128 v[108:111], v173 offset:32768
    v_mfma_f32_16x16x32_bf16 v[92:95], v[16:19], v[132:135], v[92:95]
    ds_read_b128 v[112:115], v173 offset:33792
    v_mfma_f32_16x16x32_bf16 v[96:99], v[16:19], v[136:139], v[96:99]
    ds_read_b128 v[116:119], v173 offset:34816
    s_waitcnt vmcnt(18) lgkmcnt(5)
    v_mfma_f32_16x16x32_bf16 v[80:83], v[20:23], v[140:143], v[80:83]
    ds_read_b128 v[120:123], v173 offset:35840
    v_mfma_f32_16x16x32_bf16 v[84:87], v[20:23], v[144:147], v[84:87]
    ds_read_b128 v[124:127], v173 offset:36864
    v_mfma_f32_16x16x32_bf16 v[88:91], v[20:23], v[148:151], v[88:91]
    ds_read_b128 v[128:131], v173 offset:37888
    v_mfma_f32_16x16x32_bf16 v[92:95], v[20:23], v[152:155], v[92:95]
    ds_read_b128 v[132:135], v173 offset:38912
    v_mfma_f32_16x16x32_bf16 v[96:99], v[20:23], v[156:159], v[96:99]
    ds_read_b128 v[136:139], v173 offset:39936
    s_waitcnt vmcnt(17) lgkmcnt(5)
    v_mfma_f32_16x16x32_bf16 v[80:83], v[24:27], v[100:103], v[80:83]
    ds_read_b128 v[140:143], v173 offset:40960
    v_mfma_f32_16x16x32_bf16 v[84:87], v[24:27], v[104:107], v[84:87]
    ds_read_b128 v[144:147], v173 offset:41984
    v_mfma_f32_16x16x32_bf16 v[88:91], v[24:27], v[108:111], v[88:91]
    ds_read_b128 v[148:151], v173 offset:43008
    v_mfma_f32_16x16x32_bf16 v[92:95], v[24:27], v[112:115], v[92:95]
    ds_read_b128 v[152:155], v173 offset:44032
    v_mfma_f32_16x16x32_bf16 v[96:99], v[24:27], v[116:119], v[96:99]
    ds_read_b128 v[156:159], v173 offset:45056
    s_waitcnt vmcnt(16) lgkmcnt(5)
    v_mfma_f32_16x16x32_bf16 v[80:83], v[28:31], v[120:123], v[80:83]
    ds_read_b128 v[100:103], v173 offset:46080
    v_mfma_f32_16x16x32_bf16 v[84:87], v[28:31], v[124:127], v[84:87]
    ds_read_b128 v[104:107], v173 offset:47104
    v_mfma_f32_16x16x32_bf16 v[88:91], v[28:31], v[128:131], v[88:91]
    ds_read_b128 v[108:111], v173 offset:48128
    v_mfma_f32_16x16x32_bf16 v[92:95], v[28:31], v[132:135], v[92:95]
    ds_read_b128 v[112:115], v173 offset:49152
    v_mfma_f32_16x16x32_bf16 v[96:99], v[28:31], v[136:139], v[96:99]
    ds_read_b128 v[116:119], v173 offset:50176
    s_waitcnt vmcnt(15) lgkmcnt(5)
    v_add_u32 v173, 81920, v173
    v_mfma_f32_16x16x32_bf16 v[80:83], v[32:35], v[140:143], v[80:83]
    ds_read_b128 v[120:123], v173 offset:0
    v_mfma_f32_16x16x32_bf16 v[84:87], v[32:35], v[144:147], v[84:87]
    ds_read_b128 v[124:127], v173 offset:1024
    v_mfma_f32_16x16x32_bf16 v[88:91], v[32:35], v[148:151], v[88:91]
    ds_read_b128 v[128:131], v173 offset:2048
    v_mfma_f32_16x16x32_bf16 v[92:95], v[32:35], v[152:155], v[92:95]
    ds_read_b128 v[132:135], v173 offset:3072
    v_mfma_f32_16x16x32_bf16 v[96:99], v[32:35], v[156:159], v[96:99]
    ds_read_b128 v[136:139], v173 offset:4096
    s_waitcnt vmcnt(14) lgkmcnt(5)
    v_mfma_f32_16x16x32_bf16 v[80:83], v[36:39], v[100:103], v[80:83]
    ds_read_b128 v[140:143], v173 offset:5120
    v_mfma_f32_16x16x32_bf16 v[84:87], v[36:39], v[104:107], v[84:87]
    ds_read_b128 v[144:147], v173 offset:6144
    v_mfma_f32_16x16x32_bf16 v[88:91], v[36:39], v[108:111], v[88:91]
    ds_read_b128 v[148:151], v173 offset:7168
    v_mfma_f32_16x16x32_bf16 v[92:95], v[36:39], v[112:115], v[92:95]
    ds_read_b128 v[152:155], v173 offset:8192
    v_mfma_f32_16x16x32_bf16 v[96:99], v[36:39], v[116:119], v[96:99]
    ds_read_b128 v[156:159], v173 offset:9216
    s_waitcnt vmcnt(13) lgkmcnt(5)
    s_barrier
    v_mfma_f32_16x16x32_bf16 v[80:83], v[40:43], v[120:123], v[80:83]
    ds_read_b128 v[100:103], v173 offset:10240
    v_mfma_f32_16x16x32_bf16 v[84:87], v[40:43], v[124:127], v[84:87]
    ds_read_b128 v[104:107], v173 offset:11264
    v_mfma_f32_16x16x32_bf16 v[88:91], v[40:43], v[128:131], v[88:91]
    ds_read_b128 v[108:111], v173 offset:12288
    v_mfma_f32_16x16x32_bf16 v[92:95], v[40:43], v[132:135], v[92:95]
    ds_read_b128 v[112:115], v173 offset:13312
    v_mfma_f32_16x16x32_bf16 v[96:99], v[40:43], v[136:139], v[96:99]
    ds_read_b128 v[116:119], v173 offset:14336
    s_waitcnt vmcnt(12) lgkmcnt(5)
    v_mfma_f32_16x16x32_bf16 v[80:83], v[44:47], v[140:143], v[80:83]
    ds_read_b128 v[120:123], v173 offset:15360
    v_mfma_f32_16x16x32_bf16 v[84:87], v[44:47], v[144:147], v[84:87]
    ds_read_b128 v[124:127], v173 offset:16384
    v_mfma_f32_16x16x32_bf16 v[88:91], v[44:47], v[148:151], v[88:91]
    ds_read_b128 v[128:131], v173 offset:17408
    v_mfma_f32_16x16x32_bf16 v[92:95], v[44:47], v[152:155], v[92:95]
    ds_read_b128 v[132:135], v173 offset:18432
    v_mfma_f32_16x16x32_bf16 v[96:99], v[44:47], v[156:159], v[96:99]
    ds_read_b128 v[136:139], v173 offset:19456
    s_waitcnt vmcnt(11) lgkmcnt(5)
    v_mfma_f32_16x16x32_bf16 v[80:83], v[48:51], v[100:103], v[80:83]
    ds_read_b128 v[140:143], v173 offset:20480
    v_mfma_f32_16x16x32_bf16 v[84:87], v[48:51], v[104:107], v[84:87]
    ds_read_b128 v[144:147], v173 offset:21504
    v_mfma_f32_16x16x32_bf16 v[88:91], v[48:51], v[108:111], v[88:91]
    ds_read_b128 v[148:151], v173 offset:22528
    v_mfma_f32_16x16x32_bf16 v[92:95], v[48:51], v[112:115], v[92:95]
    ds_read_b128 v[152:155], v173 offset:23552
    v_mfma_f32_16x16x32_bf16 v[96:99], v[48:51], v[116:119], v[96:99]
    ds_read_b128 v[156:159], v173 offset:24576
    s_waitcnt vmcnt(10) lgkmcnt(5)
    v_mfma_f32_16x16x32_bf16 v[80:83], v[52:55], v[120:123], v[80:83]
    ds_read_b128 v[100:103], v173 offset:25600
    v_mfma_f32_16x16x32_bf16 v[84:87], v[52:55], v[124:127], v[84:87]
    ds_read_b128 v[104:107], v173 offset:26624
    v_mfma_f32_16x16x32_bf16 v[88:91], v[52:55], v[128:131], v[88:91]
    ds_read_b128 v[108:111], v173 offset:27648
    v_mfma_f32_16x16x32_bf16 v[92:95], v[52:55], v[132:135], v[92:95]
    ds_read_b128 v[112:115], v173 offset:28672
    v_mfma_f32_16x16x32_bf16 v[96:99], v[52:55], v[136:139], v[96:99]
    ds_read_b128 v[116:119], v173 offset:29696
    s_waitcnt vmcnt(9) lgkmcnt(5)
    v_mfma_f32_16x16x32_bf16 v[80:83], v[56:59], v[140:143], v[80:83]
    ds_read_b128 v[120:123], v173 offset:30720
    v_mfma_f32_16x16x32_bf16 v[84:87], v[56:59], v[144:147], v[84:87]
    ds_read_b128 v[124:127], v173 offset:31744
    v_mfma_f32_16x16x32_bf16 v[88:91], v[56:59], v[148:151], v[88:91]
    ds_read_b128 v[128:131], v173 offset:32768
    v_mfma_f32_16x16x32_bf16 v[92:95], v[56:59], v[152:155], v[92:95]
    ds_read_b128 v[132:135], v173 offset:33792
    v_mfma_f32_16x16x32_bf16 v[96:99], v[56:59], v[156:159], v[96:99]
    ds_read_b128 v[136:139], v173 offset:34816
    s_waitcnt vmcnt(8) lgkmcnt(5)
    v_mfma_f32_16x16x32_bf16 v[80:83], v[60:63], v[100:103], v[80:83]
    ds_read_b128 v[140:143], v173 offset:35840
    v_mfma_f32_16x16x32_bf16 v[84:87], v[60:63], v[104:107], v[84:87]
    ds_read_b128 v[144:147], v173 offset:36864
    v_mfma_f32_16x16x32_bf16 v[88:91], v[60:63], v[108:111], v[88:91]
    ds_read_b128 v[148:151], v173 offset:37888
    v_mfma_f32_16x16x32_bf16 v[92:95], v[60:63], v[112:115], v[92:95]
    ds_read_b128 v[152:155], v173 offset:38912
    v_mfma_f32_16x16x32_bf16 v[96:99], v[60:63], v[116:119], v[96:99]
    ds_read_b128 v[156:159], v173 offset:39936
    s_waitcnt vmcnt(6) lgkmcnt(5)
    v_mfma_f32_16x16x32_bf16 v[80:83], v[64:67], v[120:123], v[80:83]
    ds_read_b128 v[100:103], v173 offset:40960
    v_mfma_f32_16x16x32_bf16 v[84:87], v[64:67], v[124:127], v[84:87]
    ds_read_b128 v[104:107], v173 offset:41984
    v_mfma_f32_16x16x32_bf16 v[88:91], v[64:67], v[128:131], v[88:91]
    ds_read_b128 v[108:111], v173 offset:43008
    v_mfma_f32_16x16x32_bf16 v[92:95], v[64:67], v[132:135], v[92:95]
    ds_read_b128 v[112:115], v173 offset:44032
    v_mfma_f32_16x16x32_bf16 v[96:99], v[64:67], v[136:139], v[96:99]
    ds_read_b128 v[116:119], v173 offset:45056
    s_waitcnt vmcnt(4) lgkmcnt(5)
    v_mfma_f32_16x16x32_bf16 v[80:83], v[68:71], v[140:143], v[80:83]
    ds_read_b128 v[120:123], v173 offset:46080
    v_mfma_f32_16x16x32_bf16 v[84:87], v[68:71], v[144:147], v[84:87]
    ds_read_b128 v[124:127], v173 offset:47104
    v_mfma_f32_16x16x32_bf16 v[88:91], v[68:71], v[148:151], v[88:91]
    ds_read_b128 v[128:131], v173 offset:48128
    v_mfma_f32_16x16x32_bf16 v[92:95], v[68:71], v[152:155], v[92:95]
    ds_read_b128 v[132:135], v173 offset:49152
    v_mfma_f32_16x16x32_bf16 v[96:99], v[68:71], v[156:159], v[96:99]
    ds_read_b128 v[136:139], v173 offset:50176
    s_waitcnt vmcnt(2) lgkmcnt(5)
    v_mfma_f32_16x16x32_bf16 v[80:83], v[72:75], v[100:103], v[80:83]
    v_mfma_f32_16x16x32_bf16 v[84:87], v[72:75], v[104:107], v[84:87]
    v_mfma_f32_16x16x32_bf16 v[88:91], v[72:75], v[108:111], v[88:91]
    v_mfma_f32_16x16x32_bf16 v[92:95], v[72:75], v[112:115], v[92:95]
    v_mfma_f32_16x16x32_bf16 v[96:99], v[72:75], v[116:119], v[96:99]
    s_waitcnt vmcnt(0) lgkmcnt(0)
    v_mfma_f32_16x16x32_bf16 v[80:83], v[76:79], v[120:123], v[80:83]
    v_mfma_f32_16x16x32_bf16 v[84:87], v[76:79], v[124:127], v[84:87]
    v_mfma_f32_16x16x32_bf16 v[88:91], v[76:79], v[128:131], v[88:91]
    v_mfma_f32_16x16x32_bf16 v[92:95], v[76:79], v[132:135], v[92:95]
    v_mfma_f32_16x16x32_bf16 v[96:99], v[76:79], v[136:139], v[96:99]
    v_mov_b32 v29, s90
    v_mov_b32 v31, s90
    s_nop 2
    v_pk_add_f32 v[20:21], v[80:81], v[84:85]
    v_pk_mul_f32 v[24:25], v[80:81], v[80:81]
    v_pk_add_f32 v[22:23], v[82:83], v[86:87]
    v_pk_mul_f32 v[26:27], v[82:83], v[82:83]
    v_pk_fma_f32 v[24:25], v[84:85], v[84:85], v[24:25]
    v_pk_fma_f32 v[26:27], v[86:87], v[86:87], v[26:27]
    v_pk_add_f32 v[20:21], v[20:21], v[88:89]
    v_pk_fma_f32 v[24:25], v[88:89], v[88:89], v[24:25]
    v_pk_add_f32 v[22:23], v[22:23], v[90:91]
    v_pk_fma_f32 v[26:27], v[90:91], v[90:91], v[26:27]
    v_pk_add_f32 v[20:21], v[20:21], v[92:93]
    v_pk_fma_f32 v[24:25], v[92:93], v[92:93], v[24:25]
    v_pk_add_f32 v[22:23], v[22:23], v[94:95]
    v_pk_fma_f32 v[26:27], v[94:95], v[94:95], v[26:27]
    v_pk_add_f32 v[20:21], v[20:21], v[96:97]
    v_pk_fma_f32 v[24:25], v[96:97], v[96:97], v[24:25]
    v_pk_add_f32 v[22:23], v[22:23], v[98:99]
    v_pk_fma_f32 v[26:27], v[98:99], v[98:99], v[26:27]
    s_nop 0
    v_add_f32_dpp v20, v20, v20 row_ror:8 row_mask:0xf bank_mask:0xf
    v_add_f32_dpp v21, v21, v21 row_ror:8 row_mask:0xf bank_mask:0xf
    v_add_f32_dpp v24, v24, v24 row_ror:8 row_mask:0xf bank_mask:0xf
    v_add_f32_dpp v25, v25, v25 row_ror:8 row_mask:0xf bank_mask:0xf
    v_add_f32_dpp v20, v22, v22 row_ror:8 row_mask:0xf bank_mask:0xc
    v_add_f32_dpp v21, v23, v23 row_ror:8 row_mask:0xf bank_mask:0xc
    v_add_f32_dpp v24, v26, v26 row_ror:8 row_mask:0xf bank_mask:0xc
    v_add_f32_dpp v25, v27, v27 row_ror:8 row_mask:0xf bank_mask:0xc
    v_add_f32_dpp v28, v20, v20 row_half_mirror row_mask:0xf bank_mask:0xf
    v_add_f32_dpp v30, v24, v24 row_half_mirror row_mask:0xf bank_mask:0xf
    s_nop 0
    v_add_f32_dpp v28, v21, v21 row_half_mirror row_mask:0xf bank_mask:0xa
    v_add_f32_dpp v30, v25, v25 row_half_mirror row_mask:0xf bank_mask:0xa
    s_nop 0
    v_add_f32_dpp v28, v28, v28 quad_perm:[1,0,3,2] row_mask:0xf bank_mask:0xf
    v_add_f32_dpp v30, v30, v30 quad_perm:[1,0,3,2] row_mask:0xf bank_mask:0xf
    s_nop 0
    v_add_f32_dpp v28, v28, v28 quad_perm:[2,3,0,1] row_mask:0xf bank_mask:0xf
    v_add_f32_dpp v30, v30, v30 quad_perm:[2,3,0,1] row_mask:0xf bank_mask:0xf
    s_mov_b64 exec, s[42:43]
    buffer_store_dwordx4 v[28:31], v172, s[20:23], s34 offen sc1
    s_mov_b64 exec, -1
    v_cvt_pk_bf16_f32 v240, v80, v81
    v_cvt_pk_bf16_f32 v241, v82, v83
    v_cvt_pk_bf16_f32 v242, v84, v85
    v_cvt_pk_bf16_f32 v243, v86, v87
    v_cvt_pk_bf16_f32 v244, v88, v89
    v_cvt_pk_bf16_f32 v245, v90, v91
    v_cvt_pk_bf16_f32 v246, v92, v93
    v_cvt_pk_bf16_f32 v247, v94, v95
    v_cvt_pk_bf16_f32 v248, v96, v97
    v_cvt_pk_bf16_f32 v249, v98, v99
    s_mov_b32 s61, 0x40000
L_wo_poll:
    buffer_load_dwordx4 v[32:35], v165, s[20:23], s33 offen sc1
    buffer_load_dwordx4 v[36:39], v165, s[20:23], s33 offen offset:1024 sc1
    s_sub_u32 s61, s61, 1
    s_waitcnt vmcnt(0)
    s_cbranch_scc1 L_wo_go
    v_xor_b32 v33, s90, v33
    v_xor_b32 v35, s90, v35
    v_xor_b32 v37, s90, v37
    v_xor_b32 v39, s90, v39
    v_or3_b32 v33, v33, v35, v37
    v_or_b32 v33, v33, v39
    v_cmp_ne_u32 vcc, 0, v33
    s_cbranch_vccz L_wo_go
    s_mov_b64 exec, vcc
    s_branch L_wo_poll
L_wo_go:
    s_mov_b64 exec, -1
    v_add_f32 v32, v32, v36
    v_add_f32 v33, v34, v38
    s_nop 0
    v_add_f32_dpp v32, v32, v32 quad_perm:[1,0,3,2] row_mask:0xf bank_mask:0xf
    v_add_f32_dpp v33, v33, v33 quad_perm:[1,0,3,2] row_mask:0xf bank_mask:0xf
    s_nop 0
    v_add_f32_dpp v32, v32, v32 quad_perm:[2,3,0,1] row_mask:0xf bank_mask:0xf
    v_add_f32_dpp v33, v33, v33 quad_perm:[2,3,0,1] row_mask:0xf bank_mask:0xf
    v_mul_f32 v32, 0xbacccccd, v32
    s_mov_b32 s44, 0x3acccccd
    v_mul_f32 v34, v32, v32
    v_fma_f32 v33, v33, s44, -v34
    v_max_f32 v33, 0, v33
    s_mov_b32 s44, 0x3f800054
    v_mov_b32 v34, 0x2edbe6ff
    v_fma_f32 v33, v33, s44, v34
    v_rsq_f32 v33, v33
    v_mov_b32_dpp v40, v32 row_newbcast:0 row_mask:0xf bank_mask:0xf
    v_mov_b32_dpp v41, v32 row_newbcast:4 row_mask:0xf bank_mask:0xf
    v_mov_b32_dpp v42, v32 row_newbcast:8 row_mask:0xf bank_mask:0xf
    v_mov_b32_dpp v43, v32 row_newbcast:12 row_mask:0xf bank_mask:0xf
    v_mov_b32_dpp v44, v33 row_newbcast:0 row_mask:0xf bank_mask:0xf
    v_mov_b32_dpp v45, v33 row_newbcast:4 row_mask:0xf bank_mask:0xf
    v_mov_b32_dpp v46, v33 row_newbcast:8 row_mask:0xf bank_mask:0xf
    v_mov_b32_dpp v47, v33 row_newbcast:12 row_mask:0xf bank_mask:0xf
    v_pk_add_f32 v[80:81], v[80:81], v[40:41]
    v_pk_add_f32 v[82:83], v[82:83], v[42:43]
    v_pk_mul_f32 v[80:81], v[80:81], v[44:45]
    v_pk_mul_f32 v[82:83], v[82:83], v[46:47]
    v_cvt_pk_bf16_f32 v48, v80, v81
    v_cvt_pk_bf16_f32 v49, v82, v83
    buffer_store_dwordx2 v[48:49], v167, s[20:23], s40 offen sc1
    v_pk_add_f32 v[84:85], v[84:85], v[40:41]
    v_pk_add_f32 v[86:87], v[86:87], v[42:43]
    v_pk_mul_f32 v[84:85], v[84:85], v[44:45]
    v_pk_mul_f32 v[86:87], v[86:87], v[46:47]
    v_cvt_pk_bf16_f32 v50, v84, v85
    v_cvt_pk_bf16_f32 v51, v86, v87
    buffer_store_dwordx2 v[50:51], v168, s[20:23], s40 offen sc1
    v_pk_add_f32 v[88:89], v[88:89], v[40:41]
    v_pk_add_f32 v[90:91], v[90:91], v[42:43]
    v_pk_mul_f32 v[88:89], v[88:89], v[44:45]
    v_pk_mul_f32 v[90:91], v[90:91], v[46:47]
    v_cvt_pk_bf16_f32 v52, v88, v89
    v_cvt_pk_bf16_f32 v53, v90, v91
    buffer_store_dwordx2 v[52:53], v169, s[20:23], s40 offen sc1
    v_pk_add_f32 v[92:93], v[92:93], v[40:41]
    v_pk_add_f32 v[94:95], v[94:95], v[42:43]
    v_pk_mul_f32 v[92:93], v[92:93], v[44:45]
    v_pk_mul_f32 v[94:95], v[94:95], v[46:47]
    v_cvt_pk_bf16_f32 v54, v92, v93
    v_cvt_pk_bf16_f32 v55, v94, v95
    buffer_store_dwordx2 v[54:55], v170, s[20:23], s40 offen sc1
    v_pk_add_f32 v[96:97], v[96:97], v[40:41]
    v_pk_add_f32 v[98:99], v[98:99], v[42:43]
    v_pk_mul_f32 v[96:97], v[96:97], v[44:45]
    v_pk_mul_f32 v[98:99], v[98:99], v[46:47]
    v_cvt_pk_bf16_f32 v56, v96, v97
    v_cvt_pk_bf16_f32 v57, v98, v99
    buffer_store_dwordx2 v[56:57], v171, s[20:23], s40 offen sc1
L_wo_end:
    s_cmp_lt_u32 s2, 240
    s_cbranch_scc1 L_g1_run
    v_mov_b32 v250, s90
    v_lshlrev_b32 v251, 15, v252
    s_waitcnt vmcnt(0) lgkmcnt(0)
    s_barrier
    s_cmp_lg_u32 s24, 3
    s_cbranch_scc1 L_sig49
    s_mov_b64 exec, 1
    buffer_store_dword v250, v251, s[4:7], s97 offen sc1
    s_mov_b64 exec, -1
L_sig49:
    s_lshl_b32 s97, s2, 7
    s_add_u32 s97, s97, s96
    s_add_u32 s97, s97, 786432
    s_cmp_ge_u32 s24, 4
    s_cbranch_scc1 L_g1_end
    s_bfe_u32 s48, s2, 0x20001
    s_lshl_b32 s48, s48, 3
    s_lshr_b32 s49, s2, 5
    s_add_u32 s48, s48, s49
    s_mul_i32 s48, s48, 48
    s_mul_i32 s49, s3, 12
    s_add_u32 s48, s48, s49
    s_lshl_b32 s48, s48, 12
    s_add_u32 s48, s48, 0xb0a000
    s_lshl_b32 s49, s3, 10
    v_lshl_add_u32 v0, v252, 4, s49
    v_xor_b32 v1, 1024, v0
    v_xor_b32 v2, 2048, v0
    v_xor_b32 v3, 3072, v0
    s_add_u32 s49, s48, 4096
    buffer_load_dwordx4 v[208:211], v0, s[4:7], s48 offen sc1
    buffer_load_dwordx4 v[212:215], v1, s[4:7], s48 offen sc1
    buffer_load_dwordx4 v[216:219], v2, s[4:7], s48 offen sc1
    buffer_load_dwordx4 v[220:223], v3, s[4:7], s48 offen sc1
    buffer_load_dwordx4 v[224:227], v0, s[4:7], s49 offen sc1
    buffer_load_dwordx4 v[228:231], v1, s[4:7], s49 offen sc1
    buffer_load_dwordx4 v[232:235], v2, s[4:7], s49 offen sc1
    buffer_load_dwordx4 v[236:239], v3, s[4:7], s49 offen sc1
    s_branch L_g1_end
L_g1_run:
    s_lshr_b32 s30, s2, 3
    s_mul_i32 s31, s30, 52
    s_lshr_b32 s31, s31, 8
    s_mul_i32 s33, s31, 5
    s_sub_u32 s30, s30, s33
    s_and_b32 s33, s2, 1
    s_mul_i32 s33, s33, 5
    s_add_u32 s25, s33, s30
    s_bfe_u32 s33, s2, 0x20001
    s_mul_i32 s33, s33, 6
    s_add_u32 s26, s33, s31
    s_mul_i32 s45, s25, 24
    s_add_u32 s45, s45, s26
    s_lshl_b32 s27, s26, 18
    s_lshl_b32 s30, s3, 16
    s_add_u32 s27, s27, s30
    s_add_u32 s27, s27, 0x500000
    s_cmp_lt_u32 s24, 4
    s_cbranch_scc1 L_g1_c
    s_lshr_b32 s30, s3, 1
    s_mul_i32 s30, s30, 81920
    s_and_b32 s31, s3, 1
    s_mul_i32 s33, s31, 69632
    s_add_u32 s33, s33, s30
    s_mul_i32 s34, s31, 28672
    s_add_u32 s34, s34, s30
    s_add_u32 s34, s34, 12288
    s_add_u32 s27, s27, 12288
    v_add_u32 v1, s34, v0
    s_add_u32 s34, s34, 0
    s_barrier
    s_mov_b32 m0, s34
    s_mov_b32 s30, 7
L_wo_dma3:
    buffer_load_dwordx4 v0, s[4:7], s27 offen offset:0 sc1 lds
    buffer_load_dwordx4 v0, s[4:7], s27 offen offset:1024 sc1 lds
    buffer_load_dwordx4 v0, s[4:7], s27 offen offset:2048 sc1 lds
    buffer_load_dwordx4 v0, s[4:7], s27 offen offset:3072 sc1 lds
    s_add_u32 m0, m0, 4096
    s_add_u32 s27, s27, 4096
    s_sub_u32 s30, s30, 1
    s_cmp_lg_u32 s30, 0
    s_cbranch_scc1 L_wo_dma3
    s_waitcnt vmcnt(0) lgkmcnt(0)
    s_barrier
    s_and_b32 s30, s2, 1
    s_lshl_b32 s30, s30, 2
    s_bfe_u32 s31, s2, 0x20003
    s_add_u32 s25, s30, s31
    s_bfe_u32 s30, s2, 0x20001
    s_lshl_b32 s30, s30, 3
    s_lshr_b32 s31, s2, 5
    s_add_u32 s26, s30, s31
    s_lshl_b32 s47, s26, 3
    s_add_u32 s47, s47, s25
    s_mul_i32 s27, s26, 196608
    s_mul_i32 s30, s3, 49152
    s_add_u32 s27, s27, s30
    s_add_u32 s27, s27, 0xb00000
    s_lshl_b32 s29, s3, 12
    s_add_u32 s33, s29, 49152
    s_barrier
    s_mov_b32 m0, s29
    s_mov_b32 s30, 3
L_g1_dma2:
    buffer_load_dwordx4 v0, s[4:7], s27 offen offset:0 sc1 lds
    buffer_load_dwordx4 v0, s[4:7], s27 offen offset:1024 sc1 lds
    buffer_load_dwordx4 v0, s[4:7], s27 offen offset:2048 sc1 lds
    buffer_load_dwordx4 v0, s[4:7], s27 offen offset:3072 sc1 lds
    s_add_u32 m0, m0, 16384
    s_add_u32 s27, s27, 4096
    s_sub_u32 s30, s30, 1
    s_cmp_lg_u32 s30, 0
    s_cbranch_scc1 L_g1_dma2
    s_barrier
    v_add_u32 v1, s33, v0
    ds_write_b128 v1, v[64:67] offset:0
    ds_write_b128 v1, v[68:71] offset:1024
    ds_write_b128 v1, v[72:75] offset:2048
    ds_write_b128 v1, v[76:79] offset:3072
    ds_write_b128 v1, v[80:83] offset:16384
    ds_write_b128 v1, v[84:87] offset:17408
    ds_write_b128 v1, v[88:91] offset:18432
    ds_write_b128 v1, v[92:95] offset:19456
    ds_write_b128 v1, v[96:99] offset:32768
    ds_write_b128 v1, v[100:103] offset:33792
    ds_write_b128 v1, v[104:107] offset:34816
    ds_write_b128 v1, v[108:111] offset:35840
    s_branch L_g1_end
L_g1_c:
    v_lshlrev_b32 v128, 4, v252
    s_add_u32 s27, s27, 40960
    s_and_b32 s30, s3, 1
    s_lshl_b32 s31, s25, 1
    s_add_u32 s35, s31, s30
    s_xor_b32 s36, s35, 1
    s_lshl_b32 s33, s3, 15
    s_add_u32 s33, s33, 0xe06000
    s_lshl_b32 s28, s35, 17
    s_lshl_b32 s29, s36, 17
    s_add_u32 s28, s28, s33
    s_add_u32 s29, s29, s33
    s_lshr_b32 s30, s3, 1
    s_lshl_b32 s31, s30, 10
    v_add_u32 v129, s31, v128
    v_xor_b32 v130, 0x400, v129
    s_lshr_b32 s30, s3, 1
    s_mul_i32 s30, s30, 81920
    s_and_b32 s31, s3, 1
    s_mul_i32 s33, s31, 69632
    s_add_u32 s33, s33, s30
    s_mul_i32 s34, s31, 28672
    s_add_u32 s34, s34, s30
    s_add_u32 s34, s34, 12288
    s_lshr_b32 s30, s3, 1
    v_add_u32 v139, s33, v129
    v_add_u32 v140, s33, v130
    s_sub_u32 s46, s34, s33
    s_lshl_b32 s31, s26, 1
    s_add_u32 s37, s31, s30
    s_lshl_b32 s38, s37, 6
    v_lshrrev_b32 v146, 5, v252
    v_lshlrev_b32 v141, 4, v146
    s_mov_b32 s16, s78
    s_mov_b32 s17, s79
    s_mov_b32 s18, 0xc00
    s_mov_b32 s19, 0x20000
    s_xor_b32 s31, s3, 0
    s_mul_i32 s31, s31, 12288
    s_add_u32 s31, s31, 114688
    v_add_u32 v138, s31, v128
    s_xor_b32 s31, s3, 1
    s_mul_i32 s31, s31, 12288
    s_add_u32 s31, s31, 114688
    v_add_u32 v135, s31, v128
    s_xor_b32 s31, s3, 2
    s_mul_i32 s31, s31, 12288
    s_add_u32 s31, s31, 114688
    v_add_u32 v136, s31, v128
    s_xor_b32 s31, s3, 3
    s_mul_i32 s31, s31, 12288
    s_add_u32 s31, s31, 114688
    v_add_u32 v137, s31, v128
    v_and_b32 v143, 31, v252
    s_lshl_b32 s30, s35, 5
    v_add_u32 v143, s30, v143
    v_mul_u32_u24 v144, 820, v143
    v_lshrrev_b32 v144, 16, v144
    v_mul_u32_u24 v145, 80, v144
    v_sub_u32 v143, v143, v145
    v_lshrrev_b32 v145, 4, v143
    v_lshlrev_b32 v145, 10, v145
    v_and_b32 v147, 15, v143
    v_lshl_add_u32 v145, v147, 4, v145
    s_mov_b32 s30, 245760
    v_mul_lo_u32 v144, v144, s30
    v_lshl_add_u32 v145, v146, 8, v145
    v_add_u32 v133, v145, v144
    s_mul_i32 s43, s37, 5120
    s_add_u32 s43, s43, 0x1100000
    s_lshl_b32 s30, s25, 6
    s_add_u32 s31, s30, 63
    s_mul_i32 s30, s30, 820
    s_mul_i32 s31, s31, 820
    s_lshr_b32 s30, s30, 16
    s_lshr_b32 s31, s31, 16
    v_mov_b32 v144, s30
    v_mov_b32 v145, s31
    v_cmp_gt_u32 vcc, 8, v252
    v_and_b32 v143, 7, v252
    s_lshl_b32 s44, s3, 6
    v_cndmask_b32 v144, v145, v144, vcc
    v_lshl_add_u32 v143, v143, 3, v144
    v_lshlrev_b32 v134, 7, v143
    s_lshl_b32 s44, s44, 7
    s_add_u32 s44, s44, s96
    s_add_u32 s44, s44, 524288
    v_mov_b32 v250, s90
    v_lshlrev_b32 v251, 15, v252
    s_waitcnt vmcnt(0) lgkmcnt(0)
    s_barrier
    s_cmp_lg_u32 s24, 3
    s_cbranch_scc1 L_sig50
    s_mov_b64 exec, 1
    buffer_store_dword v250, v251, s[4:7], s97 offen sc1
    s_mov_b64 exec, -1
L_sig50:
    s_lshl_b32 s97, s45, 7
    s_add_u32 s97, s97, s96
    s_add_u32 s97, s97, 786432
    s_barrier
    s_mov_b32 s61, 0x40000
L_poll51:
    buffer_load_dword v250, v134, s[4:7], s44 offen sc1
    s_sub_u32 s61, s61, 1
    s_waitcnt vmcnt(0)
    s_cbranch_scc1 L_pollx52
    v_cmp_ne_u32 vcc, s90, v250
    s_cbranch_vccz L_pollx52
    s_mov_b64 exec, vcc
    s_sleep 1
    s_branch L_poll51
L_pollx52:
    s_mov_b64 exec, -1
    buffer_load_dwordx4 v[0:3], v128, s[20:23], s28 offen offset:0 sc1
    buffer_load_dwordx4 v[4:7], v128, s[20:23], s29 offen offset:0 sc1
    buffer_load_dwordx4 v[8:11], v128, s[20:23], s28 offen offset:1024 sc1
    buffer_load_dwordx4 v[12:15], v128, s[20:23], s29 offen offset:1024 sc1
    buffer_load_dwordx4 v[16:19], v128, s[20:23], s28 offen offset:2048 sc1
    buffer_load_dwordx4 v[20:23], v128, s[20:23], s29 offen offset:2048 sc1
    buffer_load_dwordx4 v[24:27], v128, s[20:23], s28 offen offset:3072 sc1
    buffer_load_dwordx4 v[28:31], v128, s[20:23], s29 offen offset:3072 sc1
    s_add_u32 s28, s28, 4096
    s_add_u32 s29, s29, 4096
    buffer_load_dwordx4 v[32:35], v128, s[20:23], s28 offen offset:0 sc1
    buffer_load_dwordx4 v[36:39], v128, s[20:23], s29 offen offset:0 sc1
    buffer_load_dwordx4 v[40:43], v128, s[20:23], s28 offen offset:1024 sc1
    buffer_load_dwordx4 v[44:47], v128, s[20:23], s29 offen offset:1024 sc1
    buffer_load_dwordx4 v[48:51], v128, s[20:23], s28 offen offset:2048 sc1
    buffer_load_dwordx4 v[52:55], v128, s[20:23], s29 offen offset:2048 sc1
    buffer_load_dwordx4 v[56:59], v128, s[20:23], s28 offen offset:3072 sc1
    buffer_load_dwordx4 v[60:63], v128, s[20:23], s29 offen offset:3072 sc1
    s_sub_u32 s28, s28, 28672
    s_sub_u32 s29, s29, 28672
    s_waitcnt vmcnt(14) lgkmcnt(0)
    v_mfma_f32_32x32x16_bf16 v[64:79], v[176:179], v[0:3], 0
    v_mfma_f32_32x32x16_bf16 v[96:111], v[180:183], v[0:3], 0
    v_mfma_f32_32x32x16_bf16 v[80:95], v[176:179], v[4:7], 0
    buffer_load_dwordx4 v[0:3], v128, s[20:23], s28 offen offset:0 sc1
    v_mfma_f32_32x32x16_bf16 v[112:127], v[180:183], v[4:7], 0
    buffer_load_dwordx4 v[4:7], v128, s[20:23], s29 offen offset:0 sc1
    s_waitcnt vmcnt(14) lgkmcnt(0)
    v_mfma_f32_32x32x16_bf16 v[64:79], v[184:187], v[8:11], v[64:79]
    v_mfma_f32_32x32x16_bf16 v[96:111], v[188:191], v[8:11], v[96:111]
    v_mfma_f32_32x32x16_bf16 v[80:95], v[184:187], v[12:15], v[80:95]
    buffer_load_dwordx4 v[8:11], v128, s[20:23], s28 offen offset:1024 sc1
    v_mfma_f32_32x32x16_bf16 v[112:127], v[188:191], v[12:15], v[112:127]
    buffer_load_dwordx4 v[12:15], v128, s[20:23], s29 offen offset:1024 sc1
    s_waitcnt vmcnt(14) lgkmcnt(0)
    v_mfma_f32_32x32x16_bf16 v[64:79], v[192:195], v[16:19], v[64:79]
    v_mfma_f32_32x32x16_bf16 v[96:111], v[196:199], v[16:19], v[96:111]
    v_mfma_f32_32x32x16_bf16 v[80:95], v[192:195], v[20:23], v[80:95]
    buffer_load_dwordx4 v[16:19], v128, s[20:23], s28 offen offset:2048 sc1
    v_mfma_f32_32x32x16_bf16 v[112:127], v[196:199], v[20:23], v[112:127]
    buffer_load_dwordx4 v[20:23], v128, s[20:23], s29 offen offset:2048 sc1
    s_waitcnt vmcnt(14) lgkmcnt(0)
    v_mfma_f32_32x32x16_bf16 v[64:79], v[200:203], v[24:27], v[64:79]
    v_mfma_f32_32x32x16_bf16 v[96:111], v[204:207], v[24:27], v[96:111]
    v_mfma_f32_32x32x16_bf16 v[80:95], v[200:203], v[28:31], v[80:95]
    buffer_load_dwordx4 v[24:27], v128, s[20:23], s28 offen offset:3072 sc1
    v_mfma_f32_32x32x16_bf16 v[112:127], v[204:207], v[28:31], v[112:127]
    buffer_load_dwordx4 v[28:31], v128, s[20:23], s29 offen offset:3072 sc1
    s_add_u32 s28, s28, 4096
    s_add_u32 s29, s29, 4096
    s_waitcnt vmcnt(14) lgkmcnt(0)
    v_mfma_f32_32x32x16_bf16 v[64:79], v[208:211], v[32:35], v[64:79]
    v_mfma_f32_32x32x16_bf16 v[96:111], v[212:215], v[32:35], v[96:111]
    v_mfma_f32_32x32x16_bf16 v[80:95], v[208:211], v[36:39], v[80:95]
    buffer_load_dwordx4 v[32:35], v128, s[20:23], s28 offen offset:0 sc1
    v_mfma_f32_32x32x16_bf16 v[112:127], v[212:215], v[36:39], v[112:127]
    buffer_load_dwordx4 v[36:39], v128, s[20:23], s29 offen offset:0 sc1
    s_waitcnt vmcnt(14) lgkmcnt(0)
    v_mfma_f32_32x32x16_bf16 v[64:79], v[216:219], v[40:43], v[64:79]
    v_mfma_f32_32x32x16_bf16 v[96:111], v[220:223], v[40:43], v[96:111]
    v_mfma_f32_32x32x16_bf16 v[80:95], v[216:219], v[44:47], v[80:95]
    buffer_load_dwordx4 v[40:43], v128, s[20:23], s28 offen offset:1024 sc1
    v_mfma_f32_32x32x16_bf16 v[112:127], v[220:223], v[44:47], v[112:127]
    buffer_load_dwordx4 v[44:47], v128, s[20:23], s29 offen offset:1024 sc1
    s_waitcnt vmcnt(14) lgkmcnt(0)
    v_mfma_f32_32x32x16_bf16 v[64:79], v[224:227], v[48:51], v[64:79]
    v_mfma_f32_32x32x16_bf16 v[96:111], v[228:231], v[48:51], v[96:111]
    v_mfma_f32_32x32x16_bf16 v[80:95], v[224:227], v[52:55], v[80:95]
    buffer_load_dwordx4 v[48:51], v128, s[20:23], s28 offen offset:2048 sc1
    v_mfma_f32_32x32x16_bf16 v[112:127], v[228:231], v[52:55], v[112:127]
    buffer_load_dwordx4 v[52:55], v128, s[20:23], s29 offen offset:2048 sc1
    s_waitcnt vmcnt(14) lgkmcnt(0)
    v_mfma_f32_32x32x16_bf16 v[64:79], v[232:235], v[56:59], v[64:79]
    ds_read_b128 v[160:163], v139 offset:0
    ds_read_b128 v[164:167], v140 offset:0
    v_mfma_f32_32x32x16_bf16 v[96:111], v[236:239], v[56:59], v[96:111]
    v_mfma_f32_32x32x16_bf16 v[80:95], v[232:235], v[60:63], v[80:95]
    buffer_load_dwordx4 v[56:59], v128, s[20:23], s28 offen offset:3072 sc1
    v_mfma_f32_32x32x16_bf16 v[112:127], v[236:239], v[60:63], v[112:127]
    buffer_load_dwordx4 v[60:63], v128, s[20:23], s29 offen offset:3072 sc1
    s_add_u32 s28, s28, 4096
    s_add_u32 s29, s29, 4096
    s_waitcnt vmcnt(14) lgkmcnt(0)
    v_mfma_f32_32x32x16_bf16 v[64:79], v[160:163], v[0:3], v[64:79]
    ds_read_b128 v[168:171], v139 offset:2048
    ds_read_b128 v[172:175], v140 offset:2048
    v_mfma_f32_32x32x16_bf16 v[96:111], v[164:167], v[0:3], v[96:111]
    v_mfma_f32_32x32x16_bf16 v[80:95], v[160:163], v[4:7], v[80:95]
    buffer_load_dwordx4 v[0:3], v128, s[20:23], s28 offen offset:0 sc1
    v_mfma_f32_32x32x16_bf16 v[112:127], v[164:167], v[4:7], v[112:127]
    buffer_load_dwordx4 v[4:7], v128, s[20:23], s29 offen offset:0 sc1
    s_waitcnt vmcnt(14) lgkmcnt(0)
    v_mfma_f32_32x32x16_bf16 v[64:79], v[168:171], v[8:11], v[64:79]
    ds_read_b128 v[160:163], v139 offset:4096
    ds_read_b128 v[164:167], v140 offset:4096
    v_mfma_f32_32x32x16_bf16 v[96:111], v[172:175], v[8:11], v[96:111]
    v_mfma_f32_32x32x16_bf16 v[80:95], v[168:171], v[12:15], v[80:95]
    buffer_load_dwordx4 v[8:11], v128, s[20:23], s28 offen offset:1024 sc1
    v_mfma_f32_32x32x16_bf16 v[112:127], v[172:175], v[12:15], v[112:127]
    buffer_load_dwordx4 v[12:15], v128, s[20:23], s29 offen offset:1024 sc1
    s_waitcnt vmcnt(14) lgkmcnt(0)
    v_mfma_f32_32x32x16_bf16 v[64:79], v[160:163], v[16:19], v[64:79]
    ds_read_b128 v[168:171], v139 offset:6144
    ds_read_b128 v[172:175], v140 offset:6144
    v_mfma_f32_32x32x16_bf16 v[96:111], v[164:167], v[16:19], v[96:111]
    v_mfma_f32_32x32x16_bf16 v[80:95], v[160:163], v[20:23], v[80:95]
    buffer_load_dwordx4 v[16:19], v128, s[20:23], s28 offen offset:2048 sc1
    v_mfma_f32_32x32x16_bf16 v[112:127], v[164:167], v[20:23], v[112:127]
    buffer_load_dwordx4 v[20:23], v128, s[20:23], s29 offen offset:2048 sc1
    s_waitcnt vmcnt(14) lgkmcnt(0)
    v_mfma_f32_32x32x16_bf16 v[64:79], v[168:171], v[24:27], v[64:79]
    ds_read_b128 v[160:163], v139 offset:8192
    ds_read_b128 v[164:167], v140 offset:8192
    v_mfma_f32_32x32x16_bf16 v[96:111], v[172:175], v[24:27], v[96:111]
    v_mfma_f32_32x32x16_bf16 v[80:95], v[168:171], v[28:31], v[80:95]
    buffer_load_dwordx4 v[24:27], v128, s[20:23], s28 offen offset:3072 sc1
    v_mfma_f32_32x32x16_bf16 v[112:127], v[172:175], v[28:31], v[112:127]
    buffer_load_dwordx4 v[28:31], v128, s[20:23], s29 offen offset:3072 sc1
    s_add_u32 s28, s28, 4096
    s_add_u32 s29, s29, 4096
    s_waitcnt vmcnt(14) lgkmcnt(0)
    v_mfma_f32_32x32x16_bf16 v[64:79], v[160:163], v[32:35], v[64:79]
    ds_read_b128 v[168:171], v139 offset:10240
    ds_read_b128 v[172:175], v140 offset:10240
    v_mfma_f32_32x32x16_bf16 v[96:111], v[164:167], v[32:35], v[96:111]
    v_mfma_f32_32x32x16_bf16 v[80:95], v[160:163], v[36:39], v[80:95]
    buffer_load_dwordx4 v[32:35], v128, s[20:23], s28 offen offset:0 sc1
    v_mfma_f32_32x32x16_bf16 v[112:127], v[164:167], v[36:39], v[112:127]
    buffer_load_dwordx4 v[36:39], v128, s[20:23], s29 offen offset:0 sc1
    s_waitcnt vmcnt(14) lgkmcnt(0)
    v_mfma_f32_32x32x16_bf16 v[64:79], v[168:171], v[40:43], v[64:79]
    v_add_u32 v139, s46, v139
    v_add_u32 v140, s46, v140
    ds_read_b128 v[160:163], v139 offset:0
    ds_read_b128 v[164:167], v140 offset:0
    v_mfma_f32_32x32x16_bf16 v[96:111], v[172:175], v[40:43], v[96:111]
    v_mfma_f32_32x32x16_bf16 v[80:95], v[168:171], v[44:47], v[80:95]
    buffer_load_dwordx4 v[40:43], v128, s[20:23], s28 offen offset:1024 sc1
    v_mfma_f32_32x32x16_bf16 v[112:127], v[172:175], v[44:47], v[112:127]
    buffer_load_dwordx4 v[44:47], v128, s[20:23], s29 offen offset:1024 sc1
    s_waitcnt vmcnt(14) lgkmcnt(0)
    v_mfma_f32_32x32x16_bf16 v[64:79], v[160:163], v[48:51], v[64:79]
    ds_read_b128 v[168:171], v139 offset:2048
    ds_read_b128 v[172:175], v140 offset:2048
    v_mfma_f32_32x32x16_bf16 v[96:111], v[164:167], v[48:51], v[96:111]
    v_mfma_f32_32x32x16_bf16 v[80:95], v[160:163], v[52:55], v[80:95]
    buffer_load_dwordx4 v[48:51], v128, s[20:23], s28 offen offset:2048 sc1
    v_mfma_f32_32x32x16_bf16 v[112:127], v[164:167], v[52:55], v[112:127]
    buffer_load_dwordx4 v[52:55], v128, s[20:23], s29 offen offset:2048 sc1
    s_waitcnt vmcnt(14) lgkmcnt(0)
    v_mfma_f32_32x32x16_bf16 v[64:79], v[168:171], v[56:59], v[64:79]
    ds_read_b128 v[160:163], v139 offset:4096
    ds_read_b128 v[164:167], v140 offset:4096
    v_mfma_f32_32x32x16_bf16 v[96:111], v[172:175], v[56:59], v[96:111]
    v_mfma_f32_32x32x16_bf16 v[80:95], v[168:171], v[60:63], v[80:95]
    buffer_load_dwordx4 v[56:59], v128, s[20:23], s28 offen offset:3072 sc1
    v_mfma_f32_32x32x16_bf16 v[112:127], v[172:175], v[60:63], v[112:127]
    buffer_load_dwordx4 v[60:63], v128, s[20:23], s29 offen offset:3072 sc1
    s_add_u32 s28, s28, 4096
    s_add_u32 s29, s29, 4096
    s_waitcnt vmcnt(14) lgkmcnt(0)
    v_mfma_f32_32x32x16_bf16 v[64:79], v[160:163], v[0:3], v[64:79]
    ds_read_b128 v[168:171], v139 offset:6144
    ds_read_b128 v[172:175], v140 offset:6144
    v_mfma_f32_32x32x16_bf16 v[96:111], v[164:167], v[0:3], v[96:111]
    v_mfma_f32_32x32x16_bf16 v[80:95], v[160:163], v[4:7], v[80:95]
    buffer_load_dwordx4 v[0:3], v128, s[20:23], s28 offen offset:0 sc1
    v_mfma_f32_32x32x16_bf16 v[112:127], v[164:167], v[4:7], v[112:127]
    buffer_load_dwordx4 v[4:7], v128, s[20:23], s29 offen offset:0 sc1
    s_waitcnt vmcnt(14) lgkmcnt(0)
    v_mfma_f32_32x32x16_bf16 v[64:79], v[168:171], v[8:11], v[64:79]
    ds_read_b128 v[160:163], v139 offset:8192
    ds_read_b128 v[164:167], v140 offset:8192
    v_mfma_f32_32x32x16_bf16 v[96:111], v[172:175], v[8:11], v[96:111]
    v_mfma_f32_32x32x16_bf16 v[80:95], v[168:171], v[12:15], v[80:95]
    buffer_load_dwordx4 v[8:11], v128, s[20:23], s28 offen offset:1024 sc1
    v_mfma_f32_32x32x16_bf16 v[112:127], v[172:175], v[12:15], v[112:127]
    buffer_load_dwordx4 v[12:15], v128, s[20:23], s29 offen offset:1024 sc1
    s_waitcnt vmcnt(14) lgkmcnt(0)
    v_mfma_f32_32x32x16_bf16 v[64:79], v[160:163], v[16:19], v[64:79]
    ds_read_b128 v[168:171], v139 offset:10240
    ds_read_b128 v[172:175], v140 offset:10240
    v_mfma_f32_32x32x16_bf16 v[96:111], v[164:167], v[16:19], v[96:111]
    v_mfma_f32_32x32x16_bf16 v[80:95], v[160:163], v[20:23], v[80:95]
    buffer_load_dwordx4 v[16:19], v128, s[20:23], s28 offen offset:2048 sc1
    v_mfma_f32_32x32x16_bf16 v[112:127], v[164:167], v[20:23], v[112:127]
    buffer_load_dwordx4 v[20:23], v128, s[20:23], s29 offen offset:2048 sc1
    s_waitcnt vmcnt(14) lgkmcnt(0)
    v_mfma_f32_32x32x16_bf16 v[64:79], v[168:171], v[24:27], v[64:79]
    ds_read_b128 v[160:163], v139 offset:12288
    ds_read_b128 v[164:167], v140 offset:12288
    v_mfma_f32_32x32x16_bf16 v[96:111], v[172:175], v[24:27], v[96:111]
    v_mfma_f32_32x32x16_bf16 v[80:95], v[168:171], v[28:31], v[80:95]
    buffer_load_dwordx4 v[24:27], v128, s[20:23], s28 offen offset:3072 sc1
    v_mfma_f32_32x32x16_bf16 v[112:127], v[172:175], v[28:31], v[112:127]
    buffer_load_dwordx4 v[28:31], v128, s[20:23], s29 offen offset:3072 sc1
    s_add_u32 s28, s28, 4096
    s_add_u32 s29, s29, 4096
    s_waitcnt vmcnt(14) lgkmcnt(0)
    v_mfma_f32_32x32x16_bf16 v[64:79], v[160:163], v[32:35], v[64:79]
    ds_read_b128 v[168:171], v139 offset:14336
    ds_read_b128 v[172:175], v140 offset:14336
    v_mfma_f32_32x32x16_bf16 v[96:111], v[164:167], v[32:35], v[96:111]
    buffer_load_dwordx4 v[176:179], v129, s[4:7], s27 offen offset:0 sc1
    buffer_load_dwordx4 v[180:183], v130, s[4:7], s27 offen offset:0 sc1
    v_mfma_f32_32x32x16_bf16 v[80:95], v[160:163], v[36:39], v[80:95]
    buffer_load_dwordx4 v[32:35], v128, s[20:23], s28 offen offset:0 sc1
    v_mfma_f32_32x32x16_bf16 v[112:127], v[164:167], v[36:39], v[112:127]
    buffer_load_dwordx4 v[36:39], v128, s[20:23], s29 offen offset:0 sc1
    buffer_load_dwordx4 v[152:155], v141, s[16:19], s38 offen
    buffer_load_dwordx4 v[156:159], v141, s[16:19], s38 offen offset:32
    s_waitcnt vmcnt(18) lgkmcnt(0)
    v_mfma_f32_32x32x16_bf16 v[64:79], v[168:171], v[40:43], v[64:79]
    ds_read_b128 v[160:163], v139 offset:16384
    ds_read_b128 v[164:167], v140 offset:16384
    v_mfma_f32_32x32x16_bf16 v[96:111], v[172:175], v[40:43], v[96:111]
    buffer_load_dwordx4 v[184:187], v129, s[4:7], s27 offen offset:2048 sc1
    buffer_load_dwordx4 v[188:191], v130, s[4:7], s27 offen offset:2048 sc1
    s_add_u32 s27, s27, 4096
    v_mfma_f32_32x32x16_bf16 v[80:95], v[168:171], v[44:47], v[80:95]
    buffer_load_dwordx4 v[40:43], v128, s[20:23], s28 offen offset:1024 sc1
    v_mfma_f32_32x32x16_bf16 v[112:127], v[172:175], v[44:47], v[112:127]
    buffer_load_dwordx4 v[44:47], v128, s[20:23], s29 offen offset:1024 sc1
    s_waitcnt vmcnt(20) lgkmcnt(0)
    v_mfma_f32_32x32x16_bf16 v[64:79], v[160:163], v[48:51], v[64:79]
    ds_read_b128 v[168:171], v139 offset:18432
    ds_read_b128 v[172:175], v140 offset:18432
    v_mfma_f32_32x32x16_bf16 v[96:111], v[164:167], v[48:51], v[96:111]
    buffer_load_dwordx4 v[192:195], v129, s[4:7], s27 offen offset:0 sc1
    buffer_load_dwordx4 v[196:199], v130, s[4:7], s27 offen offset:0 sc1
    v_mfma_f32_32x32x16_bf16 v[80:95], v[160:163], v[52:55], v[80:95]
    buffer_load_dwordx4 v[48:51], v128, s[20:23], s28 offen offset:2048 sc1
    v_mfma_f32_32x32x16_bf16 v[112:127], v[164:167], v[52:55], v[112:127]
    buffer_load_dwordx4 v[52:55], v128, s[20:23], s29 offen offset:2048 sc1
    s_waitcnt vmcnt(22) lgkmcnt(0)
    v_mfma_f32_32x32x16_bf16 v[64:79], v[168:171], v[56:59], v[64:79]
    ds_read_b128 v[160:163], v139 offset:20480
    ds_read_b128 v[164:167], v140 offset:20480
    v_mfma_f32_32x32x16_bf16 v[96:111], v[172:175], v[56:59], v[96:111]
    buffer_load_dwordx4 v[200:203], v129, s[4:7], s27 offen offset:2048 sc1
    buffer_load_dwordx4 v[204:207], v130, s[4:7], s27 offen offset:2048 sc1
    s_add_u32 s27, s27, 4096
    v_mfma_f32_32x32x16_bf16 v[80:95], v[168:171], v[60:63], v[80:95]
    buffer_load_dwordx4 v[56:59], v128, s[20:23], s28 offen offset:3072 sc1
    v_mfma_f32_32x32x16_bf16 v[112:127], v[172:175], v[60:63], v[112:127]
    buffer_load_dwordx4 v[60:63], v128, s[20:23], s29 offen offset:3072 sc1
    s_add_u32 s28, s28, 4096
    s_add_u32 s29, s29, 4096
    s_waitcnt vmcnt(24) lgkmcnt(0)
    v_mfma_f32_32x32x16_bf16 v[64:79], v[160:163], v[0:3], v[64:79]
    ds_read_b128 v[168:171], v139 offset:22528
    ds_read_b128 v[172:175], v140 offset:22528
    v_mfma_f32_32x32x16_bf16 v[96:111], v[164:167], v[0:3], v[96:111]
    v_mfma_f32_32x32x16_bf16 v[80:95], v[160:163], v[4:7], v[80:95]
    v_mfma_f32_32x32x16_bf16 v[112:127], v[164:167], v[4:7], v[112:127]
    s_waitcnt vmcnt(22) lgkmcnt(0)
    v_mfma_f32_32x32x16_bf16 v[64:79], v[168:171], v[8:11], v[64:79]
    ds_read_b128 v[160:163], v139 offset:24576
    ds_read_b128 v[164:167], v140 offset:24576
    v_mfma_f32_32x32x16_bf16 v[96:111], v[172:175], v[8:11], v[96:111]
    v_mfma_f32_32x32x16_bf16 v[80:95], v[168:171], v[12:15], v[80:95]
    v_mfma_f32_32x32x16_bf16 v[112:127], v[172:175], v[12:15], v[112:127]
    s_waitcnt vmcnt(20) lgkmcnt(0)
    v_mfma_f32_32x32x16_bf16 v[64:79], v[160:163], v[16:19], v[64:79]
    ds_read_b128 v[168:171], v139 offset:26624
    ds_read_b128 v[172:175], v140 offset:26624
    v_mfma_f32_32x32x16_bf16 v[96:111], v[164:167], v[16:19], v[96:111]
    v_mfma_f32_32x32x16_bf16 v[80:95], v[160:163], v[20:23], v[80:95]
    v_mfma_f32_32x32x16_bf16 v[112:127], v[164:167], v[20:23], v[112:127]
    s_waitcnt vmcnt(18) lgkmcnt(0)
    v_mfma_f32_32x32x16_bf16 v[64:79], v[168:171], v[24:27], v[64:79]
    v_mfma_f32_32x32x16_bf16 v[96:111], v[172:175], v[24:27], v[96:111]
    v_mfma_f32_32x32x16_bf16 v[80:95], v[168:171], v[28:31], v[80:95]
    v_mfma_f32_32x32x16_bf16 v[112:127], v[172:175], v[28:31], v[112:127]
    s_waitcnt vmcnt(14) lgkmcnt(0)
    s_barrier
    v_mfma_f32_32x32x16_bf16 v[64:79], v[176:179], v[32:35], v[64:79]
    v_mfma_f32_32x32x16_bf16 v[96:111], v[180:183], v[32:35], v[96:111]
    v_mfma_f32_32x32x16_bf16 v[80:95], v[176:179], v[36:39], v[80:95]
    v_mfma_f32_32x32x16_bf16 v[112:127], v[180:183], v[36:39], v[112:127]
    s_bfe_u32 s48, s2, 0x20001
    s_lshl_b32 s48, s48, 3
    s_lshr_b32 s49, s2, 5
    s_add_u32 s48, s48, s49
    s_mul_i32 s48, s48, 48
    s_mul_i32 s49, s3, 12
    s_add_u32 s48, s48, s49
    s_lshl_b32 s48, s48, 12
    s_add_u32 s48, s48, 0xb0a000
    s_lshl_b32 s49, s3, 10
    v_lshl_add_u32 v142, v252, 4, s49
    v_xor_b32 v143, 1024, v142
    v_xor_b32 v144, 2048, v142
    v_xor_b32 v145, 3072, v142
    s_add_u32 s49, s48, 4096
    buffer_load_dwordx4 v[208:211], v142, s[4:7], s48 offen sc1
    buffer_load_dwordx4 v[212:215], v143, s[4:7], s48 offen sc1
    buffer_load_dwordx4 v[216:219], v144, s[4:7], s48 offen sc1
    buffer_load_dwordx4 v[220:223], v145, s[4:7], s48 offen sc1
    buffer_load_dwordx4 v[224:227], v142, s[4:7], s49 offen sc1
    buffer_load_dwordx4 v[228:231], v143, s[4:7], s49 offen sc1
    buffer_load_dwordx4 v[232:235], v144, s[4:7], s49 offen sc1
    buffer_load_dwordx4 v[236:239], v145, s[4:7], s49 offen sc1
    s_waitcnt vmcnt(16) lgkmcnt(0)
    v_mfma_f32_32x32x16_bf16 v[64:79], v[184:187], v[40:43], v[64:79]
    v_mfma_f32_32x32x16_bf16 v[96:111], v[188:191], v[40:43], v[96:111]
    v_mfma_f32_32x32x16_bf16 v[80:95], v[184:187], v[44:47], v[80:95]
    v_mfma_f32_32x32x16_bf16 v[112:127], v[188:191], v[44:47], v[112:127]
    s_waitcnt vmcnt(12) lgkmcnt(0)
    v_mfma_f32_32x32x16_bf16 v[64:79], v[192:195], v[48:51], v[64:79]
    v_mfma_f32_32x32x16_bf16 v[96:111], v[196:199], v[48:51], v[96:111]
    v_mfma_f32_32x32x16_bf16 v[80:95], v[192:195], v[52:55], v[80:95]
    v_mfma_f32_32x32x16_bf16 v[112:127], v[196:199], v[52:55], v[112:127]
    s_waitcnt vmcnt(8) lgkmcnt(0)
    v_mfma_f32_32x32x16_bf16 v[96:111], v[204:207], v[56:59], v[96:111]
    v_mfma_f32_32x32x16_bf16 v[80:95], v[200:203], v[60:63], v[80:95]
    v_mfma_f32_32x32x16_bf16 v[112:127], v[204:207], v[60:63], v[112:127]
    v_mfma_f32_32x32x16_bf16 v[64:79], v[200:203], v[56:59], v[64:79]
    s_mov_b32 s40, 0xbdd2d3e8
    s_mov_b32 s41, 0xbdd2d3e8
    v_mov_b32 v142, 0xc0135761
    v_mov_b32 v143, 0xc0135761
    s_nop 5
    ds_write_b128 v138, v[80:83] offset:0
    ds_write_b128 v138, v[84:87] offset:1024
    ds_write_b128 v138, v[88:91] offset:2048
    ds_write_b128 v138, v[92:95] offset:3072
    ds_write_b128 v138, v[96:99] offset:4096
    ds_write_b128 v138, v[100:103] offset:5120
    ds_write_b128 v138, v[104:107] offset:6144
    ds_write_b128 v138, v[108:111] offset:7168
    ds_write_b128 v138, v[112:115] offset:8192
    ds_write_b128 v138, v[116:119] offset:9216
    ds_write_b128 v138, v[120:123] offset:10240
    ds_write_b128 v138, v[124:127] offset:11264
    v_lshlrev_b32 v160, 16, v152
    v_and_b32 v161, 0xffff0000, v152
    v_lshlrev_b32 v162, 16, v153
    v_and_b32 v163, 0xffff0000, v153
    v_lshlrev_b32 v164, 16, v154
    v_and_b32 v165, 0xffff0000, v154
    v_lshlrev_b32 v166, 16, v155
    v_and_b32 v167, 0xffff0000, v155
    v_lshlrev_b32 v168, 16, v156
    v_and_b32 v169, 0xffff0000, v156
    v_lshlrev_b32 v170, 16, v157
    v_and_b32 v171, 0xffff0000, v157
    v_lshlrev_b32 v172, 16, v158
    v_and_b32 v173, 0xffff0000, v158
    v_lshlrev_b32 v174, 16, v159
    v_and_b32 v175, 0xffff0000, v159
    v_pk_add_f32 v[64:65], v[64:65], v[160:161]
    v_pk_add_f32 v[66:67], v[66:67], v[162:163]
    v_pk_add_f32 v[68:69], v[68:69], v[164:165]
    v_pk_add_f32 v[70:71], v[70:71], v[166:167]
    v_pk_add_f32 v[72:73], v[72:73], v[168:169]
    v_pk_add_f32 v[74:75], v[74:75], v[170:171]
    v_pk_add_f32 v[76:77], v[76:77], v[172:173]
    v_pk_add_f32 v[78:79], v[78:79], v[174:175]
    s_waitcnt lgkmcnt(0)
    s_barrier
    ds_read_b128 v[0:3], v135 offset:0
    ds_read_b128 v[16:19], v136 offset:4096
    ds_read_b128 v[32:35], v137 offset:8192
    ds_read_b128 v[4:7], v135 offset:1024
    ds_read_b128 v[20:23], v136 offset:5120
    ds_read_b128 v[36:39], v137 offset:9216
    ds_read_b128 v[8:11], v135 offset:2048
    ds_read_b128 v[24:27], v136 offset:6144
    ds_read_b128 v[40:43], v137 offset:10240
    ds_read_b128 v[12:15], v135 offset:3072
    ds_read_b128 v[28:31], v136 offset:7168
    ds_read_b128 v[44:47], v137 offset:11264
    s_waitcnt lgkmcnt(6)
    v_pk_add_f32 v[0:1], v[0:1], v[16:17]
    v_pk_add_f32 v[2:3], v[2:3], v[18:19]
    v_pk_add_f32 v[4:5], v[4:5], v[20:21]
    v_pk_add_f32 v[6:7], v[6:7], v[22:23]
    v_pk_add_f32 v[64:65], v[64:65], v[32:33]
    v_pk_add_f32 v[66:67], v[66:67], v[34:35]
    v_pk_add_f32 v[68:69], v[68:69], v[36:37]
    v_pk_add_f32 v[70:71], v[70:71], v[38:39]
    v_pk_add_f32 v[64:65], v[64:65], v[0:1]
    v_pk_add_f32 v[66:67], v[66:67], v[2:3]
    v_pk_add_f32 v[68:69], v[68:69], v[4:5]
    v_pk_add_f32 v[70:71], v[70:71], v[6:7]
    v_pk_mul_f32 v[80:81], v[64:65], v[64:65]
    v_pk_mul_f32 v[82:83], v[66:67], v[66:67]
    v_pk_mul_f32 v[84:85], v[68:69], v[68:69]
    v_pk_mul_f32 v[86:87], v[70:71], v[70:71]
    v_pk_fma_f32 v[80:81], v[80:81], s[40:41], v[142:143]
    v_pk_fma_f32 v[82:83], v[82:83], s[40:41], v[142:143]
    v_pk_fma_f32 v[84:85], v[84:85], s[40:41], v[142:143]
    v_pk_fma_f32 v[86:87], v[86:87], s[40:41], v[142:143]
    v_pk_mul_f32 v[80:81], v[80:81], v[64:65]
    v_pk_mul_f32 v[82:83], v[82:83], v[66:67]
    v_pk_mul_f32 v[84:85], v[84:85], v[68:69]
    v_pk_mul_f32 v[86:87], v[86:87], v[70:71]
    v_exp_f32 v80, v80
    v_exp_f32 v81, v81
    v_exp_f32 v82, v82
    v_exp_f32 v83, v83
    v_exp_f32 v84, v84
    v_exp_f32 v85, v85
    v_exp_f32 v86, v86
    v_exp_f32 v87, v87
    v_pk_add_f32 v[80:81], v[80:81], 1.0 op_sel_hi:[1,0]
    v_pk_add_f32 v[82:83], v[82:83], 1.0 op_sel_hi:[1,0]
    v_pk_add_f32 v[84:85], v[84:85], 1.0 op_sel_hi:[1,0]
    v_pk_add_f32 v[86:87], v[86:87], 1.0 op_sel_hi:[1,0]
    v_rcp_f32 v80, v80
    v_rcp_f32 v81, v81
    v_rcp_f32 v82, v82
    v_rcp_f32 v83, v83
    v_rcp_f32 v84, v84
    v_rcp_f32 v85, v85
    v_rcp_f32 v86, v86
    v_rcp_f32 v87, v87
    v_pk_mul_f32 v[80:81], v[80:81], v[64:65]
    v_pk_mul_f32 v[82:83], v[82:83], v[66:67]
    v_pk_mul_f32 v[84:85], v[84:85], v[68:69]
    v_pk_mul_f32 v[86:87], v[86:87], v[70:71]
    v_cvt_pk_bf16_f32 v96, v80, v81
    v_cvt_pk_bf16_f32 v97, v82, v83
    v_cvt_pk_bf16_f32 v98, v84, v85
    v_cvt_pk_bf16_f32 v99, v86, v87
    buffer_store_dwordx4 v[96:99], v133, s[20:23], s43 offen offset:0 sc1
    s_waitcnt lgkmcnt(0)
    v_pk_add_f32 v[8:9], v[8:9], v[24:25]
    v_pk_add_f32 v[10:11], v[10:11], v[26:27]
    v_pk_add_f32 v[12:13], v[12:13], v[28:29]
    v_pk_add_f32 v[14:15], v[14:15], v[30:31]
    v_pk_add_f32 v[72:73], v[72:73], v[40:41]
    v_pk_add_f32 v[74:75], v[74:75], v[42:43]
    v_pk_add_f32 v[76:77], v[76:77], v[44:45]
    v_pk_add_f32 v[78:79], v[78:79], v[46:47]
    v_pk_add_f32 v[72:73], v[72:73], v[8:9]
    v_pk_add_f32 v[74:75], v[74:75], v[10:11]
    v_pk_add_f32 v[76:77], v[76:77], v[12:13]
    v_pk_add_f32 v[78:79], v[78:79], v[14:15]
    v_pk_mul_f32 v[88:89], v[72:73], v[72:73]
    v_pk_mul_f32 v[90:91], v[74:75], v[74:75]
    v_pk_mul_f32 v[92:93], v[76:77], v[76:77]
    v_pk_mul_f32 v[94:95], v[78:79], v[78:79]
    v_pk_fma_f32 v[88:89], v[88:89], s[40:41], v[142:143]
    v_pk_fma_f32 v[90:91], v[90:91], s[40:41], v[142:143]
    v_pk_fma_f32 v[92:93], v[92:93], s[40:41], v[142:143]
    v_pk_fma_f32 v[94:95], v[94:95], s[40:41], v[142:143]
    v_pk_mul_f32 v[88:89], v[88:89], v[72:73]
    v_pk_mul_f32 v[90:91], v[90:91], v[74:75]
    v_pk_mul_f32 v[92:93], v[92:93], v[76:77]
    v_pk_mul_f32 v[94:95], v[94:95], v[78:79]
    v_exp_f32 v88, v88
    v_exp_f32 v89, v89
    v_exp_f32 v90, v90
    v_exp_f32 v91, v91
    v_exp_f32 v92, v92
    v_exp_f32 v93, v93
    v_exp_f32 v94, v94
    v_exp_f32 v95, v95
    v_pk_add_f32 v[88:89], v[88:89], 1.0 op_sel_hi:[1,0]
    v_pk_add_f32 v[90:91], v[90:91], 1.0 op_sel_hi:[1,0]
    v_pk_add_f32 v[92:93], v[92:93], 1.0 op_sel_hi:[1,0]
    v_pk_add_f32 v[94:95], v[94:95], 1.0 op_sel_hi:[1,0]
    v_rcp_f32 v88, v88
    v_rcp_f32 v89, v89
    v_rcp_f32 v90, v90
    v_rcp_f32 v91, v91
    v_rcp_f32 v92, v92
    v_rcp_f32 v93, v93
    v_rcp_f32 v94, v94
    v_rcp_f32 v95, v95
    v_pk_mul_f32 v[88:89], v[88:89], v[72:73]
    v_pk_mul_f32 v[90:91], v[90:91], v[74:75]
    v_pk_mul_f32 v[92:93], v[92:93], v[76:77]
    v_pk_mul_f32 v[94:95], v[94:95], v[78:79]
    v_cvt_pk_bf16_f32 v100, v88, v89
    v_cvt_pk_bf16_f32 v101, v90, v91
    v_cvt_pk_bf16_f32 v102, v92, v93
    v_cvt_pk_bf16_f32 v103, v94, v95
    buffer_store_dwordx4 v[100:103], v133, s[20:23], s43 offen offset:512 sc1
L_g1_end:
    s_and_b32 s30, s2, 1
    s_lshl_b32 s30, s30, 2
    s_bfe_u32 s31, s2, 0x20003
    s_add_u32 s25, s30, s31
    s_bfe_u32 s30, s2, 0x20001
    s_lshl_b32 s30, s30, 3
    s_lshr_b32 s31, s2, 5
    s_add_u32 s26, s30, s31
    s_lshl_b32 s47, s26, 3
    s_add_u32 s47, s47, s25
    s_mul_i32 s27, s26, 196608
    s_mul_i32 s30, s3, 49152
    s_add_u32 s27, s27, s30
    s_add_u32 s27, s27, 0xb00000
    s_lshl_b32 s29, s3, 12
    s_cmp_lt_u32 s24, 4
    s_cbranch_scc1 L_g2_c
    v_lshlrev_b32 v0, 4, v252
    v_add_u32 v1, s29, v0
    v_add_u32 v1, 98304, v1
    s_cmp_lt_u32 s2, 240
    s_cbranch_scc1 L_g2_h0
    s_mov_b32 m0, s29
    s_mov_b32 s30, 6
L_g2_dma:
    buffer_load_dwordx4 v0, s[4:7], s27 offen offset:0 sc1 lds
    buffer_load_dwordx4 v0, s[4:7], s27 offen offset:1024 sc1 lds
    buffer_load_dwordx4 v0, s[4:7], s27 offen offset:2048 sc1 lds
    buffer_load_dwordx4 v0, s[4:7], s27 offen offset:3072 sc1 lds
    s_add_u32 m0, m0, 16384
    s_add_u32 s27, s27, 4096
    s_sub_u32 s30, s30, 1
    s_cmp_lg_u32 s30, 0
    s_cbranch_scc1 L_g2_dma
L_g2_h0:
    s_waitcnt vmcnt(0) lgkmcnt(0)
    s_barrier
    ds_write_b128 v1, v[176:179] offset:0
    ds_write_b128 v1, v[180:183] offset:1024
    ds_write_b128 v1, v[184:187] offset:2048
    ds_write_b128 v1, v[188:191] offset:3072
    ds_write_b128 v1, v[192:195] offset:16384
    ds_write_b128 v1, v[196:199] offset:17408
    ds_write_b128 v1, v[200:203] offset:18432
    ds_write_b128 v1, v[204:207] offset:19456
    ds_write_b128 v1, v[208:211] offset:32768
    ds_write_b128 v1, v[212:215] offset:33792
    ds_write_b128 v1, v[216:219] offset:34816
    ds_write_b128 v1, v[220:223] offset:35840
    ds_write_b128 v1, v[224:227] offset:49152
    ds_write_b128 v1, v[228:231] offset:50176
    ds_write_b128 v1, v[232:235] offset:51200
    ds_write_b128 v1, v[236:239] offset:52224
    s_cmp_lg_u32 s91, 0
    s_cbranch_scc1 L_g2_h1
    s_cmp_ge_u32 s2, 240
    s_cbranch_scc1 L_g2_h1
    s_and_b32 s30, s2, 7
    s_mul_i32 s30, s30, 30
    s_lshr_b32 s31, s2, 3
    s_add_u32 s34, s30, s31
    s_mul_i32 s31, s34, 205
    s_lshr_b32 s31, s31, 10
    s_mul_i32 s30, s31, 5
    s_sub_u32 s26, s34, s30
    s_and_b32 s25, s31, 15
    s_lshr_b32 s27, s31, 4
    s_lshl_b32 s30, s25, 2
    s_add_u32 s32, s30, s3
    s_mul_i32 s30, s27, 5
    s_add_u32 s40, s30, s26
    s_lshl_b32 s34, s40, 4
    s_add_u32 s34, s34, s25
    s_mov_b32 s16, s70
    s_mov_b32 s17, s71
    s_mov_b32 s18, 0x258000
    s_mov_b32 s19, 0x20000
    v_lshrrev_b32 v11, 4, v252
    v_and_b32 v12, 15, v252
    v_lshlrev_b32 v13, 2, v11
    v_xor_b32 v12, v12, v13
    v_mul_u32_u24 v11, 3840, v11
    v_lshl_add_u32 v0, v12, 4, v11
    v_add_u32 v1, 14336, v0
    v_add_u32 v2, 28672, v0
    v_add_u32 v3, 43008, v0
    s_lshl_b32 s30, s40, 8
    s_mul_i32 s29, s3, 61440
    s_add_u32 s29, s29, s30
    s_lshl_b32 m0, s3, 12
    s_add_u32 s33, s29, 1474560
    buffer_load_dwordx4 v[112:115], v0, s[16:19], s33 offen offset:0
    buffer_load_dwordx4 v[116:119], v1, s[16:19], s33 offen offset:1024
    buffer_load_dwordx4 v[120:123], v2, s[16:19], s33 offen offset:2048
    buffer_load_dwordx4 v[124:127], v3, s[16:19], s33 offen offset:3072
    s_add_u32 s33, s33, 245760
    buffer_load_dwordx4 v[128:131], v0, s[16:19], s33 offen offset:0
    buffer_load_dwordx4 v[132:135], v1, s[16:19], s33 offen offset:1024
    buffer_load_dwordx4 v[136:139], v2, s[16:19], s33 offen offset:2048
    buffer_load_dwordx4 v[140:143], v3, s[16:19], s33 offen offset:3072
    s_add_u32 s33, s33, 245760
    buffer_load_dwordx4 v[144:147], v0, s[16:19], s33 offen offset:0
    buffer_load_dwordx4 v[148:151], v1, s[16:19], s33 offen offset:1024
    buffer_load_dwordx4 v[152:155], v2, s[16:19], s33 offen offset:2048
    buffer_load_dwordx4 v[156:159], v3, s[16:19], s33 offen offset:3072
    s_add_u32 s33, s33, 245760
    buffer_load_dwordx4 v[160:163], v0, s[16:19], s33 offen offset:0
    buffer_load_dwordx4 v[164:167], v1, s[16:19], s33 offen offset:1024
    buffer_load_dwordx4 v[168:171], v2, s[16:19], s33 offen offset:2048
    buffer_load_dwordx4 v[172:175], v3, s[16:19], s33 offen offset:3072
    s_add_u32 s33, s33, 245760
    s_waitcnt lgkmcnt(0)
    s_barrier
    s_barrier
    s_mov_b32 s30, 3
L_g2_dma2:
    buffer_load_dwordx4 v0, s[16:19], s29 offen offset:0 lds
    buffer_load_dwordx4 v1, s[16:19], s29 offen offset:1024 lds
    buffer_load_dwordx4 v2, s[16:19], s29 offen offset:2048 lds
    buffer_load_dwordx4 v3, s[16:19], s29 offen offset:3072 lds
    s_add_u32 m0, m0, 16384
    s_add_u32 s29, s29, 245760
    s_sub_u32 s30, s30, 1
    s_cmp_lg_u32 s30, 0
    s_cbranch_scc1 L_g2_dma2
    s_barrier
    s_mov_b32 s30, 3
L_g2_dma3:
    buffer_load_dwordx4 v0, s[16:19], s29 offen offset:0 lds
    buffer_load_dwordx4 v1, s[16:19], s29 offen offset:1024 lds
    buffer_load_dwordx4 v2, s[16:19], s29 offen offset:2048 lds
    buffer_load_dwordx4 v3, s[16:19], s29 offen offset:3072 lds
    s_add_u32 m0, m0, 16384
    s_add_u32 s29, s29, 245760
    s_sub_u32 s30, s30, 1
    s_cmp_lg_u32 s30, 0
    s_cbranch_scc1 L_g2_dma3
    s_branch L_next
L_g2_h1:
    s_waitcnt lgkmcnt(0)
    s_barrier
    s_barrier
    s_barrier
    s_cmp_lg_u32 s91, 0
    s_cbranch_scc1 L_end
    s_branch L_next
L_g2_c:
    v_lshlrev_b32 v194, 4, v252
    s_lshl_b32 s30, s3, 10
    s_add_u32 s30, s30, s29
    v_add_u32 v195, s30, v194
    v_xor_b32 v196, 1024, v195
    v_xor_b32 v197, 2048, v195
    v_xor_b32 v198, 3072, v195
    s_mul_i32 s28, s25, 245760
    s_mul_i32 s30, s3, 61440
    s_add_u32 s28, s28, s30
    s_add_u32 s28, s28, 0x1100000
    s_add_u32 s33, s28, 4096
    v_lshrrev_b32 v192, 4, v252
    v_and_b32 v193, 15, v252
    s_lshl_b32 s30, s26, 2
    s_add_u32 s34, s30, s3
    s_mul_i32 s30, s25, 80
    v_cmp_gt_u32 vcc, 2, v192
    v_mov_b32 v181, 0x80000000
    v_lshlrev_b32 v205, 1, v193
    s_lshl_b32 s36, s34, 5
    s_mov_b32 s16, s82
    s_mov_b32 s17, s83
    s_mov_b32 s18, 0x1000
    s_mov_b32 s19, 0x20000
    v_lshlrev_b32 v178, 2, v192
    v_lshl_add_u32 v178, v193, 3, v178
    v_cndmask_b32 v204, v181, v178, vcc
    s_lshr_b32 s30, s30, 6
    s_mul_i32 s44, s30, 24
    s_mul_i32 s31, s3, 6
    s_add_u32 s44, s44, s31
    v_min_u32 v179, 5, v193
    v_and_b32 v178, 1, v192
    v_mad_u32_u24 v179, v178, 24, v179
    v_lshlrev_b32 v206, 7, v179
    s_lshl_b32 s44, s44, 7
    s_add_u32 s44, s44, s96
    s_add_u32 s44, s44, 786432
    v_lshlrev_b32 v176, 2, v192
    v_sub_u32 v176, v193, v176
    v_mov_b32 v179, 0x3f80
    v_mov_b32 v180, 0x3f800000
    v_cmp_eq_i32 vcc, 0, v176
    v_cmp_eq_i32 s[38:39], 1, v176
    s_nop 0
    v_cndmask_b32 v128, 0, v179, vcc
    v_cndmask_b32 v128, v128, v180, s[38:39]
    v_cmp_eq_i32 vcc, 2, v176
    v_cmp_eq_i32 s[38:39], 3, v176
    s_nop 0
    v_cndmask_b32 v129, 0, v179, vcc
    v_cndmask_b32 v129, v129, v180, s[38:39]
    s_xor_b32 s31, s3, 1
    s_mul_i32 s31, s31, 15360
    s_add_u32 s31, s31, 102400
    v_add_u32 v199, s31, v194
    s_xor_b32 s31, s3, 2
    s_mul_i32 s31, s31, 15360
    s_add_u32 s31, s31, 102400
    v_add_u32 v200, s31, v194
    s_xor_b32 s31, s3, 3
    s_mul_i32 s31, s31, 15360
    s_add_u32 s31, s31, 102400
    v_add_u32 v201, s31, v194
    s_lshl_b32 s46, s34, 7
    s_add_u32 s46, s46, 0x60000
    s_cmp_lg_u32 s91, 0
    s_cbranch_scc1 L_g2_o1
    v_and_b32 v176, 3, v193
    v_and_b32 v178, 4, v193
    v_lshl_or_b32 v176, v178, 1, v176
    v_and_b32 v178, 8, v193
    v_lshrrev_b32 v178, 1, v178
    v_or_b32 v176, v176, v178
    v_lshlrev_b32 v176, 4, v176
    v_lshl_add_u32 v202, v192, 9, v176
    v_lshrrev_b32 v178, 1, v192
    v_lshl_add_u32 v176, v178, 9, v176
    v_and_b32 v178, 1, v192
    v_lshl_add_u32 v176, v178, 3, v176
    v_add_u32 v203, 4096, v176
    s_lshr_b32 s45, s34, 1
    s_mul_i32 s45, s45, 40960
    s_and_b32 s31, s34, 1
    s_lshl_b32 s31, s31, 8
    s_add_u32 s45, s45, s31
    s_mul_i32 s31, s25, 5120
    s_add_u32 s45, s45, s31
    s_add_u32 s45, s45, 0x200000
    s_branch L_g2_o2
L_g2_o1:
    v_mul_u32_u24 v177, 1280, v193
    v_lshl_add_u32 v203, v192, 3, v177
    v_lshl_add_u32 v202, v192, 4, v177
    s_mul_i32 s45, s34, 20480
    s_mul_i32 s31, s25, 160
    s_add_u32 s45, s45, s31
L_g2_o2:
    s_mov_b32 s12, s84
    s_mov_b32 s13, s85
    s_mov_b32 s14, 0x280000
    s_mov_b32 s15, 0x20000
    v_mov_b32 v250, s90
    v_lshlrev_b32 v251, 15, v252
    s_waitcnt vmcnt(0) lgkmcnt(0)
    s_barrier
    s_cmp_lg_u32 s24, 3
    s_cbranch_scc1 L_sig53
    s_mov_b64 exec, 1
    buffer_store_dword v250, v251, s[4:7], s97 offen sc1
    s_mov_b64 exec, -1
L_sig53:
    s_lshl_b32 s97, s47, 7
    s_add_u32 s97, s97, s96
    s_add_u32 s97, s97, 1048576
    s_barrier
    s_mov_b32 s61, 0x40000
L_poll54:
    buffer_load_dword v250, v206, s[4:7], s44 offen sc1
    s_sub_u32 s61, s61, 1
    s_waitcnt vmcnt(0)
    s_cbranch_scc1 L_pollx55
    v_cmp_ne_u32 vcc, s90, v250
    s_cbranch_vccz L_pollx55
    s_mov_b64 exec, vcc
    s_sleep 1
    s_branch L_poll54
L_pollx55:
    s_mov_b64 exec, -1
    buffer_load_ushort v205, v205, s[16:19], s36 offen
    buffer_load_dwordx4 v[0:3], v194, s[20:23], s28 offen offset:0 sc1
    buffer_load_dwordx4 v[4:7], v194, s[20:23], s28 offen offset:1024 sc1
    buffer_load_dwordx4 v[8:11], v194, s[20:23], s28 offen offset:2048 sc1
    buffer_load_dwordx4 v[12:15], v194, s[20:23], s28 offen offset:3072 sc1
    buffer_load_dwordx4 v[16:19], v194, s[20:23], s33 offen sc1
    s_add_u32 s28, s28, 5120
    s_add_u32 s33, s33, 5120
    ds_read_b128 v[160:163], v195 offset:0
    ds_read_b128 v[164:167], v196 offset:0
    ds_read_b128 v[168:171], v197 offset:0
    ds_read_b128 v[172:175], v198 offset:0
    buffer_load_dwordx4 v[20:23], v194, s[20:23], s28 offen offset:0 sc1
    buffer_load_dwordx4 v[24:27], v194, s[20:23], s28 offen offset:1024 sc1
    buffer_load_dwordx4 v[28:31], v194, s[20:23], s28 offen offset:2048 sc1
    buffer_load_dwordx4 v[32:35], v194, s[20:23], s28 offen offset:3072 sc1
    buffer_load_dwordx4 v[36:39], v194, s[20:23], s33 offen sc1
    s_add_u32 s28, s28, 5120
    s_add_u32 s33, s33, 5120
    buffer_load_dwordx4 v[40:43], v194, s[20:23], s28 offen offset:0 sc1
    buffer_load_dwordx4 v[44:47], v194, s[20:23], s28 offen offset:1024 sc1
    buffer_load_dwordx4 v[48:51], v194, s[20:23], s28 offen offset:2048 sc1
    buffer_load_dwordx4 v[52:55], v194, s[20:23], s28 offen offset:3072 sc1
    buffer_load_dwordx4 v[56:59], v194, s[20:23], s33 offen sc1
    s_add_u32 s28, s28, 5120
    s_add_u32 s33, s33, 5120
    buffer_load_dwordx4 v[60:63], v194, s[20:23], s28 offen offset:0 sc1
    buffer_load_dwordx4 v[64:67], v194, s[20:23], s28 offen offset:1024 sc1
    buffer_load_dwordx4 v[68:71], v194, s[20:23], s28 offen offset:2048 sc1
    buffer_load_dwordx4 v[72:75], v194, s[20:23], s28 offen offset:3072 sc1
    buffer_load_dwordx4 v[76:79], v194, s[20:23], s33 offen sc1
    s_add_u32 s28, s28, 5120
    s_add_u32 s33, s33, 5120
    s_waitcnt vmcnt(15) lgkmcnt(0)
    v_lshlrev_b32 v124, 16, v205
    v_lshlrev_b32 v125, 16, v205
    v_lshlrev_b32 v126, 16, v205
    v_lshlrev_b32 v127, 16, v205
    s_nop 1
    v_mfma_f32_16x16x16_bf16 v[80:83], v[240:241], v[128:129], v[124:127]
    v_mfma_f32_16x16x16_bf16 v[84:87], v[242:243], v[128:129], v[124:127]
    v_mfma_f32_16x16x16_bf16 v[88:91], v[244:245], v[128:129], v[124:127]
    v_mfma_f32_16x16x16_bf16 v[92:95], v[246:247], v[128:129], v[124:127]
    v_mfma_f32_16x16x16_bf16 v[96:99], v[248:249], v[128:129], v[124:127]
    v_mfma_f32_16x16x32_bf16 v[80:83], v[0:3], v[160:163], v[80:83]
    ds_read_b128 v[176:179], v195 offset:16384
    v_mfma_f32_16x16x32_bf16 v[100:103], v[0:3], v[164:167], 0
    ds_read_b128 v[180:183], v196 offset:16384
    v_mfma_f32_16x16x32_bf16 v[120:123], v[0:3], v[168:171], 0
    ds_read_b128 v[184:187], v197 offset:16384
    v_mfma_f32_16x16x32_bf16 v[140:143], v[0:3], v[172:175], 0
    ds_read_b128 v[188:191], v198 offset:16384
    v_mfma_f32_16x16x32_bf16 v[84:87], v[4:7], v[160:163], v[84:87]
    buffer_load_dwordx4 v[0:3], v194, s[20:23], s28 offen offset:0 sc1
    v_mfma_f32_16x16x32_bf16 v[104:107], v[4:7], v[164:167], 0
    v_mfma_f32_16x16x32_bf16 v[124:127], v[4:7], v[168:171], 0
    v_mfma_f32_16x16x32_bf16 v[144:147], v[4:7], v[172:175], 0
    v_mfma_f32_16x16x32_bf16 v[88:91], v[8:11], v[160:163], v[88:91]
    buffer_load_dwordx4 v[4:7], v194, s[20:23], s28 offen offset:1024 sc1
    v_mfma_f32_16x16x32_bf16 v[108:111], v[8:11], v[164:167], 0
    v_mfma_f32_16x16x32_bf16 v[128:131], v[8:11], v[168:171], 0
    v_mfma_f32_16x16x32_bf16 v[148:151], v[8:11], v[172:175], 0
    v_mfma_f32_16x16x32_bf16 v[92:95], v[12:15], v[160:163], v[92:95]
    buffer_load_dwordx4 v[8:11], v194, s[20:23], s28 offen offset:2048 sc1
    v_mfma_f32_16x16x32_bf16 v[112:115], v[12:15], v[164:167], 0
    v_mfma_f32_16x16x32_bf16 v[132:135], v[12:15], v[168:171], 0
    v_mfma_f32_16x16x32_bf16 v[152:155], v[12:15], v[172:175], 0
    v_mfma_f32_16x16x32_bf16 v[96:99], v[16:19], v[160:163], v[96:99]
    buffer_load_dwordx4 v[12:15], v194, s[20:23], s28 offen offset:3072 sc1
    v_mfma_f32_16x16x32_bf16 v[116:119], v[16:19], v[164:167], 0
    v_mfma_f32_16x16x32_bf16 v[136:139], v[16:19], v[168:171], 0
    v_mfma_f32_16x16x32_bf16 v[156:159], v[16:19], v[172:175], 0
    buffer_load_dwordx4 v[16:19], v194, s[20:23], s33 offen sc1
    s_add_u32 s28, s28, 5120
    s_add_u32 s33, s33, 5120
    s_waitcnt vmcnt(15) lgkmcnt(0)
    v_mfma_f32_16x16x32_bf16 v[80:83], v[20:23], v[176:179], v[80:83]
    ds_read_b128 v[160:163], v195 offset:32768
    v_mfma_f32_16x16x32_bf16 v[100:103], v[20:23], v[180:183], v[100:103]
    ds_read_b128 v[164:167], v196 offset:32768
    v_mfma_f32_16x16x32_bf16 v[120:123], v[20:23], v[184:187], v[120:123]
    ds_read_b128 v[168:171], v197 offset:32768
    v_mfma_f32_16x16x32_bf16 v[140:143], v[20:23], v[188:191], v[140:143]
    ds_read_b128 v[172:175], v198 offset:32768
    v_mfma_f32_16x16x32_bf16 v[84:87], v[24:27], v[176:179], v[84:87]
    buffer_load_dwordx4 v[20:23], v194, s[20:23], s28 offen offset:0 sc1
    v_mfma_f32_16x16x32_bf16 v[104:107], v[24:27], v[180:183], v[104:107]
    v_mfma_f32_16x16x32_bf16 v[124:127], v[24:27], v[184:187], v[124:127]
    v_mfma_f32_16x16x32_bf16 v[144:147], v[24:27], v[188:191], v[144:147]
    v_mfma_f32_16x16x32_bf16 v[88:91], v[28:31], v[176:179], v[88:91]
    buffer_load_dwordx4 v[24:27], v194, s[20:23], s28 offen offset:1024 sc1
    v_mfma_f32_16x16x32_bf16 v[108:111], v[28:31], v[180:183], v[108:111]
    v_mfma_f32_16x16x32_bf16 v[128:131], v[28:31], v[184:187], v[128:131]
    v_mfma_f32_16x16x32_bf16 v[148:151], v[28:31], v[188:191], v[148:151]
    v_mfma_f32_16x16x32_bf16 v[92:95], v[32:35], v[176:179], v[92:95]
    buffer_load_dwordx4 v[28:31], v194, s[20:23], s28 offen offset:2048 sc1
    v_mfma_f32_16x16x32_bf16 v[112:115], v[32:35], v[180:183], v[112:115]
    v_mfma_f32_16x16x32_bf16 v[132:135], v[32:35], v[184:187], v[132:135]
    v_mfma_f32_16x16x32_bf16 v[152:155], v[32:35], v[188:191], v[152:155]
    v_mfma_f32_16x16x32_bf16 v[96:99], v[36:39], v[176:179], v[96:99]
    buffer_load_dwordx4 v[32:35], v194, s[20:23], s28 offen offset:3072 sc1
    v_mfma_f32_16x16x32_bf16 v[116:119], v[36:39], v[180:183], v[116:119]
    v_mfma_f32_16x16x32_bf16 v[136:139], v[36:39], v[184:187], v[136:139]
    v_mfma_f32_16x16x32_bf16 v[156:159], v[36:39], v[188:191], v[156:159]
    buffer_load_dwordx4 v[36:39], v194, s[20:23], s33 offen sc1
    s_add_u32 s28, s28, 5120
    s_add_u32 s33, s33, 5120
    s_waitcnt vmcnt(15) lgkmcnt(0)
    v_mfma_f32_16x16x32_bf16 v[80:83], v[40:43], v[160:163], v[80:83]
    ds_read_b128 v[176:179], v195 offset:49152
    v_mfma_f32_16x16x32_bf16 v[100:103], v[40:43], v[164:167], v[100:103]
    ds_read_b128 v[180:183], v196 offset:49152
    v_mfma_f32_16x16x32_bf16 v[120:123], v[40:43], v[168:171], v[120:123]
    ds_read_b128 v[184:187], v197 offset:49152
    v_mfma_f32_16x16x32_bf16 v[140:143], v[40:43], v[172:175], v[140:143]
    ds_read_b128 v[188:191], v198 offset:49152
    v_mfma_f32_16x16x32_bf16 v[84:87], v[44:47], v[160:163], v[84:87]
    buffer_load_dwordx4 v[40:43], v194, s[20:23], s28 offen offset:0 sc1
    v_mfma_f32_16x16x32_bf16 v[104:107], v[44:47], v[164:167], v[104:107]
    v_mfma_f32_16x16x32_bf16 v[124:127], v[44:47], v[168:171], v[124:127]
    v_mfma_f32_16x16x32_bf16 v[144:147], v[44:47], v[172:175], v[144:147]
    v_mfma_f32_16x16x32_bf16 v[88:91], v[48:51], v[160:163], v[88:91]
    buffer_load_dwordx4 v[44:47], v194, s[20:23], s28 offen offset:1024 sc1
    v_mfma_f32_16x16x32_bf16 v[108:111], v[48:51], v[164:167], v[108:111]
    v_mfma_f32_16x16x32_bf16 v[128:131], v[48:51], v[168:171], v[128:131]
    v_mfma_f32_16x16x32_bf16 v[148:151], v[48:51], v[172:175], v[148:151]
    v_mfma_f32_16x16x32_bf16 v[92:95], v[52:55], v[160:163], v[92:95]
    buffer_load_dwordx4 v[48:51], v194, s[20:23], s28 offen offset:2048 sc1
    v_mfma_f32_16x16x32_bf16 v[112:115], v[52:55], v[164:167], v[112:115]
    v_mfma_f32_16x16x32_bf16 v[132:135], v[52:55], v[168:171], v[132:135]
    v_mfma_f32_16x16x32_bf16 v[152:155], v[52:55], v[172:175], v[152:155]
    v_mfma_f32_16x16x32_bf16 v[96:99], v[56:59], v[160:163], v[96:99]
    buffer_load_dwordx4 v[52:55], v194, s[20:23], s28 offen offset:3072 sc1
    v_mfma_f32_16x16x32_bf16 v[116:119], v[56:59], v[164:167], v[116:119]
    v_mfma_f32_16x16x32_bf16 v[136:139], v[56:59], v[168:171], v[136:139]
    v_mfma_f32_16x16x32_bf16 v[156:159], v[56:59], v[172:175], v[156:159]
    buffer_load_dwordx4 v[56:59], v194, s[20:23], s33 offen sc1
    s_add_u32 s28, s28, 5120
    s_add_u32 s33, s33, 5120
    s_waitcnt vmcnt(15) lgkmcnt(0)
    v_mfma_f32_16x16x32_bf16 v[80:83], v[60:63], v[176:179], v[80:83]
    v_add_u32 v195, 0x10000, v195
    v_mfma_f32_16x16x32_bf16 v[100:103], v[60:63], v[180:183], v[100:103]
    v_add_u32 v196, 0x10000, v196
    v_mfma_f32_16x16x32_bf16 v[120:123], v[60:63], v[184:187], v[120:123]
    v_add_u32 v197, 0x10000, v197
    v_mfma_f32_16x16x32_bf16 v[140:143], v[60:63], v[188:191], v[140:143]
    v_add_u32 v198, 0x10000, v198
    v_mfma_f32_16x16x32_bf16 v[84:87], v[64:67], v[176:179], v[84:87]
    buffer_load_dwordx4 v[60:63], v194, s[20:23], s28 offen offset:0 sc1
    v_mfma_f32_16x16x32_bf16 v[104:107], v[64:67], v[180:183], v[104:107]
    ds_read_b128 v[160:163], v195 offset:0
    v_mfma_f32_16x16x32_bf16 v[124:127], v[64:67], v[184:187], v[124:127]
    ds_read_b128 v[164:167], v196 offset:0
    v_mfma_f32_16x16x32_bf16 v[144:147], v[64:67], v[188:191], v[144:147]
    ds_read_b128 v[168:171], v197 offset:0
    v_mfma_f32_16x16x32_bf16 v[88:91], v[68:71], v[176:179], v[88:91]
    buffer_load_dwordx4 v[64:67], v194, s[20:23], s28 offen offset:1024 sc1
    v_mfma_f32_16x16x32_bf16 v[108:111], v[68:71], v[180:183], v[108:111]
    ds_read_b128 v[172:175], v198 offset:0
    v_mfma_f32_16x16x32_bf16 v[128:131], v[68:71], v[184:187], v[128:131]
    v_mfma_f32_16x16x32_bf16 v[148:151], v[68:71], v[188:191], v[148:151]
    v_mfma_f32_16x16x32_bf16 v[92:95], v[72:75], v[176:179], v[92:95]
    buffer_load_dwordx4 v[68:71], v194, s[20:23], s28 offen offset:2048 sc1
    v_mfma_f32_16x16x32_bf16 v[112:115], v[72:75], v[180:183], v[112:115]
    v_mfma_f32_16x16x32_bf16 v[132:135], v[72:75], v[184:187], v[132:135]
    v_mfma_f32_16x16x32_bf16 v[152:155], v[72:75], v[188:191], v[152:155]
    v_mfma_f32_16x16x32_bf16 v[96:99], v[76:79], v[176:179], v[96:99]
    buffer_load_dwordx4 v[72:75], v194, s[20:23], s28 offen offset:3072 sc1
    v_mfma_f32_16x16x32_bf16 v[116:119], v[76:79], v[180:183], v[116:119]
    v_mfma_f32_16x16x32_bf16 v[136:139], v[76:79], v[184:187], v[136:139]
    v_mfma_f32_16x16x32_bf16 v[156:159], v[76:79], v[188:191], v[156:159]
    buffer_load_dwordx4 v[76:79], v194, s[20:23], s33 offen sc1
    s_add_u32 s28, s28, 5120
    s_add_u32 s33, s33, 5120
    s_waitcnt vmcnt(15) lgkmcnt(0)
    v_mfma_f32_16x16x32_bf16 v[80:83], v[0:3], v[160:163], v[80:83]
    ds_read_b128 v[176:179], v195 offset:16384
    v_mfma_f32_16x16x32_bf16 v[100:103], v[0:3], v[164:167], v[100:103]
    ds_read_b128 v[180:183], v196 offset:16384
    v_mfma_f32_16x16x32_bf16 v[120:123], v[0:3], v[168:171], v[120:123]
    ds_read_b128 v[184:187], v197 offset:16384
    v_mfma_f32_16x16x32_bf16 v[140:143], v[0:3], v[172:175], v[140:143]
    ds_read_b128 v[188:191], v198 offset:16384
    v_mfma_f32_16x16x32_bf16 v[84:87], v[4:7], v[160:163], v[84:87]
    buffer_load_dwordx4 v[0:3], v194, s[20:23], s28 offen offset:0 sc1
    v_mfma_f32_16x16x32_bf16 v[104:107], v[4:7], v[164:167], v[104:107]
    v_mfma_f32_16x16x32_bf16 v[124:127], v[4:7], v[168:171], v[124:127]
    v_mfma_f32_16x16x32_bf16 v[144:147], v[4:7], v[172:175], v[144:147]
    v_mfma_f32_16x16x32_bf16 v[88:91], v[8:11], v[160:163], v[88:91]
    buffer_load_dwordx4 v[4:7], v194, s[20:23], s28 offen offset:1024 sc1
    v_mfma_f32_16x16x32_bf16 v[108:111], v[8:11], v[164:167], v[108:111]
    v_mfma_f32_16x16x32_bf16 v[128:131], v[8:11], v[168:171], v[128:131]
    v_mfma_f32_16x16x32_bf16 v[148:151], v[8:11], v[172:175], v[148:151]
    v_mfma_f32_16x16x32_bf16 v[92:95], v[12:15], v[160:163], v[92:95]
    buffer_load_dwordx4 v[8:11], v194, s[20:23], s28 offen offset:2048 sc1
    v_mfma_f32_16x16x32_bf16 v[112:115], v[12:15], v[164:167], v[112:115]
    v_mfma_f32_16x16x32_bf16 v[132:135], v[12:15], v[168:171], v[132:135]
    v_mfma_f32_16x16x32_bf16 v[152:155], v[12:15], v[172:175], v[152:155]
    v_mfma_f32_16x16x32_bf16 v[96:99], v[16:19], v[160:163], v[96:99]
    buffer_load_dwordx4 v[12:15], v194, s[20:23], s28 offen offset:3072 sc1
    v_mfma_f32_16x16x32_bf16 v[116:119], v[16:19], v[164:167], v[116:119]
    v_mfma_f32_16x16x32_bf16 v[136:139], v[16:19], v[168:171], v[136:139]
    v_mfma_f32_16x16x32_bf16 v[156:159], v[16:19], v[172:175], v[156:159]
    buffer_load_dwordx4 v[16:19], v194, s[20:23], s33 offen sc1
    s_add_u32 s28, s28, 5120
    s_add_u32 s33, s33, 5120
    s_waitcnt vmcnt(15) lgkmcnt(0)
    v_mfma_f32_16x16x32_bf16 v[80:83], v[20:23], v[176:179], v[80:83]
    ds_read_b128 v[160:163], v195 offset:32768
    v_mfma_f32_16x16x32_bf16 v[100:103], v[20:23], v[180:183], v[100:103]
    ds_read_b128 v[164:167], v196 offset:32768
    v_mfma_f32_16x16x32_bf16 v[120:123], v[20:23], v[184:187], v[120:123]
    ds_read_b128 v[168:171], v197 offset:32768
    v_mfma_f32_16x16x32_bf16 v[140:143], v[20:23], v[188:191], v[140:143]
    ds_read_b128 v[172:175], v198 offset:32768
    v_mfma_f32_16x16x32_bf16 v[84:87], v[24:27], v[176:179], v[84:87]
    buffer_load_dwordx4 v[20:23], v194, s[20:23], s28 offen offset:0 sc1
    v_mfma_f32_16x16x32_bf16 v[104:107], v[24:27], v[180:183], v[104:107]
    v_mfma_f32_16x16x32_bf16 v[124:127], v[24:27], v[184:187], v[124:127]
    v_mfma_f32_16x16x32_bf16 v[144:147], v[24:27], v[188:191], v[144:147]
    v_mfma_f32_16x16x32_bf16 v[88:91], v[28:31], v[176:179], v[88:91]
    buffer_load_dwordx4 v[24:27], v194, s[20:23], s28 offen offset:1024 sc1
    v_mfma_f32_16x16x32_bf16 v[108:111], v[28:31], v[180:183], v[108:111]
    v_mfma_f32_16x16x32_bf16 v[128:131], v[28:31], v[184:187], v[128:131]
    v_mfma_f32_16x16x32_bf16 v[148:151], v[28:31], v[188:191], v[148:151]
    v_mfma_f32_16x16x32_bf16 v[92:95], v[32:35], v[176:179], v[92:95]
    buffer_load_dwordx4 v[28:31], v194, s[20:23], s28 offen offset:2048 sc1
    v_mfma_f32_16x16x32_bf16 v[112:115], v[32:35], v[180:183], v[112:115]
    v_mfma_f32_16x16x32_bf16 v[132:135], v[32:35], v[184:187], v[132:135]
    v_mfma_f32_16x16x32_bf16 v[152:155], v[32:35], v[188:191], v[152:155]
    v_mfma_f32_16x16x32_bf16 v[96:99], v[36:39], v[176:179], v[96:99]
    buffer_load_dwordx4 v[32:35], v194, s[20:23], s28 offen offset:3072 sc1
    v_mfma_f32_16x16x32_bf16 v[116:119], v[36:39], v[180:183], v[116:119]
    v_mfma_f32_16x16x32_bf16 v[136:139], v[36:39], v[184:187], v[136:139]
    v_mfma_f32_16x16x32_bf16 v[156:159], v[36:39], v[188:191], v[156:159]
    buffer_load_dwordx4 v[36:39], v194, s[20:23], s33 offen sc1
    s_add_u32 s28, s28, 5120
    s_add_u32 s33, s33, 5120
    s_waitcnt vmcnt(15) lgkmcnt(0)
    v_mfma_f32_16x16x32_bf16 v[80:83], v[40:43], v[160:163], v[80:83]
    ds_read_b128 v[176:179], v195 offset:49152
    v_mfma_f32_16x16x32_bf16 v[100:103], v[40:43], v[164:167], v[100:103]
    ds_read_b128 v[180:183], v196 offset:49152
    v_mfma_f32_16x16x32_bf16 v[120:123], v[40:43], v[168:171], v[120:123]
    ds_read_b128 v[184:187], v197 offset:49152
    v_mfma_f32_16x16x32_bf16 v[140:143], v[40:43], v[172:175], v[140:143]
    ds_read_b128 v[188:191], v198 offset:49152
    v_mfma_f32_16x16x32_bf16 v[84:87], v[44:47], v[160:163], v[84:87]
    buffer_load_dwordx4 v[40:43], v194, s[20:23], s28 offen offset:0 sc1
    v_mfma_f32_16x16x32_bf16 v[104:107], v[44:47], v[164:167], v[104:107]
    v_mfma_f32_16x16x32_bf16 v[124:127], v[44:47], v[168:171], v[124:127]
    v_mfma_f32_16x16x32_bf16 v[144:147], v[44:47], v[172:175], v[144:147]
    v_mfma_f32_16x16x32_bf16 v[88:91], v[48:51], v[160:163], v[88:91]
    buffer_load_dwordx4 v[44:47], v194, s[20:23], s28 offen offset:1024 sc1
    v_mfma_f32_16x16x32_bf16 v[108:111], v[48:51], v[164:167], v[108:111]
    v_mfma_f32_16x16x32_bf16 v[128:131], v[48:51], v[168:171], v[128:131]
    v_mfma_f32_16x16x32_bf16 v[148:151], v[48:51], v[172:175], v[148:151]
    v_mfma_f32_16x16x32_bf16 v[92:95], v[52:55], v[160:163], v[92:95]
    buffer_load_dwordx4 v[48:51], v194, s[20:23], s28 offen offset:2048 sc1
    v_mfma_f32_16x16x32_bf16 v[112:115], v[52:55], v[164:167], v[112:115]
    v_mfma_f32_16x16x32_bf16 v[132:135], v[52:55], v[168:171], v[132:135]
    v_mfma_f32_16x16x32_bf16 v[152:155], v[52:55], v[172:175], v[152:155]
    v_mfma_f32_16x16x32_bf16 v[96:99], v[56:59], v[160:163], v[96:99]
    buffer_load_dwordx4 v[52:55], v194, s[20:23], s28 offen offset:3072 sc1
    v_mfma_f32_16x16x32_bf16 v[116:119], v[56:59], v[164:167], v[116:119]
    v_mfma_f32_16x16x32_bf16 v[136:139], v[56:59], v[168:171], v[136:139]
    v_mfma_f32_16x16x32_bf16 v[156:159], v[56:59], v[172:175], v[156:159]
    buffer_load_dwordx4 v[56:59], v194, s[20:23], s33 offen sc1
    s_add_u32 s28, s28, 5120
    s_add_u32 s33, s33, 5120
    s_waitcnt vmcnt(15) lgkmcnt(0)
    v_mfma_f32_16x16x32_bf16 v[80:83], v[60:63], v[176:179], v[80:83]
    v_add_u32 v195, 0x10000, v195
    v_mfma_f32_16x16x32_bf16 v[100:103], v[60:63], v[180:183], v[100:103]
    v_add_u32 v196, 0x10000, v196
    v_mfma_f32_16x16x32_bf16 v[120:123], v[60:63], v[184:187], v[120:123]
    v_add_u32 v197, 0x10000, v197
    v_mfma_f32_16x16x32_bf16 v[140:143], v[60:63], v[188:191], v[140:143]
    v_add_u32 v198, 0x10000, v198
    v_mfma_f32_16x16x32_bf16 v[84:87], v[64:67], v[176:179], v[84:87]
    buffer_load_dwordx4 v[60:63], v194, s[20:23], s28 offen offset:0 sc1
    v_mfma_f32_16x16x32_bf16 v[104:107], v[64:67], v[180:183], v[104:107]
    ds_read_b128 v[160:163], v195 offset:0
    v_mfma_f32_16x16x32_bf16 v[124:127], v[64:67], v[184:187], v[124:127]
    ds_read_b128 v[164:167], v196 offset:0
    v_mfma_f32_16x16x32_bf16 v[144:147], v[64:67], v[188:191], v[144:147]
    ds_read_b128 v[168:171], v197 offset:0
    v_mfma_f32_16x16x32_bf16 v[88:91], v[68:71], v[176:179], v[88:91]
    buffer_load_dwordx4 v[64:67], v194, s[20:23], s28 offen offset:1024 sc1
    v_mfma_f32_16x16x32_bf16 v[108:111], v[68:71], v[180:183], v[108:111]
    ds_read_b128 v[172:175], v198 offset:0
    v_mfma_f32_16x16x32_bf16 v[128:131], v[68:71], v[184:187], v[128:131]
    v_mfma_f32_16x16x32_bf16 v[148:151], v[68:71], v[188:191], v[148:151]
    v_mfma_f32_16x16x32_bf16 v[92:95], v[72:75], v[176:179], v[92:95]
    buffer_load_dwordx4 v[68:71], v194, s[20:23], s28 offen offset:2048 sc1
    v_mfma_f32_16x16x32_bf16 v[112:115], v[72:75], v[180:183], v[112:115]
    v_mfma_f32_16x16x32_bf16 v[132:135], v[72:75], v[184:187], v[132:135]
    v_mfma_f32_16x16x32_bf16 v[152:155], v[72:75], v[188:191], v[152:155]
    v_mfma_f32_16x16x32_bf16 v[96:99], v[76:79], v[176:179], v[96:99]
    buffer_load_dwordx4 v[72:75], v194, s[20:23], s28 offen offset:3072 sc1
    v_mfma_f32_16x16x32_bf16 v[116:119], v[76:79], v[180:183], v[116:119]
    v_mfma_f32_16x16x32_bf16 v[136:139], v[76:79], v[184:187], v[136:139]
    v_mfma_f32_16x16x32_bf16 v[156:159], v[76:79], v[188:191], v[156:159]
    buffer_load_dwordx4 v[76:79], v194, s[20:23], s33 offen sc1
    s_add_u32 s28, s28, 5120
    s_add_u32 s33, s33, 5120
    s_waitcnt vmcnt(15) lgkmcnt(0)
    v_mfma_f32_16x16x32_bf16 v[80:83], v[0:3], v[160:163], v[80:83]
    ds_read_b128 v[176:179], v195 offset:16384
    v_mfma_f32_16x16x32_bf16 v[100:103], v[0:3], v[164:167], v[100:103]
    ds_read_b128 v[180:183], v196 offset:16384
    v_mfma_f32_16x16x32_bf16 v[120:123], v[0:3], v[168:171], v[120:123]
    ds_read_b128 v[184:187], v197 offset:16384
    v_mfma_f32_16x16x32_bf16 v[140:143], v[0:3], v[172:175], v[140:143]
    ds_read_b128 v[188:191], v198 offset:16384
    v_mfma_f32_16x16x32_bf16 v[84:87], v[4:7], v[160:163], v[84:87]
    v_mfma_f32_16x16x32_bf16 v[104:107], v[4:7], v[164:167], v[104:107]
    v_mfma_f32_16x16x32_bf16 v[124:127], v[4:7], v[168:171], v[124:127]
    v_mfma_f32_16x16x32_bf16 v[144:147], v[4:7], v[172:175], v[144:147]
    v_mfma_f32_16x16x32_bf16 v[88:91], v[8:11], v[160:163], v[88:91]
    v_mfma_f32_16x16x32_bf16 v[108:111], v[8:11], v[164:167], v[108:111]
    v_mfma_f32_16x16x32_bf16 v[128:131], v[8:11], v[168:171], v[128:131]
    v_mfma_f32_16x16x32_bf16 v[148:151], v[8:11], v[172:175], v[148:151]
    v_mfma_f32_16x16x32_bf16 v[92:95], v[12:15], v[160:163], v[92:95]
    v_mfma_f32_16x16x32_bf16 v[112:115], v[12:15], v[164:167], v[112:115]
    v_mfma_f32_16x16x32_bf16 v[132:135], v[12:15], v[168:171], v[132:135]
    v_mfma_f32_16x16x32_bf16 v[152:155], v[12:15], v[172:175], v[152:155]
    v_mfma_f32_16x16x32_bf16 v[96:99], v[16:19], v[160:163], v[96:99]
    v_mfma_f32_16x16x32_bf16 v[116:119], v[16:19], v[164:167], v[116:119]
    v_mfma_f32_16x16x32_bf16 v[136:139], v[16:19], v[168:171], v[136:139]
    v_mfma_f32_16x16x32_bf16 v[156:159], v[16:19], v[172:175], v[156:159]
    s_waitcnt vmcnt(10) lgkmcnt(0)
    s_barrier
    v_mfma_f32_16x16x32_bf16 v[80:83], v[20:23], v[176:179], v[80:83]
    v_mfma_f32_16x16x32_bf16 v[100:103], v[20:23], v[180:183], v[100:103]
    v_mfma_f32_16x16x32_bf16 v[120:123], v[20:23], v[184:187], v[120:123]
    v_mfma_f32_16x16x32_bf16 v[140:143], v[20:23], v[188:191], v[140:143]
    v_mfma_f32_16x16x32_bf16 v[84:87], v[24:27], v[176:179], v[84:87]
    v_mfma_f32_16x16x32_bf16 v[104:107], v[24:27], v[180:183], v[104:107]
    v_mfma_f32_16x16x32_bf16 v[124:127], v[24:27], v[184:187], v[124:127]
    v_mfma_f32_16x16x32_bf16 v[144:147], v[24:27], v[188:191], v[144:147]
    v_mfma_f32_16x16x32_bf16 v[88:91], v[28:31], v[176:179], v[88:91]
    v_mfma_f32_16x16x32_bf16 v[108:111], v[28:31], v[180:183], v[108:111]
    v_mfma_f32_16x16x32_bf16 v[128:131], v[28:31], v[184:187], v[128:131]
    v_mfma_f32_16x16x32_bf16 v[148:151], v[28:31], v[188:191], v[148:151]
    v_mfma_f32_16x16x32_bf16 v[92:95], v[32:35], v[176:179], v[92:95]
    v_mfma_f32_16x16x32_bf16 v[112:115], v[32:35], v[180:183], v[112:115]
    v_mfma_f32_16x16x32_bf16 v[132:135], v[32:35], v[184:187], v[132:135]
    v_mfma_f32_16x16x32_bf16 v[152:155], v[32:35], v[188:191], v[152:155]
    v_mfma_f32_16x16x32_bf16 v[96:99], v[36:39], v[176:179], v[96:99]
    v_mfma_f32_16x16x32_bf16 v[116:119], v[36:39], v[180:183], v[116:119]
    v_mfma_f32_16x16x32_bf16 v[136:139], v[36:39], v[184:187], v[136:139]
    v_mfma_f32_16x16x32_bf16 v[156:159], v[36:39], v[188:191], v[156:159]
    s_waitcnt vmcnt(5) lgkmcnt(0)
    v_mfma_f32_16x16x32_bf16 v[80:83], v[40:43], v[208:211], v[80:83]
    v_mfma_f32_16x16x32_bf16 v[100:103], v[40:43], v[212:215], v[100:103]
    v_mfma_f32_16x16x32_bf16 v[120:123], v[40:43], v[216:219], v[120:123]
    v_mfma_f32_16x16x32_bf16 v[140:143], v[40:43], v[220:223], v[140:143]
    v_mfma_f32_16x16x32_bf16 v[84:87], v[44:47], v[208:211], v[84:87]
    v_mfma_f32_16x16x32_bf16 v[104:107], v[44:47], v[212:215], v[104:107]
    v_mfma_f32_16x16x32_bf16 v[124:127], v[44:47], v[216:219], v[124:127]
    v_mfma_f32_16x16x32_bf16 v[144:147], v[44:47], v[220:223], v[144:147]
    v_mfma_f32_16x16x32_bf16 v[88:91], v[48:51], v[208:211], v[88:91]
    v_mfma_f32_16x16x32_bf16 v[108:111], v[48:51], v[212:215], v[108:111]
    v_mfma_f32_16x16x32_bf16 v[128:131], v[48:51], v[216:219], v[128:131]
    v_mfma_f32_16x16x32_bf16 v[148:151], v[48:51], v[220:223], v[148:151]
    v_mfma_f32_16x16x32_bf16 v[92:95], v[52:55], v[208:211], v[92:95]
    v_mfma_f32_16x16x32_bf16 v[112:115], v[52:55], v[212:215], v[112:115]
    v_mfma_f32_16x16x32_bf16 v[132:135], v[52:55], v[216:219], v[132:135]
    v_mfma_f32_16x16x32_bf16 v[152:155], v[52:55], v[220:223], v[152:155]
    v_mfma_f32_16x16x32_bf16 v[96:99], v[56:59], v[208:211], v[96:99]
    v_mfma_f32_16x16x32_bf16 v[116:119], v[56:59], v[212:215], v[116:119]
    v_mfma_f32_16x16x32_bf16 v[136:139], v[56:59], v[216:219], v[136:139]
    v_mfma_f32_16x16x32_bf16 v[156:159], v[56:59], v[220:223], v[156:159]
    s_waitcnt vmcnt(0) lgkmcnt(0)
    v_mfma_f32_16x16x32_bf16 v[100:103], v[60:63], v[228:231], v[100:103]
    v_mfma_f32_16x16x32_bf16 v[104:107], v[64:67], v[228:231], v[104:107]
    v_mfma_f32_16x16x32_bf16 v[108:111], v[68:71], v[228:231], v[108:111]
    v_mfma_f32_16x16x32_bf16 v[112:115], v[72:75], v[228:231], v[112:115]
    v_mfma_f32_16x16x32_bf16 v[116:119], v[76:79], v[228:231], v[116:119]
    v_mfma_f32_16x16x32_bf16 v[120:123], v[60:63], v[232:235], v[120:123]
    v_mfma_f32_16x16x32_bf16 v[124:127], v[64:67], v[232:235], v[124:127]
    v_mfma_f32_16x16x32_bf16 v[128:131], v[68:71], v[232:235], v[128:131]
    v_mfma_f32_16x16x32_bf16 v[132:135], v[72:75], v[232:235], v[132:135]
    v_mfma_f32_16x16x32_bf16 v[136:139], v[76:79], v[232:235], v[136:139]
    v_mfma_f32_16x16x32_bf16 v[140:143], v[60:63], v[236:239], v[140:143]
    v_mfma_f32_16x16x32_bf16 v[144:147], v[64:67], v[236:239], v[144:147]
    v_mfma_f32_16x16x32_bf16 v[148:151], v[68:71], v[236:239], v[148:151]
    v_mfma_f32_16x16x32_bf16 v[152:155], v[72:75], v[236:239], v[152:155]
    v_mfma_f32_16x16x32_bf16 v[156:159], v[76:79], v[236:239], v[156:159]
    v_mfma_f32_16x16x32_bf16 v[80:83], v[60:63], v[224:227], v[80:83]
    v_mfma_f32_16x16x32_bf16 v[84:87], v[64:67], v[224:227], v[84:87]
    v_mfma_f32_16x16x32_bf16 v[88:91], v[68:71], v[224:227], v[88:91]
    v_mfma_f32_16x16x32_bf16 v[92:95], v[72:75], v[224:227], v[92:95]
    v_mfma_f32_16x16x32_bf16 v[96:99], v[76:79], v[224:227], v[96:99]
    s_mul_i32 s31, s3, 15360
    s_add_u32 s31, s31, 102400
    v_add_u32 v176, s31, v194
    ds_write_b128 v176, v[100:103] offset:0
    ds_write_b128 v176, v[104:107] offset:1024
    ds_write_b128 v176, v[108:111] offset:2048
    ds_write_b128 v176, v[112:115] offset:3072
    ds_write_b128 v176, v[116:119] offset:4096
    ds_write_b128 v176, v[120:123] offset:5120
    ds_write_b128 v176, v[124:127] offset:6144
    ds_write_b128 v176, v[128:131] offset:7168
    ds_write_b128 v176, v[132:135] offset:8192
    ds_write_b128 v176, v[136:139] offset:9216
    ds_write_b128 v176, v[140:143] offset:10240
    ds_write_b128 v176, v[144:147] offset:11264
    ds_write_b128 v176, v[148:151] offset:12288
    ds_write_b128 v176, v[152:155] offset:13312
    ds_write_b128 v176, v[156:159] offset:14336
    s_waitcnt lgkmcnt(0)
    s_barrier
    ds_read_b128 v[0:3], v199 offset:0
    ds_read_b128 v[20:23], v200 offset:5120
    ds_read_b128 v[40:43], v201 offset:10240
    ds_read_b128 v[4:7], v199 offset:1024
    ds_read_b128 v[24:27], v200 offset:6144
    ds_read_b128 v[44:47], v201 offset:11264
    ds_read_b128 v[8:11], v199 offset:2048
    ds_read_b128 v[28:31], v200 offset:7168
    ds_read_b128 v[48:51], v201 offset:12288
    ds_read_b128 v[12:15], v199 offset:3072
    ds_read_b128 v[32:35], v200 offset:8192
    ds_read_b128 v[52:55], v201 offset:13312
    ds_read_b128 v[16:19], v199 offset:4096
    ds_read_b128 v[36:39], v200 offset:9216
    ds_read_b128 v[56:59], v201 offset:14336
    s_waitcnt lgkmcnt(9)
    v_pk_add_f32 v[0:1], v[0:1], v[20:21]
    v_pk_add_f32 v[2:3], v[2:3], v[22:23]
    v_pk_add_f32 v[4:5], v[4:5], v[24:25]
    v_pk_add_f32 v[6:7], v[6:7], v[26:27]
    v_pk_add_f32 v[80:81], v[80:81], v[40:41]
    v_pk_add_f32 v[82:83], v[82:83], v[42:43]
    v_pk_add_f32 v[84:85], v[84:85], v[44:45]
    v_pk_add_f32 v[86:87], v[86:87], v[46:47]
    v_pk_add_f32 v[80:81], v[80:81], v[0:1]
    v_pk_add_f32 v[82:83], v[82:83], v[2:3]
    v_pk_add_f32 v[84:85], v[84:85], v[4:5]
    v_pk_add_f32 v[86:87], v[86:87], v[6:7]
    v_cvt_pk_bf16_f32 v64, v80, v81
    v_cvt_pk_bf16_f32 v65, v82, v83
    v_cvt_pk_bf16_f32 v66, v84, v85
    v_cvt_pk_bf16_f32 v67, v86, v87
    s_waitcnt lgkmcnt(3)
    v_pk_add_f32 v[8:9], v[8:9], v[28:29]
    v_pk_add_f32 v[10:11], v[10:11], v[30:31]
    v_pk_add_f32 v[12:13], v[12:13], v[32:33]
    v_pk_add_f32 v[14:15], v[14:15], v[34:35]
    v_pk_add_f32 v[88:89], v[88:89], v[48:49]
    v_pk_add_f32 v[90:91], v[90:91], v[50:51]
    v_pk_add_f32 v[92:93], v[92:93], v[52:53]
    v_pk_add_f32 v[94:95], v[94:95], v[54:55]
    v_pk_add_f32 v[88:89], v[88:89], v[8:9]
    v_pk_add_f32 v[90:91], v[90:91], v[10:11]
    v_pk_add_f32 v[92:93], v[92:93], v[12:13]
    v_pk_add_f32 v[94:95], v[94:95], v[14:15]
    v_cvt_pk_bf16_f32 v68, v88, v89
    v_cvt_pk_bf16_f32 v69, v90, v91
    v_cvt_pk_bf16_f32 v70, v92, v93
    v_cvt_pk_bf16_f32 v71, v94, v95
    s_waitcnt lgkmcnt(0)
    v_pk_add_f32 v[16:17], v[16:17], v[36:37]
    v_pk_add_f32 v[18:19], v[18:19], v[38:39]
    v_pk_add_f32 v[96:97], v[96:97], v[56:57]
    v_pk_add_f32 v[98:99], v[98:99], v[58:59]
    v_pk_add_f32 v[96:97], v[96:97], v[16:17]
    v_pk_add_f32 v[98:99], v[98:99], v[18:19]
    v_cvt_pk_bf16_f32 v72, v96, v97
    v_cvt_pk_bf16_f32 v73, v98, v99
    s_cmp_lg_u32 s91, 0
    s_cbranch_scc1 L_g2_last
    buffer_store_dwordx4 v[64:67], v202, s[4:7], s45 offen sc1
    buffer_store_dwordx4 v[68:71], v202, s[4:7], s45 offen offset:2048 sc1
    buffer_store_dwordx2 v[72:73], v203, s[4:7], s45 offen sc1
    s_mov_b32 s48, 0x3f803f80
    v_mov_b32 v100, 0
    v_mov_b32 v101, 0
    v_mov_b32 v102, 0
    v_mov_b32 v103, 0
    v_dot2_f32_bf16 v100, v64, s48, v100
    v_dot2_f32_bf16 v102, v64, v64, v102
    v_dot2_f32_bf16 v101, v65, s48, v101
    v_dot2_f32_bf16 v103, v65, v65, v103
    v_dot2_f32_bf16 v100, v66, s48, v100
    v_dot2_f32_bf16 v102, v66, v66, v102
    v_dot2_f32_bf16 v101, v67, s48, v101
    v_dot2_f32_bf16 v103, v67, v67, v103
    v_dot2_f32_bf16 v100, v68, s48, v100
    v_dot2_f32_bf16 v102, v68, v68, v102
    v_dot2_f32_bf16 v101, v69, s48, v101
    v_dot2_f32_bf16 v103, v69, v69, v103
    v_dot2_f32_bf16 v100, v70, s48, v100
    v_dot2_f32_bf16 v102, v70, v70, v102
    v_dot2_f32_bf16 v101, v71, s48, v101
    v_dot2_f32_bf16 v103, v71, v71, v103
    v_dot2_f32_bf16 v100, v72, s48, v100
    v_dot2_f32_bf16 v102, v72, v72, v102
    v_dot2_f32_bf16 v101, v73, s48, v101
    v_dot2_f32_bf16 v103, v73, v73, v103
    s_nop 2
    v_add_f32 v100, v100, v101
    v_add_f32 v102, v102, v103
    s_nop 1
    v_permlane16_swap_b32 v100, v102
    v_add_f32 v100, v100, v102
    v_mov_b32 v101, v100
    s_nop 1
    v_permlane32_swap_b32 v100, v101
    v_add_f32 v100, v100, v101
    buffer_atomic_add_f32 v100, v204, s[4:7], s46 offen
    s_branch L_next
L_g2_last:
    buffer_store_dwordx4 v[64:67], v202, s[12:15], s45 offen
    buffer_store_dwordx4 v[68:71], v202, s[12:15], s45 offen offset:64
    buffer_store_dwordx2 v[72:73], v203, s[12:15], s45 offen offset:128
    s_cmp_lg_u32 s2, 0
    s_cbranch_scc1 L_fin
    s_cmp_lg_u32 s24, 0
    s_cbranch_scc1 L_fin
    v_mov_b32 v250, s90
    s_mov_b64 exec, 1
    buffer_store_dword v250, v255, s[4:7], 0 offen
    s_mov_b64 exec, -1
L_fin:
L_end:
    s_endpgm
.section .rodata,"a"
.p2align 6
.amdhsa_kernel interleave_layers__softmax_full_mha__mixer_token_mlp__prompt_kernel
  .amdhsa_next_free_vgpr 256
  .amdhsa_next_free_sgpr 102
  .amdhsa_accum_offset 256
  .amdhsa_group_segment_fixed_size 0
  .amdhsa_kernarg_size 88
  .amdhsa_user_sgpr_count 2
  .amdhsa_user_sgpr_kernarg_segment_ptr 1
  .amdhsa_system_sgpr_workgroup_id_x 1
.end_amdhsa_kernel
```
